```python
import torch

def _softmax(x, axis=-1):
    return torch.softmax(x, dim=axis)
def _gelu(x):
    return torch.nn.functional.gelu(x, approximate="tanh")
def _silu(x):
    return torch.nn.functional.silu(x)
def _sigmoid(x):
    return torch.sigmoid(x)
def _layernorm(x, axis=-1, eps=1e-5):
    m = x.mean(dim=axis, keepdim=True)
    v = x.var(dim=axis, keepdim=True, unbiased=False)
    return (x - m) / torch.sqrt(v + eps)
def _scatter_add(tgt, idx, src, axis=0):
    return tgt.clone().index_add_(axis, idx, src)
def _segment_sum(src, seg, n):
    out = torch.zeros((n,) + src.shape[1:], dtype=src.dtype)
    return out.index_add_(0, seg, src)
def _pad(x, pw):
    flat = tuple(v for pair in reversed(pw) for v in pair)
    return torch.nn.functional.pad(x, flat)

kernel_name = 'standalone__deep_cross_xdeepfm__recsys'

def setup_inputs():

    _w = (lambda a: (lambda t: t.to(torch.bfloat16) if t.is_floating_point() else t)(torch.as_tensor(a)))
    B, F, D, L = 4096, 26, 32, 6
    V = min(100000, 100000)
    Din = F * D
    return {
        "idx": _w((lambda lo, hi, *s: torch.randint(lo, hi, s))(0, V, B, F).to(torch.int64)),
        "table": _w((lambda *s: torch.randn(*s, dtype=torch.bfloat16) * 0.8)(V, D)),
        "ws_cin": _w((lambda *s: torch.randn(*s, dtype=torch.bfloat16) * 0.2)(L, F, F, F) * (1.0 / F)),
        "w_cin_out": _w((lambda *s: torch.randn(*s, dtype=torch.bfloat16) * 0.2)(L * F) * ((L * F) ** -0.5)),
        "w_dnn1": _w((lambda *s: torch.randn(*s, dtype=torch.bfloat16) * 0.8)(Din, Din) * (Din ** -0.5)),
        "b_dnn1": _w((lambda *s: torch.randn(*s, dtype=torch.bfloat16) * 3.2)(Din) * 0.1),
        "w_dnn2": _w((lambda *s: torch.randn(*s, dtype=torch.bfloat16) * 0.2)(Din) * (Din ** -0.5)),
        "b_out": _w((lambda *s: torch.randn(*s, dtype=torch.bfloat16) * 0.2)(1)),
    }

def reference(idx, table, ws_cin, w_cin_out, w_dnn1, b_dnn1, w_dnn2, b_out):
    x0 = table[idx]
    B = x0.shape[0]
    L = ws_cin.shape[0]
    xk = x0
    pooled = []
    for l in range(L):
        xk = torch.einsum('bid,bjd,hij->bhd', xk, x0, ws_cin[l])
        pooled.append(xk.sum(axis=-1))
    p_plus = torch.stack(pooled, axis=1).reshape(B, -1)
    logit_cin = p_plus @ w_cin_out
    h = x0.reshape(B, -1)
    h = _gelu(h @ w_dnn1 + b_dnn1)
    logit_dnn = h @ w_dnn2
    return logit_cin + logit_dnn + b_out
```

```asm
; @launch grid=(256,1,1) block=(512,1,1) lds=162304
.amdgcn_target "amdgcn-amd-amdhsa--gfx950"
.text
.globl standalone__deep_cross_xdeepfm__recsys_kernel
.p2align 8
.type standalone__deep_cross_xdeepfm__recsys_kernel,@function
standalone__deep_cross_xdeepfm__recsys_kernel:
    s_cmp_ge_u32 s2, 256
    s_cbranch_scc1 L_end
    s_load_dwordx16 s[48:63], s[0:1], 0
    s_load_dwordx4 s[64:67], s[0:1], 64
    s_load_dwordx2 s[68:69], s[0:1], 80
    s_getpc_b64 s[76:77]
L_pfbase:
    s_mov_b32 s78, L_end - L_pfbase
    s_mov_b32 s79, 0x00020000
    s_lshr_b32 s72, s2, 3
    s_lshl_b32 s72, s72, 7
    v_xor_b32 v1, 0x1c0, v0
    v_lshlrev_b32 v1, 12, v1
    buffer_load_dword v255, v1, s[76:79], s72 offen
    v_lshrrev_b32 v1, 6, v0
    v_and_b32 v0, 63, v0
    v_readfirstlane_b32 s83, v1
    s_and_b32 s72, s2, 7
    s_lshr_b32 s73, s2, 3
    s_lshr_b32 s70, s73, 4
    s_lshl_b32 s72, s72, 1
    s_add_u32 s70, s70, s72
    s_and_b32 s71, s73, 15
    s_mov_b32 s80, 0x7fff7fff
    v_and_b32 v25, 31, v0
    v_lshlrev_b32 v25, 2, v25
    v_add_u32 v25, 160000, v25
    v_mov_b32 v2, 0
    ds_write_b32 v25, v2
    s_cmp_ge_u32 s83, 4
    s_cbranch_scc1 L_helper
    s_setprio 3
    s_lshl_b32 s72, s70, 8
    s_lshl_b32 s73, s71, 4
    s_add_u32 s72, s72, s73
    s_lshl_b32 s73, s83, 2
    s_add_u32 s82, s72, s73
    v_lshrrev_b32 v1, 4, v0
    v_bfe_u32 v2, v0, 2, 2
    v_and_b32 v3, 3, v0
    v_mul_u32_u24 v4, 104, v1
    v_mad_u32_u24 v4, v2, 28, v4
    s_mov_b32 s6, 425984
    s_mov_b32 s7, 0x00020000
    s_mul_i32 s72, s82, 104
    s_waitcnt lgkmcnt(0)
    s_mov_b64 s[4:5], s[48:49]
    buffer_load_dwordx4 v[8:11], v4, s[4:7], s72 offen nt
    buffer_load_dwordx3 v[12:14], v4, s[4:7], s72 offen offset:16 nt
    v_lshlrev_b32 v15, 20, v0
    s_cmp_lg_u32 s83, 0
    s_cbranch_scc1 L_tt_1
    s_mov_b32 s10, 6400000
    s_mov_b32 s11, 0x00020000
    s_mov_b64 s[8:9], s[50:51]
    buffer_load_ushort v19, v15, s[8:11], 0 offen
L_tt_1:
    s_setprio 1
    s_branch L_cin2
L_helper:
    s_setprio 2
    s_sub_u32 s3, s83, 4
    v_and_b32 v2, 31, v0
    v_lshrrev_b32 v3, 5, v0
    v_lshlrev_b32 v252, 4, v3
    v_lshrrev_b32 v4, 3, v2
    v_and_b32 v6, 3, v2
    v_lshl_add_u32 v4, v4, 2, v6
    v_bfe_u32 v6, v2, 2, 1
    v_mad_u32_u24 v254, v6, 13, v4
    v_cmp_lt_u32 vcc, 12, v4
    v_mov_b32 v7, 0x100000
    s_nop 0
    v_cndmask_b32 v254, v254, v7, vcc
    v_mul_u32_u24 v4, 676, v3
    s_movk_i32 s73, 1352
    v_mad_u32_u24 v243, v254, s73, v4
    s_mov_b32 s42, 35152
    s_mov_b32 s43, 0x00020000
    s_mov_b32 s14, 268435456
    s_mov_b32 s15, 0x00020000
    s_mov_b32 s46, 312
    s_mov_b32 s47, 0x00020000
    s_mov_b32 s18, 1384448
    s_mov_b32 s19, 0x00020000
    s_mov_b32 s22, 1664
    s_mov_b32 s23, 0x00020000
    s_mov_b32 s26, 1664
    s_mov_b32 s27, 0x00020000
    s_mov_b32 s34, 256
    s_mov_b32 s35, 0x00020000
    s_waitcnt lgkmcnt(0)
    s_mov_b64 s[40:41], s[52:53]
    s_mov_b64 s[12:13], s[68:69]
    s_mov_b64 s[44:45], s[54:55]
    s_mov_b64 s[16:17], s[56:57]
    s_mov_b64 s[20:21], s[58:59]
    s_mov_b64 s[24:25], s[60:61]
    s_mov_b64 s[32:33], s[66:67]
    s_mov_b64 s[56:57], s[40:41]
    s_mov_b32 s59, 0x00020000
    s_mov_b32 s58, 70304
    s_cmp_lt_u32 s71, 15
    s_cselect_b32 s48, 63, s70
    s_mov_b32 s68, 0
    s_mul_i32 s55, s70, 4352
    s_add_u32 s55, s55, 364544
    s_cmp_lg_u32 s3, 0
    s_cbranch_scc1 L_nowpf
    s_mov_b32 s42, 210912
    s_lshr_b32 s72, s2, 3
    s_lshl_b32 s72, s72, 7
    v_lshlrev_b32 v1, 12, v0
    buffer_load_dword v247, v1, s[40:43], s72 offen
    s_mov_b32 s42, 35152
    s_cmp_lt_u32 s71, 15
    s_cbranch_scc1 L_nowpf
    v_mov_b32 v36, 0
    v_mov_b32 v37, 0
    v_mov_b32 v38, 0
    v_mov_b32 v39, 0
    v_lshlrev_b32 v35, 8, v0
    v_cmp_lt_u32 vcc, 2, v0
    v_mov_b32 v34, 1073741824
    s_nop 0
    v_cndmask_b32 v35, v35, v34, vcc
    buffer_store_dwordx4 v[36:39], v35, s[12:15], s55 offen sc1
L_nowpf:
    s_cmp_lt_u32 s48, 11
    s_cbranch_scc0 L_nc_18
    s_call_b64 s[66:67], L_pe1
L_nc_18:
    v_and_b32 v2, 31, v0
    v_lshrrev_b32 v3, 5, v0
    v_mad_u32_u24 v1, v2, 52, v252
    s_mul_i32 s72, s3, 1352
    s_add_u32 s73, s72, 0
    buffer_load_dwordx4 v[180:183], v1, s[40:43], s73 offen offset:0
    buffer_load_dwordx4 v[184:187], v1, s[40:43], s73 offen offset:32
    s_add_u32 s73, s72, 17576
    buffer_load_dwordx4 v[188:191], v1, s[40:43], s73 offen offset:0
    buffer_load_dwordx4 v[192:195], v1, s[40:43], s73 offen offset:32
    s_add_u32 s73, s72, 5408
    buffer_load_dwordx4 v[196:199], v1, s[40:43], s73 offen offset:0
    buffer_load_dwordx4 v[200:203], v1, s[40:43], s73 offen offset:32
    s_add_u32 s73, s72, 22984
    buffer_load_dwordx4 v[204:207], v1, s[40:43], s73 offen offset:0
    buffer_load_dwordx4 v[208:211], v1, s[40:43], s73 offen offset:32
    s_add_u32 s73, s72, 10816
    buffer_load_dwordx4 v[212:215], v1, s[40:43], s73 offen offset:0
    buffer_load_dwordx4 v[216:219], v1, s[40:43], s73 offen offset:32
    s_add_u32 s73, s72, 28392
    buffer_load_dwordx4 v[220:223], v1, s[40:43], s73 offen offset:0
    buffer_load_dwordx4 v[224:227], v1, s[40:43], s73 offen offset:32
    s_mul_i32 s73, s3, 17576
    s_add_u32 s73, s73, 16224
    buffer_load_dwordx4 v[228:231], v1, s[40:43], s73 offen offset:0
    buffer_load_dwordx4 v[232:235], v1, s[40:43], s73 offen offset:32
    s_branch L_helper2
L_cin2:
    s_mov_b64 s[40:41], s[52:53]
    s_mov_b64 s[8:9], s[50:51]
    s_mov_b64 s[12:13], s[68:69]
    s_mov_b64 s[28:29], s[64:65]
    s_load_dword s36, s[62:63], 0
    s_mov_b32 s42, 35152
    s_mov_b32 s43, 0x00020000
    s_mov_b32 s10, 6400000
    s_mov_b32 s11, 0x00020000
    s_mov_b32 s14, 268435456
    s_mov_b32 s15, 0x00020000
    s_mov_b32 s30, 8192
    s_mov_b32 s31, 0x00020000
    s_mov_b32 s42, 70304
    s_mov_b32 s3, s83
    v_lshlrev_b32 v5, 4, v3
    v_cmp_eq_u32 vcc, 3, v2
    v_mov_b32 v6, 1073741824
    s_nop 0
    v_cndmask_b32 v6, 0, v6, vcc
    v_add_u32 v6, v6, v5
    v_lshlrev_b32 v26, 4, v0
    v_cmp_lt_u32 vcc, 42, v0
    v_mov_b32 v27, 1073741824
    s_nop 0
    v_cndmask_b32 v26, v26, v27, vcc
    v_lshlrev_b32 v29, 4, v0
    v_add_u32 v29, 28672, v29
    s_lshl_b32 s72, s3, 4
    s_add_u32 s72, s72, 45056
    v_mul_u32_u24 v28, 1040, v0
    v_add_u32 v28, s72, v28
    v_cndmask_b32 v28, v28, v29, vcc
    s_mul_i32 s73, s83, 6720
    s_add_u32 s73, s73, 90112
    v_mul_u32_u24 v7, 1680, v1
    v_mad_u32_u24 v16, v2, 7, 0
    v_lshl_add_u32 v7, v16, 6, v7
    v_add3_u32 v7, v7, v5, s73
    v_cmp_eq_u32 vcc, 3, v2
    v_lshl_add_u32 v18, v0, 4, 0
    v_add_u32 v18, 116928, v18
    v_cndmask_b32 v18, v7, v18, vcc
    v_lshrrev_b32 v16, 1, v1
    v_xor_b32 v16, v16, v2
    v_lshlrev_b32 v16, 6, v16
    v_and_b32 v17, 1, v1
    v_lshl_add_u32 v16, v17, 5, v16
    v_lshl_add_u32 v16, v3, 3, v16
    v_add_u32 v16, s73, v16
    v_mov_b32 v248, 0
    v_mov_b32 v249, 0
    v_mov_b32 v250, 0
    v_mov_b32 v251, 0
    v_mov_b32 v40, 0
    v_mov_b32 v41, 0
    v_mov_b32 v42, 0
    v_mov_b32 v43, 0
    s_and_b32 s72, s3, 1
    s_mul_i32 s72, s72, 48
    s_lshr_b32 s73, s3, 1
    s_mul_i32 s73, s73, 480
    s_add_u32 s72, s72, s73
    v_add_u32 v30, s72, v28
    v_subrev_u32 v31, 45056, v30
    v_cmp_lt_u32 vcc, 22, v0
    s_nop 1
    v_cndmask_b32 v31, v31, v29, vcc
    ds_write_b128 v30, v[40:43] offset:400
    ds_write_b128 v31, v[40:43] offset:400
    ds_write_b128 v30, v[40:43] offset:416
    ds_write_b128 v31, v[40:43] offset:416
    ds_write_b128 v30, v[40:43] offset:432
    ds_write_b128 v31, v[40:43] offset:432
    v_and_b32 v20, 1, v0
    v_lshlrev_b32 v20, 4, v20
    v_mov_b32 v21, 0x3f80
    v_lshlrev_b32 v21, v20, v21
    v_lshrrev_b32 v22, 3, v0
    v_xor_b32 v22, v22, v0
    v_and_b32 v22, 4, v22
    v_bfe_u32 v20, v0, 3, 2
    v_bfe_u32 v23, v0, 1, 1
    v_lshl_add_u32 v20, v20, 1, v23
    v_lshl_add_u32 v20, v22, 3, v20
    v_cmp_eq_u32 vcc, 0, v20
    s_nop 1
    v_cndmask_b32 v32, 0, v21, vcc
    v_cmp_eq_u32 vcc, 1, v20
    s_nop 1
    v_cndmask_b32 v33, 0, v21, vcc
    v_cmp_eq_u32 vcc, 2, v20
    s_nop 1
    v_cndmask_b32 v34, 0, v21, vcc
    v_cmp_eq_u32 vcc, 3, v20
    s_nop 1
    v_cndmask_b32 v35, 0, v21, vcc
    v_cmp_eq_u32 vcc, 4, v20
    s_nop 1
    v_cndmask_b32 v36, 0, v21, vcc
    v_cmp_eq_u32 vcc, 5, v20
    s_nop 1
    v_cndmask_b32 v37, 0, v21, vcc
    v_cmp_eq_u32 vcc, 6, v20
    s_nop 1
    v_cndmask_b32 v38, 0, v21, vcc
    v_cmp_eq_u32 vcc, 7, v20
    s_nop 1
    v_cndmask_b32 v39, 0, v21, vcc
    s_setprio 1
    s_barrier
    s_mul_i32 s72, s3, 1352
    s_add_u32 s73, s72, 35152
    buffer_load_dwordx4 v[132:135], v26, s[40:43], s73 offen offset:0
    buffer_load_dwordx4 v[136:139], v26, s[40:43], s73 offen offset:676
    s_add_u32 s73, s72, 52728
    buffer_load_dwordx4 v[140:143], v26, s[40:43], s73 offen offset:0
    buffer_load_dwordx4 v[144:147], v26, s[40:43], s73 offen offset:676
    s_add_u32 s73, s72, 40560
    buffer_load_dwordx4 v[148:151], v26, s[40:43], s73 offen offset:0
    buffer_load_dwordx4 v[152:155], v26, s[40:43], s73 offen offset:676
    s_add_u32 s73, s72, 58136
    buffer_load_dwordx4 v[156:159], v26, s[40:43], s73 offen offset:0
    buffer_load_dwordx4 v[160:163], v26, s[40:43], s73 offen offset:676
    s_add_u32 s73, s72, 45968
    buffer_load_dwordx4 v[164:167], v26, s[40:43], s73 offen offset:0
    buffer_load_dwordx4 v[168:171], v26, s[40:43], s73 offen offset:676
    s_add_u32 s73, s72, 63544
    buffer_load_dwordx4 v[172:175], v26, s[40:43], s73 offen offset:0
    buffer_load_dwordx4 v[176:179], v26, s[40:43], s73 offen offset:676
    s_lshr_b32 s73, s3, 1
    s_mul_i32 s73, s73, 17576
    s_and_b32 s74, s3, 1
    s_mul_i32 s74, s74, 676
    s_add_u32 s73, s73, s74
    s_add_u32 s73, s73, 51376
    buffer_load_dwordx4 v[180:183], v26, s[40:43], s73 offen
    s_setprio 3
    s_waitcnt vmcnt(13)
    v_lshl_add_u32 v8, v8, 6, v5
    buffer_load_dwordx4 v[68:71], v8, s[8:11], 0 offen nt
    v_lshl_add_u32 v9, v9, 6, v5
    buffer_load_dwordx4 v[72:75], v9, s[8:11], 0 offen nt
    v_lshl_add_u32 v10, v10, 6, v5
    buffer_load_dwordx4 v[76:79], v10, s[8:11], 0 offen nt
    v_lshl_add_u32 v11, v11, 6, v5
    buffer_load_dwordx4 v[80:83], v11, s[8:11], 0 offen nt
    v_lshl_add_u32 v12, v12, 6, v5
    buffer_load_dwordx4 v[84:87], v12, s[8:11], 0 offen nt
    v_lshl_add_u32 v13, v13, 6, v6
    buffer_load_dwordx4 v[88:91], v13, s[8:11], 0 offen nt
    v_lshl_add_u32 v14, v14, 6, v6
    buffer_load_dwordx4 v[92:95], v14, s[8:11], 0 offen nt
    s_setprio 1
    s_waitcnt vmcnt(19)
    v_mfma_f32_32x32x16_bf16 v[184:199], v[32:35], v[132:135], 0
    s_waitcnt vmcnt(18)
    v_mfma_f32_32x32x16_bf16 v[184:199], v[36:39], v[136:139], v[184:199]
    s_waitcnt vmcnt(17)
    v_mfma_f32_32x32x16_bf16 v[200:215], v[32:35], v[140:143], 0
    s_waitcnt vmcnt(16)
    v_mfma_f32_32x32x16_bf16 v[200:215], v[36:39], v[144:147], v[200:215]
    s_nop 7
    v_max_f32 v1, |v184|, |v185|
    v_max3_f32 v1, v1, |v186|, |v187|
    v_max3_f32 v1, v1, |v188|, |v189|
    v_max3_f32 v1, v1, |v190|, |v191|
    v_max3_f32 v1, v1, |v192|, |v193|
    v_max3_f32 v1, v1, |v194|, |v195|
    v_max3_f32 v1, v1, |v196|, |v197|
    v_max3_f32 v1, v1, |v198|, |v199|
    s_waitcnt vmcnt(15)
    v_mfma_f32_32x32x16_bf16 v[216:231], v[32:35], v[148:151], 0
    s_waitcnt vmcnt(14)
    v_mfma_f32_32x32x16_bf16 v[216:231], v[36:39], v[152:155], v[216:231]
    v_max3_f32 v1, v1, |v200|, |v201|
    v_max3_f32 v1, v1, |v202|, |v203|
    v_max3_f32 v1, v1, |v204|, |v205|
    v_max3_f32 v1, v1, |v206|, |v207|
    v_max3_f32 v1, v1, |v208|, |v209|
    v_max3_f32 v1, v1, |v210|, |v211|
    v_max3_f32 v1, v1, |v212|, |v213|
    v_max3_f32 v1, v1, |v214|, |v215|
    s_waitcnt vmcnt(13)
    v_mfma_f32_32x32x16_bf16 v[232:247], v[32:35], v[156:159], 0
    s_waitcnt vmcnt(12)
    v_mfma_f32_32x32x16_bf16 v[232:247], v[36:39], v[160:163], v[232:247]
    v_max3_f32 v1, v1, |v216|, |v217|
    v_max3_f32 v1, v1, |v218|, |v219|
    v_max3_f32 v1, v1, |v220|, |v221|
    v_max3_f32 v1, v1, |v222|, |v223|
    v_max3_f32 v1, v1, |v224|, |v225|
    v_max3_f32 v1, v1, |v226|, |v227|
    v_max3_f32 v1, v1, |v228|, |v229|
    v_max3_f32 v1, v1, |v230|, |v231|
    s_waitcnt vmcnt(11)
    v_mfma_f32_32x32x16_bf16 v[184:199], v[32:35], v[164:167], 0
    s_waitcnt vmcnt(10)
    v_mfma_f32_32x32x16_bf16 v[184:199], v[36:39], v[168:171], v[184:199]
    v_max3_f32 v1, v1, |v232|, |v233|
    v_max3_f32 v1, v1, |v234|, |v235|
    v_max3_f32 v1, v1, |v236|, |v237|
    v_max3_f32 v1, v1, |v238|, |v239|
    v_max3_f32 v1, v1, |v240|, |v241|
    v_max3_f32 v1, v1, |v242|, |v243|
    v_max3_f32 v1, v1, |v244|, |v245|
    v_max3_f32 v1, v1, |v246|, |v247|
    s_waitcnt vmcnt(9)
    v_mfma_f32_32x32x16_bf16 v[200:215], v[32:35], v[172:175], 0
    s_waitcnt vmcnt(8)
    v_mfma_f32_32x32x16_bf16 v[200:215], v[36:39], v[176:179], v[200:215]
    v_max3_f32 v1, v1, |v184|, |v185|
    v_max3_f32 v1, v1, |v186|, |v187|
    v_max3_f32 v1, v1, |v188|, |v189|
    v_max3_f32 v1, v1, |v190|, |v191|
    v_max3_f32 v1, v1, |v192|, |v193|
    v_max3_f32 v1, v1, |v194|, |v195|
    v_max3_f32 v1, v1, |v196|, |v197|
    v_max3_f32 v1, v1, |v198|, |v199|
    s_waitcnt vmcnt(7)
    v_mfma_f32_32x32x16_bf16 v[216:231], v[32:35], v[180:183], 0
    s_and_b32 s72, s3, 1
    s_lshl_b32 s72, s72, 4
    v_max3_f32 v1, v1, |v200|, |v201|
    v_max3_f32 v1, v1, |v202|, |v203|
    v_max3_f32 v1, v1, |v204|, |v205|
    v_max3_f32 v1, v1, |v206|, |v207|
    v_max3_f32 v1, v1, |v208|, |v209|
    v_max3_f32 v1, v1, |v210|, |v211|
    v_max3_f32 v1, v1, |v212|, |v213|
    v_max3_f32 v1, v1, |v214|, |v215|
    v_alignbit_b32 v180, v180, v180, s72
    v_alignbit_b32 v181, v181, v181, s72
    v_alignbit_b32 v182, v182, v182, s72
    v_alignbit_b32 v183, v183, v183, s72
    v_max3_f32 v1, v1, |v216|, |v217|
    v_max3_f32 v1, v1, |v218|, |v219|
    v_max3_f32 v1, v1, |v220|, |v221|
    v_max3_f32 v1, v1, |v222|, |v223|
    s_nop 1
    v_max_u32_dpp v1, v1, v1 row_ror:8 row_mask:0xf bank_mask:0xf
    s_nop 1
    v_max_u32_dpp v1, v1, v1 row_ror:4 row_mask:0xf bank_mask:0xf
    s_nop 1
    v_max_u32_dpp v1, v1, v1 row_ror:2 row_mask:0xf bank_mask:0xf
    s_nop 1
    v_max_u32_dpp v1, v1, v1 row_ror:1 row_mask:0xf bank_mask:0xf
    v_lshrrev_b32 v2, 4, v0
    s_lshl_b32 s72, s3, 4
    s_add_u32 s72, s72, 159808
    v_lshl_add_u32 v2, v2, 2, s72
    ds_write_b32 v2, v1
    v_mov_b32 v2, 1
    s_mov_b64 exec, 1
    ds_add_u32 v25, v2 offset:4
    s_mov_b64 exec, -1
    v_and_b32 v40, 0x800080, v32
    v_and_b32 v41, 0x800080, v33
    v_and_b32 v42, 0x800080, v34
    v_and_b32 v43, 0x800080, v35
    v_and_b32 v44, 0x800080, v36
    v_and_b32 v45, 0x800080, v37
    v_and_b32 v46, 0x800080, v38
    v_and_b32 v47, 0x800080, v39
    s_setprio 1
    s_mov_b32 s72, 1600000
L_lw_2:
    ds_read_b32 v2, v25 offset:4
    s_waitcnt lgkmcnt(0)
    v_readfirstlane_b32 s73, v2
    s_nop 0
    s_cmp_ge_u32 s73, 4
    s_cbranch_scc1 L_ld_3
    s_sleep 1
    s_sub_u32 s72, s72, 1
    s_cbranch_scc0 L_lw_2
L_ld_3:
    v_and_b32 v2, 15, v0
    v_lshlrev_b32 v2, 2, v2
    v_add_u32 v2, 159808, v2
    ds_read_b32 v1, v2
    s_waitcnt lgkmcnt(0)
    v_max_u32_dpp v1, v1, v1 row_ror:8 row_mask:0xf bank_mask:0xf
    s_nop 1
    v_max_u32_dpp v1, v1, v1 row_ror:4 row_mask:0xf bank_mask:0xf
    s_nop 1
    v_max_u32_dpp v1, v1, v1 row_ror:2 row_mask:0xf bank_mask:0xf
    s_nop 1
    v_max_u32_dpp v1, v1, v1 row_ror:1 row_mask:0xf bank_mask:0xf
    s_nop 0
    v_readfirstlane_b32 s72, v1
    s_nop 0
    s_lshr_b32 s72, s72, 23
    s_min_u32 s72, s72, 249
    s_sub_u32 s50, s72, 124
    s_sub_u32 s72, 251, s72
    v_mul_u32_u24 v40, s72, v40
    v_mul_u32_u24 v41, s72, v41
    v_mul_u32_u24 v42, s72, v42
    v_mul_u32_u24 v43, s72, v43
    v_mul_u32_u24 v44, s72, v44
    v_mul_u32_u24 v45, s72, v45
    v_mul_u32_u24 v46, s72, v46
    v_mul_u32_u24 v47, s72, v47
    v_mfma_f32_32x32x16_bf16 v[184:199], v[40:43], v[132:135], 0
    s_nop 0
    v_mfma_f32_32x32x16_bf16 v[184:199], v[44:47], v[136:139], v[184:199]
    v_mfma_f32_32x32x16_bf16 v[200:215], v[40:43], v[140:143], 0
    v_mfma_f32_32x32x16_bf16 v[200:215], v[44:47], v[144:147], v[200:215]
    v_mfma_f32_32x32x16_bf16 v[216:231], v[40:43], v[148:151], 0
    s_nop 8
    v_cvt_pk_f16_f32 v132, v184, v185
    v_cvt_pk_f16_f32 v133, v186, v187
    v_cvt_pk_f16_f32 v134, v188, v189
    v_cvt_pk_f16_f32 v135, v190, v191
    ds_write_b128 v28, v[132:135] offset:0
    v_mfma_f32_32x32x16_bf16 v[216:231], v[44:47], v[152:155], v[216:231]
    v_cvt_pk_f16_f32 v136, v193, v192
    v_cvt_pk_f16_f32 v137, v195, v194
    v_cvt_pk_f16_f32 v138, v197, v196
    v_cvt_pk_f16_f32 v139, v199, v198
    ds_write_b128 v28, v[136:139] offset:512
    v_mfma_f32_32x32x16_bf16 v[232:247], v[40:43], v[156:159], 0
    v_cvt_pk_f16_f32 v140, v200, v201
    v_cvt_pk_f16_f32 v141, v202, v203
    v_cvt_pk_f16_f32 v142, v204, v205
    v_cvt_pk_f16_f32 v143, v206, v207
    ds_write_b128 v28, v[140:143] offset:64
    v_mfma_f32_32x32x16_bf16 v[232:247], v[44:47], v[160:163], v[232:247]
    v_cvt_pk_f16_f32 v144, v209, v208
    v_cvt_pk_f16_f32 v145, v211, v210
    v_cvt_pk_f16_f32 v146, v213, v212
    v_cvt_pk_f16_f32 v147, v215, v214
    ds_write_b128 v28, v[144:147] offset:576
    v_mfma_f32_32x32x16_bf16 v[184:199], v[40:43], v[164:167], 0
    v_cvt_pk_f16_f32 v148, v216, v217
    v_cvt_pk_f16_f32 v149, v218, v219
    v_cvt_pk_f16_f32 v150, v220, v221
    v_cvt_pk_f16_f32 v151, v222, v223
    ds_write_b128 v28, v[148:151] offset:128
    v_mfma_f32_32x32x16_bf16 v[184:199], v[44:47], v[168:171], v[184:199]
    v_cvt_pk_f16_f32 v152, v225, v224
    v_cvt_pk_f16_f32 v153, v227, v226
    v_cvt_pk_f16_f32 v154, v229, v228
    v_cvt_pk_f16_f32 v155, v231, v230
    ds_write_b128 v28, v[152:155] offset:640
    v_mfma_f32_32x32x16_bf16 v[200:215], v[40:43], v[172:175], 0
    v_cvt_pk_f16_f32 v156, v232, v233
    v_cvt_pk_f16_f32 v157, v234, v235
    v_cvt_pk_f16_f32 v158, v236, v237
    v_cvt_pk_f16_f32 v159, v238, v239
    ds_write_b128 v28, v[156:159] offset:192
    v_mfma_f32_32x32x16_bf16 v[200:215], v[44:47], v[176:179], v[200:215]
    v_cvt_pk_f16_f32 v160, v241, v240
    v_cvt_pk_f16_f32 v161, v243, v242
    v_cvt_pk_f16_f32 v162, v245, v244
    v_cvt_pk_f16_f32 v163, v247, v246
    ds_write_b128 v28, v[160:163] offset:704
    v_mfma_f32_32x32x16_bf16 v[216:231], v[40:43], v[180:183], 0
    v_cvt_pk_f16_f32 v164, v184, v185
    v_cvt_pk_f16_f32 v165, v186, v187
    v_cvt_pk_f16_f32 v166, v188, v189
    v_cvt_pk_f16_f32 v167, v190, v191
    ds_write_b128 v28, v[164:167] offset:256
    v_cvt_pk_f16_f32 v168, v193, v192
    v_cvt_pk_f16_f32 v169, v195, v194
    v_cvt_pk_f16_f32 v170, v197, v196
    v_cvt_pk_f16_f32 v171, v199, v198
    ds_write_b128 v28, v[168:171] offset:768
    v_cvt_pk_f16_f32 v172, v200, v201
    v_cvt_pk_f16_f32 v173, v202, v203
    v_cvt_pk_f16_f32 v174, v204, v205
    v_cvt_pk_f16_f32 v175, v206, v207
    ds_write_b128 v28, v[172:175] offset:320
    v_cvt_pk_f16_f32 v176, v209, v208
    v_cvt_pk_f16_f32 v177, v211, v210
    v_cvt_pk_f16_f32 v178, v213, v212
    v_cvt_pk_f16_f32 v179, v215, v214
    ds_write_b128 v28, v[176:179] offset:832
    v_cvt_pk_f16_f32 v180, v216, v217
    v_cvt_pk_f16_f32 v181, v218, v219
    v_cvt_pk_f16_f32 v182, v220, v221
    v_cvt_pk_f16_f32 v183, v222, v223
    s_lshr_b32 s72, s3, 1
    s_lshl_b32 s72, s72, 5
    s_and_b32 s73, s3, 1
    s_mul_i32 s73, s73, 496
    s_add_u32 s72, s72, s73
    v_add_u32 v28, s72, v28
    ds_write_b128 v28, v[180:183] offset:384
    ds_read_b32 v3, v25 offset:80
    v_lshlrev_b32 v1, 4, v0
    ds_read_b128 v[228:231], v1 offset:0
    ds_read_b128 v[232:235], v1 offset:1040
    s_waitcnt lgkmcnt(2)
    v_mov_b32 v2, 1
    s_setprio 3
    s_waitcnt vmcnt(6)
    v_mfma_f32_32x32x16_bf16 v[132:147], v[32:35], v[68:71], 0
    ds_write_b128 v7, v[68:71] offset:0
    s_waitcnt vmcnt(5)
    v_mfma_f32_32x32x16_bf16 v[132:147], v[36:39], v[72:75], v[132:147]
    ds_write_b128 v7, v[72:75] offset:64
    s_waitcnt vmcnt(4)
    v_mfma_f32_32x32x16_bf16 v[148:163], v[32:35], v[76:79], 0
    ds_write_b128 v7, v[76:79] offset:128
    s_waitcnt vmcnt(3)
    v_mfma_f32_32x32x16_bf16 v[148:163], v[36:39], v[80:83], v[148:163]
    ds_write_b128 v7, v[80:83] offset:192
    s_nop 4
    v_max_f32 v20, |v132|, |v133|
    v_max3_f32 v20, v20, |v134|, |v135|
    v_max3_f32 v20, v20, |v136|, |v137|
    v_max3_f32 v20, v20, |v138|, |v139|
    v_max3_f32 v20, v20, |v140|, |v141|
    v_max3_f32 v20, v20, |v142|, |v143|
    v_max3_f32 v20, v20, |v144|, |v145|
    v_max3_f32 v20, v20, |v146|, |v147|
    s_waitcnt vmcnt(2)
    v_mfma_f32_32x32x16_bf16 v[164:179], v[32:35], v[84:87], 0
    ds_write_b128 v7, v[84:87] offset:256
    s_waitcnt vmcnt(1)
    v_mfma_f32_32x32x16_bf16 v[164:179], v[36:39], v[88:91], v[164:179]
    ds_write_b128 v18, v[88:91] offset:320
    v_max3_f32 v20, v20, |v148|, |v149|
    v_max3_f32 v20, v20, |v150|, |v151|
    v_max3_f32 v20, v20, |v152|, |v153|
    v_max3_f32 v20, v20, |v154|, |v155|
    v_max3_f32 v20, v20, |v156|, |v157|
    v_max3_f32 v20, v20, |v158|, |v159|
    v_max3_f32 v20, v20, |v160|, |v161|
    v_max3_f32 v20, v20, |v162|, |v163|
    s_waitcnt vmcnt(0)
    v_mfma_f32_32x32x16_bf16 v[180:195], v[32:35], v[92:95], 0
    ds_write_b128 v18, v[92:95] offset:384
    s_mov_b64 exec, 1
    ds_add_u32 v25, v2 offset:88
    s_mov_b64 exec, -1
    v_max3_f32 v20, v20, |v164|, |v165|
    v_max3_f32 v20, v20, |v166|, |v167|
    v_max3_f32 v20, v20, |v168|, |v169|
    v_max3_f32 v20, v20, |v170|, |v171|
    v_max3_f32 v20, v20, |v172|, |v173|
    v_max3_f32 v20, v20, |v174|, |v175|
    v_max3_f32 v20, v20, |v176|, |v177|
    v_max3_f32 v20, v20, |v178|, |v179|
    v_max3_f32 v20, v20, |v180|, |v181|
    v_max3_f32 v20, v20, |v182|, |v183|
    v_max3_f32 v20, v20, |v184|, |v185|
    v_max3_f32 v20, v20, |v186|, |v187|
    s_nop 1
    v_max_u32_dpp v20, v20, v20 row_ror:8 row_mask:0xf bank_mask:0xf
    s_nop 1
    v_max_u32_dpp v20, v20, v20 row_ror:4 row_mask:0xf bank_mask:0xf
    s_nop 1
    v_max_u32_dpp v20, v20, v20 row_ror:2 row_mask:0xf bank_mask:0xf
    s_nop 1
    v_max_u32_dpp v20, v20, v20 row_ror:1 row_mask:0xf bank_mask:0xf
    v_lshrrev_b32 v20, 23, v20
    v_max_u32 v20, 4, v20
    v_sub_u32 v22, 257, v20
    v_lshlrev_b32 v22, 23, v22
    v_mul_f32 v132, v132, v22
    v_mul_f32 v133, v133, v22
    v_mul_f32 v134, v134, v22
    v_mul_f32 v135, v135, v22
    v_mul_f32 v136, v136, v22
    v_mul_f32 v137, v137, v22
    v_mul_f32 v138, v138, v22
    v_mul_f32 v139, v139, v22
    v_cvt_pk_f16_f32 v96, v132, v133
    v_cvt_pk_f16_f32 v97, v134, v135
    v_cvt_pk_f16_f32 v98, v136, v137
    v_cvt_pk_f16_f32 v99, v138, v139
    ds_write_b128 v7, v[96:99] offset:28672
    v_mul_f32 v140, v140, v22
    v_mul_f32 v141, v141, v22
    v_mul_f32 v142, v142, v22
    v_mul_f32 v143, v143, v22
    v_mul_f32 v144, v144, v22
    v_mul_f32 v145, v145, v22
    v_mul_f32 v146, v146, v22
    v_mul_f32 v147, v147, v22
    v_cvt_pk_f16_f32 v100, v140, v141
    v_cvt_pk_f16_f32 v101, v142, v143
    v_cvt_pk_f16_f32 v102, v144, v145
    v_cvt_pk_f16_f32 v103, v146, v147
    ds_write_b128 v7, v[100:103] offset:28736
    v_mul_f32 v148, v148, v22
    v_mul_f32 v149, v149, v22
    v_mul_f32 v150, v150, v22
    v_mul_f32 v151, v151, v22
    v_mul_f32 v152, v152, v22
    v_mul_f32 v153, v153, v22
    v_mul_f32 v154, v154, v22
    v_mul_f32 v155, v155, v22
    v_cvt_pk_f16_f32 v104, v148, v149
    v_cvt_pk_f16_f32 v105, v150, v151
    v_cvt_pk_f16_f32 v106, v152, v153
    v_cvt_pk_f16_f32 v107, v154, v155
    ds_write_b128 v7, v[104:107] offset:28800
    v_mul_f32 v156, v156, v22
    v_mul_f32 v157, v157, v22
    v_mul_f32 v158, v158, v22
    v_mul_f32 v159, v159, v22
    v_mul_f32 v160, v160, v22
    v_mul_f32 v161, v161, v22
    v_mul_f32 v162, v162, v22
    v_mul_f32 v163, v163, v22
    v_cvt_pk_f16_f32 v108, v156, v157
    v_cvt_pk_f16_f32 v109, v158, v159
    v_cvt_pk_f16_f32 v110, v160, v161
    v_cvt_pk_f16_f32 v111, v162, v163
    ds_write_b128 v7, v[108:111] offset:28864
    v_mul_f32 v164, v164, v22
    v_mul_f32 v165, v165, v22
    v_mul_f32 v166, v166, v22
    v_mul_f32 v167, v167, v22
    v_mul_f32 v168, v168, v22
    v_mul_f32 v169, v169, v22
    v_mul_f32 v170, v170, v22
    v_mul_f32 v171, v171, v22
    v_cvt_pk_f16_f32 v112, v164, v165
    v_cvt_pk_f16_f32 v113, v166, v167
    v_cvt_pk_f16_f32 v114, v168, v169
    v_cvt_pk_f16_f32 v115, v170, v171
    ds_write_b128 v7, v[112:115] offset:28928
    v_mul_f32 v172, v172, v22
    v_mul_f32 v173, v173, v22
    v_mul_f32 v174, v174, v22
    v_mul_f32 v175, v175, v22
    v_mul_f32 v176, v176, v22
    v_mul_f32 v177, v177, v22
    v_mul_f32 v178, v178, v22
    v_mul_f32 v179, v179, v22
    v_cvt_pk_f16_f32 v116, v172, v173
    v_cvt_pk_f16_f32 v117, v174, v175
    v_cvt_pk_f16_f32 v118, v176, v177
    v_cvt_pk_f16_f32 v119, v178, v179
    ds_write_b128 v18, v[116:119] offset:28992
    v_mul_f32 v180, v180, v22
    v_mul_f32 v181, v181, v22
    v_mul_f32 v182, v182, v22
    v_mul_f32 v183, v183, v22
    v_mul_f32 v184, v184, v22
    v_mul_f32 v185, v185, v22
    v_mul_f32 v186, v186, v22
    v_mul_f32 v187, v187, v22
    v_cvt_pk_f16_f32 v120, v180, v181
    v_cvt_pk_f16_f32 v121, v182, v183
    v_cvt_pk_f16_f32 v122, v184, v185
    v_cvt_pk_f16_f32 v123, v186, v187
    ds_write_b128 v18, v[120:123] offset:29056
    ds_read_b64_tr_b16 v[132:133], v16 offset:28672
    ds_read_b64_tr_b16 v[134:135], v16 offset:28928
    ds_read_b64_tr_b16 v[136:137], v16 offset:29184
    ds_read_b64_tr_b16 v[138:139], v16 offset:29440
    ds_read_b64_tr_b16 v[140:141], v16 offset:29696
    ds_read_b64_tr_b16 v[142:143], v16 offset:29952
    ds_read_b64_tr_b16 v[144:145], v16 offset:30208
    ds_read_b64_tr_b16 v[146:147], v16 offset:30352
    ds_read_b64_tr_b16 v[148:149], v16 offset:30608
    ds_read_b64_tr_b16 v[150:151], v16 offset:30864
    ds_read_b64_tr_b16 v[152:153], v16 offset:31120
    ds_read_b64_tr_b16 v[154:155], v16 offset:31376
    ds_read_b64_tr_b16 v[156:157], v16 offset:31632
    ds_read_b64_tr_b16 v[158:159], v16 offset:31888
    ds_read_b64_tr_b16 v[160:161], v16 offset:32032
    ds_read_b64_tr_b16 v[162:163], v16 offset:32288
    ds_read_b64_tr_b16 v[164:165], v16 offset:32544
    ds_read_b64_tr_b16 v[166:167], v16 offset:32800
    ds_read_b64_tr_b16 v[168:169], v16 offset:33056
    ds_read_b64_tr_b16 v[170:171], v16 offset:33312
    ds_read_b64_tr_b16 v[172:173], v16 offset:33568
    ds_read_b64_tr_b16 v[174:175], v16 offset:33712
    ds_read_b64_tr_b16 v[176:177], v16 offset:33968
    ds_read_b64_tr_b16 v[178:179], v16 offset:34224
    ds_read_b64_tr_b16 v[180:181], v16 offset:34480
    ds_read_b64_tr_b16 v[182:183], v16 offset:34736
    ds_read_b64_tr_b16 v[184:185], v16 offset:34992
    ds_read_b64_tr_b16 v[186:187], v16 offset:35248
    v_readlane_b32 s60, v20, 0
    v_readlane_b32 s61, v20, 16
    v_readlane_b32 s62, v20, 32
    v_readlane_b32 s63, v20, 48
    s_setprio 1
    v_readfirstlane_b32 s72, v3
    s_nop 0
    s_cmp_ge_u32 s72, 4
    s_cbranch_scc1 L_s0ok
    s_mov_b32 s72, 1600000
L_lw_4:
    ds_read_b32 v2, v25 offset:80
    s_waitcnt lgkmcnt(0)
    v_readfirstlane_b32 s73, v2
    s_nop 0
    s_cmp_ge_u32 s73, 4
    s_cbranch_scc1 L_ld_5
    s_sleep 1
    s_sub_u32 s72, s72, 1
    s_cbranch_scc0 L_lw_4
L_ld_5:
    ds_read_b128 v[228:231], v1 offset:0
    ds_read_b128 v[232:235], v1 offset:1040
L_s0ok:
    s_waitcnt lgkmcnt(14)
    s_mov_b32 s81, 964689920
    s_mov_b32 s80, 145
    s_lshl_b32 s36, s36, 16
    v_pk_mul_f16 v216, v132, v132 op_sel_hi:[0,1]
    v_pk_mul_f16 v217, v132, v133 op_sel_hi:[0,1]
    v_pk_mul_f16 v218, v132, v134 op_sel_hi:[0,1]
    v_pk_mul_f16 v219, v132, v135 op_sel_hi:[0,1]
    v_pk_mul_f16 v220, v146, v146 op_sel_hi:[0,1]
    v_pk_mul_f16 v221, v146, v147 op_sel_hi:[0,1]
    v_pk_mul_f16 v222, v146, v148 op_sel_hi:[0,1]
    v_pk_mul_f16 v223, v146, v149 op_sel_hi:[0,1]
    s_waitcnt lgkmcnt(0)
    v_mfma_f32_32x32x16_f16 v[4:19], v[228:231], v[216:219], 0
    ds_read_b128 v[236:239], v1 offset:2080
    v_pk_mul_f16 v224, v160, v160 op_sel_hi:[0,1]
    v_pk_mul_f16 v225, v160, v161 op_sel_hi:[0,1]
    v_pk_mul_f16 v226, v160, v162 op_sel_hi:[0,1]
    v_pk_mul_f16 v227, v160, v163 op_sel_hi:[0,1]
    v_mov_b32 v2, 1
    v_mfma_f32_32x32x16_f16 v[20:35], v[228:231], v[220:223], 0
    ds_read_b128 v[240:243], v1 offset:3120
    v_pk_mul_f16 v216, v174, v174 op_sel_hi:[0,1]
    v_pk_mul_f16 v217, v174, v175 op_sel_hi:[0,1]
    v_pk_mul_f16 v218, v174, v176 op_sel_hi:[0,1]
    v_pk_mul_f16 v219, v174, v177 op_sel_hi:[0,1]
    v_mfma_f32_32x32x16_f16 v[36:51], v[228:231], v[224:227], 0
    v_pk_mul_f16 v220, v132, v136 op_sel_hi:[0,1]
    v_pk_mul_f16 v221, v132, v137 op_sel_hi:[0,1]
    v_pk_mul_f16 v222, v132, v138 op_sel_hi:[0,1]
    v_pk_mul_f16 v223, v132, v139 op_sel_hi:[0,1]
    v_add_u32 v3, 160120, v1
    v_mfma_f32_32x32x16_f16 v[52:67], v[228:231], v[216:219], 0
    v_pk_mul_f16 v224, v146, v150 op_sel_hi:[0,1]
    v_pk_mul_f16 v225, v146, v151 op_sel_hi:[0,1]
    v_pk_mul_f16 v226, v146, v152 op_sel_hi:[0,1]
    v_pk_mul_f16 v227, v146, v153 op_sel_hi:[0,1]
    ds_add_u32 v3, v2
    v_mfma_f32_32x32x16_f16 v[4:19], v[232:235], v[220:223], v[4:19]
    ds_read_b128 v[228:231], v1 offset:4160
    v_pk_mul_f16 v216, v160, v164 op_sel_hi:[0,1]
    v_pk_mul_f16 v217, v160, v165 op_sel_hi:[0,1]
    v_pk_mul_f16 v218, v160, v166 op_sel_hi:[0,1]
    v_pk_mul_f16 v219, v160, v167 op_sel_hi:[0,1]
    v_mfma_f32_32x32x16_f16 v[20:35], v[232:235], v[224:227], v[20:35]
    v_pk_mul_f16 v220, v174, v178 op_sel_hi:[0,1]
    v_pk_mul_f16 v221, v174, v179 op_sel_hi:[0,1]
    v_pk_mul_f16 v222, v174, v180 op_sel_hi:[0,1]
    v_pk_mul_f16 v223, v174, v181 op_sel_hi:[0,1]
    v_mfma_f32_32x32x16_f16 v[36:51], v[232:235], v[216:219], v[36:51]
    v_pk_mul_f16 v224, v132, v140 op_sel_hi:[0,1]
    v_pk_mul_f16 v225, v132, v141 op_sel_hi:[0,1]
    v_pk_mul_f16 v226, v132, v142 op_sel_hi:[0,1]
    v_pk_mul_f16 v227, v132, v143 op_sel_hi:[0,1]
    v_mfma_f32_32x32x16_f16 v[52:67], v[232:235], v[220:223], v[52:67]
    v_pk_mul_f16 v216, v146, v154 op_sel_hi:[0,1]
    v_pk_mul_f16 v217, v146, v155 op_sel_hi:[0,1]
    v_pk_mul_f16 v218, v146, v156 op_sel_hi:[0,1]
    v_pk_mul_f16 v219, v146, v157 op_sel_hi:[0,1]
    s_waitcnt lgkmcnt(0)
    v_mfma_f32_32x32x16_f16 v[4:19], v[236:239], v[224:227], v[4:19]
    ds_read_b128 v[232:235], v1 offset:5200
    v_pk_mul_f16 v220, v160, v168 op_sel_hi:[0,1]
    v_pk_mul_f16 v221, v160, v169 op_sel_hi:[0,1]
    v_pk_mul_f16 v222, v160, v170 op_sel_hi:[0,1]
    v_pk_mul_f16 v223, v160, v171 op_sel_hi:[0,1]
    v_mov_b32 v3, 24432
    v_mfma_f32_32x32x16_f16 v[20:35], v[236:239], v[216:219], v[20:35]
    v_pk_mul_f16 v224, v174, v182 op_sel_hi:[0,1]
    v_pk_mul_f16 v225, v174, v183 op_sel_hi:[0,1]
    v_pk_mul_f16 v226, v174, v184 op_sel_hi:[0,1]
    v_pk_mul_f16 v227, v174, v185 op_sel_hi:[0,1]
    ds_read_b64 v[2:3], v3
    v_mfma_f32_32x32x16_f16 v[36:51], v[236:239], v[220:223], v[36:51]
    v_pk_mul_f16 v216, v132, v144 op_sel_hi:[0,1]
    v_pk_mul_f16 v217, v133, v133 op_sel_hi:[0,1]
    v_pk_mul_f16 v218, v133, v134 op_sel_hi:[0,1]
    v_pk_mul_f16 v219, v133, v135 op_sel_hi:[0,1]
    v_mfma_f32_32x32x16_f16 v[52:67], v[236:239], v[224:227], v[52:67]
    v_pk_mul_f16 v220, v146, v158 op_sel_hi:[0,1]
    v_pk_mul_f16 v221, v147, v147 op_sel_hi:[0,1]
    v_pk_mul_f16 v222, v147, v148 op_sel_hi:[0,1]
    v_pk_mul_f16 v223, v147, v149 op_sel_hi:[0,1]
    v_mfma_f32_32x32x16_f16 v[4:19], v[240:243], v[216:219], v[4:19]
    ds_read_b128 v[236:239], v1 offset:6240
    v_pk_mul_f16 v224, v160, v172 op_sel_hi:[0,1]
    v_pk_mul_f16 v225, v161, v161 op_sel_hi:[0,1]
    v_pk_mul_f16 v226, v161, v162 op_sel_hi:[0,1]
    v_pk_mul_f16 v227, v161, v163 op_sel_hi:[0,1]
    v_mfma_f32_32x32x16_f16 v[20:35], v[240:243], v[220:223], v[20:35]
    v_pk_mul_f16 v216, v174, v186 op_sel_hi:[0,1]
    v_pk_mul_f16 v217, v175, v175 op_sel_hi:[0,1]
    v_pk_mul_f16 v218, v175, v176 op_sel_hi:[0,1]
    v_pk_mul_f16 v219, v175, v177 op_sel_hi:[0,1]
    v_mfma_f32_32x32x16_f16 v[36:51], v[240:243], v[224:227], v[36:51]
    v_pk_mul_f16 v220, v133, v136 op_sel_hi:[0,1]
    v_pk_mul_f16 v221, v133, v137 op_sel_hi:[0,1]
    v_pk_mul_f16 v222, v133, v138 op_sel_hi:[0,1]
    v_pk_mul_f16 v223, v133, v139 op_sel_hi:[0,1]
    v_mfma_f32_32x32x16_f16 v[52:67], v[240:243], v[216:219], v[52:67]
    v_pk_mul_f16 v224, v147, v150 op_sel_hi:[0,1]
    v_pk_mul_f16 v225, v147, v151 op_sel_hi:[0,1]
    v_pk_mul_f16 v226, v147, v152 op_sel_hi:[0,1]
    v_pk_mul_f16 v227, v147, v153 op_sel_hi:[0,1]
    v_mfma_f32_32x32x16_f16 v[4:19], v[228:231], v[220:223], v[4:19]
    ds_read_b128 v[240:243], v1 offset:7280
    v_pk_mul_f16 v216, v161, v164 op_sel_hi:[0,1]
    v_pk_mul_f16 v217, v161, v165 op_sel_hi:[0,1]
    v_pk_mul_f16 v218, v161, v166 op_sel_hi:[0,1]
    v_pk_mul_f16 v219, v161, v167 op_sel_hi:[0,1]
    v_mfma_f32_32x32x16_f16 v[20:35], v[228:231], v[224:227], v[20:35]
    v_pk_mul_f16 v220, v175, v178 op_sel_hi:[0,1]
    v_pk_mul_f16 v221, v175, v179 op_sel_hi:[0,1]
    v_pk_mul_f16 v222, v175, v180 op_sel_hi:[0,1]
    v_pk_mul_f16 v223, v175, v181 op_sel_hi:[0,1]
    v_mfma_f32_32x32x16_f16 v[36:51], v[228:231], v[216:219], v[36:51]
    v_pk_mul_f16 v224, v133, v140 op_sel_hi:[0,1]
    v_pk_mul_f16 v225, v133, v141 op_sel_hi:[0,1]
    v_pk_mul_f16 v226, v133, v142 op_sel_hi:[0,1]
    v_pk_mul_f16 v227, v133, v143 op_sel_hi:[0,1]
    v_mfma_f32_32x32x16_f16 v[52:67], v[228:231], v[220:223], v[52:67]
    v_pk_mul_f16 v216, v147, v154 op_sel_hi:[0,1]
    v_pk_mul_f16 v217, v147, v155 op_sel_hi:[0,1]
    v_pk_mul_f16 v218, v147, v156 op_sel_hi:[0,1]
    v_pk_mul_f16 v219, v147, v157 op_sel_hi:[0,1]
    s_waitcnt lgkmcnt(0)
    v_mfma_f32_32x32x16_f16 v[4:19], v[232:235], v[224:227], v[4:19]
    ds_read_b128 v[228:231], v1 offset:8320
    v_pk_mul_f16 v220, v161, v168 op_sel_hi:[0,1]
    v_pk_mul_f16 v221, v161, v169 op_sel_hi:[0,1]
    v_pk_mul_f16 v222, v161, v170 op_sel_hi:[0,1]
    v_pk_mul_f16 v223, v161, v171 op_sel_hi:[0,1]
    v_readfirstlane_b32 s48, v2
    v_mfma_f32_32x32x16_f16 v[20:35], v[232:235], v[216:219], v[20:35]
    v_pk_mul_f16 v224, v175, v182 op_sel_hi:[0,1]
    v_pk_mul_f16 v225, v175, v183 op_sel_hi:[0,1]
    v_pk_mul_f16 v226, v175, v184 op_sel_hi:[0,1]
    v_pk_mul_f16 v227, v175, v185 op_sel_hi:[0,1]
    v_mfma_f32_32x32x16_f16 v[36:51], v[232:235], v[220:223], v[36:51]
    v_pk_mul_f16 v216, v133, v144 op_sel_hi:[0,1]
    v_pk_mul_f16 v217, v134, v134 op_sel_hi:[0,1]
    v_pk_mul_f16 v218, v134, v135 op_sel_hi:[0,1]
    v_pk_mul_f16 v219, v134, v136 op_sel_hi:[0,1]
    v_mfma_f32_32x32x16_f16 v[52:67], v[232:235], v[224:227], v[52:67]
    v_pk_mul_f16 v220, v147, v158 op_sel_hi:[0,1]
    v_pk_mul_f16 v221, v148, v148 op_sel_hi:[0,1]
    v_pk_mul_f16 v222, v148, v149 op_sel_hi:[0,1]
    v_pk_mul_f16 v223, v148, v150 op_sel_hi:[0,1]
    v_mfma_f32_32x32x16_f16 v[4:19], v[236:239], v[216:219], v[4:19]
    ds_read_b128 v[232:235], v1 offset:9360
    v_pk_mul_f16 v224, v161, v172 op_sel_hi:[0,1]
    v_pk_mul_f16 v225, v162, v162 op_sel_hi:[0,1]
    v_pk_mul_f16 v226, v162, v163 op_sel_hi:[0,1]
    v_pk_mul_f16 v227, v162, v164 op_sel_hi:[0,1]
    v_mfma_f32_32x32x16_f16 v[20:35], v[236:239], v[220:223], v[20:35]
    v_pk_mul_f16 v216, v175, v186 op_sel_hi:[0,1]
    v_pk_mul_f16 v217, v176, v176 op_sel_hi:[0,1]
    v_pk_mul_f16 v218, v176, v177 op_sel_hi:[0,1]
    v_pk_mul_f16 v219, v176, v178 op_sel_hi:[0,1]
    v_mfma_f32_32x32x16_f16 v[36:51], v[236:239], v[224:227], v[36:51]
    v_pk_mul_f16 v220, v134, v137 op_sel_hi:[0,1]
    v_pk_mul_f16 v221, v134, v138 op_sel_hi:[0,1]
    v_pk_mul_f16 v222, v134, v139 op_sel_hi:[0,1]
    v_pk_mul_f16 v223, v134, v140 op_sel_hi:[0,1]
    v_mfma_f32_32x32x16_f16 v[52:67], v[236:239], v[216:219], v[52:67]
    v_pk_mul_f16 v224, v148, v151 op_sel_hi:[0,1]
    v_pk_mul_f16 v225, v148, v152 op_sel_hi:[0,1]
    v_pk_mul_f16 v226, v148, v153 op_sel_hi:[0,1]
    v_pk_mul_f16 v227, v148, v154 op_sel_hi:[0,1]
    v_mfma_f32_32x32x16_f16 v[4:19], v[240:243], v[220:223], v[4:19]
    ds_read_b128 v[236:239], v1 offset:10400
    v_pk_mul_f16 v216, v162, v165 op_sel_hi:[0,1]
    v_pk_mul_f16 v217, v162, v166 op_sel_hi:[0,1]
    v_pk_mul_f16 v218, v162, v167 op_sel_hi:[0,1]
    v_pk_mul_f16 v219, v162, v168 op_sel_hi:[0,1]
    v_mfma_f32_32x32x16_f16 v[20:35], v[240:243], v[224:227], v[20:35]
    v_pk_mul_f16 v220, v176, v179 op_sel_hi:[0,1]
    v_pk_mul_f16 v221, v176, v180 op_sel_hi:[0,1]
    v_pk_mul_f16 v222, v176, v181 op_sel_hi:[0,1]
    v_pk_mul_f16 v223, v176, v182 op_sel_hi:[0,1]
    v_mfma_f32_32x32x16_f16 v[36:51], v[240:243], v[216:219], v[36:51]
    v_pk_mul_f16 v224, v134, v141 op_sel_hi:[0,1]
    v_pk_mul_f16 v225, v134, v142 op_sel_hi:[0,1]
    v_pk_mul_f16 v226, v134, v143 op_sel_hi:[0,1]
    v_pk_mul_f16 v227, v134, v144 op_sel_hi:[0,1]
    v_mfma_f32_32x32x16_f16 v[52:67], v[240:243], v[220:223], v[52:67]
    v_pk_mul_f16 v216, v148, v155 op_sel_hi:[0,1]
    v_pk_mul_f16 v217, v148, v156 op_sel_hi:[0,1]
    v_pk_mul_f16 v218, v148, v157 op_sel_hi:[0,1]
    v_pk_mul_f16 v219, v148, v158 op_sel_hi:[0,1]
    s_waitcnt lgkmcnt(0)
    v_mfma_f32_32x32x16_f16 v[4:19], v[228:231], v[224:227], v[4:19]
    ds_read_b128 v[240:243], v1 offset:11440
    v_pk_mul_f16 v220, v162, v169 op_sel_hi:[0,1]
    v_pk_mul_f16 v221, v162, v170 op_sel_hi:[0,1]
    v_pk_mul_f16 v222, v162, v171 op_sel_hi:[0,1]
    v_pk_mul_f16 v223, v162, v172 op_sel_hi:[0,1]
    s_setprio 2
    v_mfma_f32_32x32x16_f16 v[20:35], v[228:231], v[216:219], v[20:35]
    v_pk_mul_f16 v224, v176, v183 op_sel_hi:[0,1]
    v_pk_mul_f16 v225, v176, v184 op_sel_hi:[0,1]
    v_pk_mul_f16 v226, v176, v185 op_sel_hi:[0,1]
    v_pk_mul_f16 v227, v176, v186 op_sel_hi:[0,1]
    v_mfma_f32_32x32x16_f16 v[36:51], v[228:231], v[220:223], v[36:51]
    v_pk_mul_f16 v216, v135, v135 op_sel_hi:[0,1]
    v_pk_mul_f16 v217, v135, v136 op_sel_hi:[0,1]
    v_pk_mul_f16 v218, v135, v137 op_sel_hi:[0,1]
    v_pk_mul_f16 v219, v135, v138 op_sel_hi:[0,1]
    v_mfma_f32_32x32x16_f16 v[52:67], v[228:231], v[224:227], v[52:67]
    v_pk_mul_f16 v220, v149, v149 op_sel_hi:[0,1]
    v_pk_mul_f16 v221, v149, v150 op_sel_hi:[0,1]
    v_pk_mul_f16 v222, v149, v151 op_sel_hi:[0,1]
    v_pk_mul_f16 v223, v149, v152 op_sel_hi:[0,1]
    v_mfma_f32_32x32x16_f16 v[4:19], v[232:235], v[216:219], v[4:19]
    ds_read_b128 v[228:231], v1 offset:12480
    v_pk_mul_f16 v224, v163, v163 op_sel_hi:[0,1]
    v_pk_mul_f16 v225, v163, v164 op_sel_hi:[0,1]
    v_pk_mul_f16 v226, v163, v165 op_sel_hi:[0,1]
    v_pk_mul_f16 v227, v163, v166 op_sel_hi:[0,1]
    v_mfma_f32_32x32x16_f16 v[20:35], v[232:235], v[220:223], v[20:35]
    v_pk_mul_f16 v216, v177, v177 op_sel_hi:[0,1]
    v_pk_mul_f16 v217, v177, v178 op_sel_hi:[0,1]
    v_pk_mul_f16 v218, v177, v179 op_sel_hi:[0,1]
    v_pk_mul_f16 v219, v177, v180 op_sel_hi:[0,1]
    v_mfma_f32_32x32x16_f16 v[36:51], v[232:235], v[224:227], v[36:51]
    v_pk_mul_f16 v220, v135, v139 op_sel_hi:[0,1]
    v_pk_mul_f16 v221, v135, v140 op_sel_hi:[0,1]
    v_pk_mul_f16 v222, v135, v141 op_sel_hi:[0,1]
    v_pk_mul_f16 v223, v135, v142 op_sel_hi:[0,1]
    v_mfma_f32_32x32x16_f16 v[52:67], v[232:235], v[216:219], v[52:67]
    v_pk_mul_f16 v224, v149, v153 op_sel_hi:[0,1]
    v_pk_mul_f16 v225, v149, v154 op_sel_hi:[0,1]
    v_pk_mul_f16 v226, v149, v155 op_sel_hi:[0,1]
    v_pk_mul_f16 v227, v149, v156 op_sel_hi:[0,1]
    v_mfma_f32_32x32x16_f16 v[4:19], v[236:239], v[220:223], v[4:19]
    ds_read_b128 v[232:235], v1 offset:13520
    v_pk_mul_f16 v216, v163, v167 op_sel_hi:[0,1]
    v_pk_mul_f16 v217, v163, v168 op_sel_hi:[0,1]
    v_pk_mul_f16 v218, v163, v169 op_sel_hi:[0,1]
    v_pk_mul_f16 v219, v163, v170 op_sel_hi:[0,1]
    v_mfma_f32_32x32x16_f16 v[20:35], v[236:239], v[224:227], v[20:35]
    v_pk_mul_f16 v220, v177, v181 op_sel_hi:[0,1]
    v_pk_mul_f16 v221, v177, v182 op_sel_hi:[0,1]
    v_pk_mul_f16 v222, v177, v183 op_sel_hi:[0,1]
    v_pk_mul_f16 v223, v177, v184 op_sel_hi:[0,1]
    v_mfma_f32_32x32x16_f16 v[36:51], v[236:239], v[216:219], v[36:51]
    v_pk_mul_f16 v224, v135, v143 op_sel_hi:[0,1]
    v_pk_mul_f16 v225, v135, v144 op_sel_hi:[0,1]
    v_pk_mul_f16 v226, v136, v136 op_sel_hi:[0,1]
    v_pk_mul_f16 v227, v136, v137 op_sel_hi:[0,1]
    v_mfma_f32_32x32x16_f16 v[52:67], v[236:239], v[220:223], v[52:67]
    v_pk_mul_f16 v216, v149, v157 op_sel_hi:[0,1]
    v_pk_mul_f16 v217, v149, v158 op_sel_hi:[0,1]
    v_pk_mul_f16 v218, v150, v150 op_sel_hi:[0,1]
    v_pk_mul_f16 v219, v150, v151 op_sel_hi:[0,1]
    s_waitcnt lgkmcnt(0)
    v_mfma_f32_32x32x16_f16 v[4:19], v[240:243], v[224:227], v[4:19]
    ds_read_b128 v[236:239], v1 offset:14560
    v_pk_mul_f16 v220, v163, v171 op_sel_hi:[0,1]
    v_pk_mul_f16 v221, v163, v172 op_sel_hi:[0,1]
    v_pk_mul_f16 v222, v164, v164 op_sel_hi:[0,1]
    v_pk_mul_f16 v223, v164, v165 op_sel_hi:[0,1]
    v_mfma_f32_32x32x16_f16 v[20:35], v[240:243], v[216:219], v[20:35]
    v_pk_mul_f16 v224, v177, v185 op_sel_hi:[0,1]
    v_pk_mul_f16 v225, v177, v186 op_sel_hi:[0,1]
    v_pk_mul_f16 v226, v178, v178 op_sel_hi:[0,1]
    v_pk_mul_f16 v227, v178, v179 op_sel_hi:[0,1]
    v_mfma_f32_32x32x16_f16 v[36:51], v[240:243], v[220:223], v[36:51]
    v_pk_mul_f16 v216, v136, v138 op_sel_hi:[0,1]
    v_pk_mul_f16 v217, v136, v139 op_sel_hi:[0,1]
    v_pk_mul_f16 v218, v136, v140 op_sel_hi:[0,1]
    v_pk_mul_f16 v219, v136, v141 op_sel_hi:[0,1]
    v_mfma_f32_32x32x16_f16 v[52:67], v[240:243], v[224:227], v[52:67]
    v_pk_mul_f16 v220, v150, v152 op_sel_hi:[0,1]
    v_pk_mul_f16 v221, v150, v153 op_sel_hi:[0,1]
    v_pk_mul_f16 v222, v150, v154 op_sel_hi:[0,1]
    v_pk_mul_f16 v223, v150, v155 op_sel_hi:[0,1]
    v_mfma_f32_32x32x16_f16 v[4:19], v[228:231], v[216:219], v[4:19]
    ds_read_b128 v[240:243], v1 offset:15600
    v_pk_mul_f16 v224, v164, v166 op_sel_hi:[0,1]
    v_pk_mul_f16 v225, v164, v167 op_sel_hi:[0,1]
    v_pk_mul_f16 v226, v164, v168 op_sel_hi:[0,1]
    v_pk_mul_f16 v227, v164, v169 op_sel_hi:[0,1]
    v_mfma_f32_32x32x16_f16 v[20:35], v[228:231], v[220:223], v[20:35]
    v_pk_mul_f16 v216, v178, v180 op_sel_hi:[0,1]
    v_pk_mul_f16 v217, v178, v181 op_sel_hi:[0,1]
    v_pk_mul_f16 v218, v178, v182 op_sel_hi:[0,1]
    v_pk_mul_f16 v219, v178, v183 op_sel_hi:[0,1]
    v_mfma_f32_32x32x16_f16 v[36:51], v[228:231], v[224:227], v[36:51]
    v_pk_mul_f16 v220, v136, v142 op_sel_hi:[0,1]
    v_pk_mul_f16 v221, v136, v143 op_sel_hi:[0,1]
    v_pk_mul_f16 v222, v136, v144 op_sel_hi:[0,1]
    v_pk_mul_f16 v223, v137, v137 op_sel_hi:[0,1]
    v_mfma_f32_32x32x16_f16 v[52:67], v[228:231], v[216:219], v[52:67]
    v_pk_mul_f16 v224, v150, v156 op_sel_hi:[0,1]
    v_pk_mul_f16 v225, v150, v157 op_sel_hi:[0,1]
    v_pk_mul_f16 v226, v150, v158 op_sel_hi:[0,1]
    v_pk_mul_f16 v227, v151, v151 op_sel_hi:[0,1]
    v_mfma_f32_32x32x16_f16 v[4:19], v[232:235], v[220:223], v[4:19]
    ds_read_b128 v[228:231], v1 offset:16640
    v_pk_mul_f16 v216, v164, v170 op_sel_hi:[0,1]
    v_pk_mul_f16 v217, v164, v171 op_sel_hi:[0,1]
    v_pk_mul_f16 v218, v164, v172 op_sel_hi:[0,1]
    v_pk_mul_f16 v219, v165, v165 op_sel_hi:[0,1]
    v_mfma_f32_32x32x16_f16 v[20:35], v[232:235], v[224:227], v[20:35]
    v_pk_mul_f16 v220, v178, v184 op_sel_hi:[0,1]
    v_pk_mul_f16 v221, v178, v185 op_sel_hi:[0,1]
    v_pk_mul_f16 v222, v178, v186 op_sel_hi:[0,1]
    v_pk_mul_f16 v223, v179, v179 op_sel_hi:[0,1]
    v_mfma_f32_32x32x16_f16 v[36:51], v[232:235], v[216:219], v[36:51]
    v_pk_mul_f16 v224, v137, v138 op_sel_hi:[0,1]
    v_pk_mul_f16 v225, v137, v139 op_sel_hi:[0,1]
    v_pk_mul_f16 v226, v137, v140 op_sel_hi:[0,1]
    v_pk_mul_f16 v227, v137, v141 op_sel_hi:[0,1]
    v_mfma_f32_32x32x16_f16 v[52:67], v[232:235], v[220:223], v[52:67]
    v_pk_mul_f16 v216, v151, v152 op_sel_hi:[0,1]
    v_pk_mul_f16 v217, v151, v153 op_sel_hi:[0,1]
    v_pk_mul_f16 v218, v151, v154 op_sel_hi:[0,1]
    v_pk_mul_f16 v219, v151, v155 op_sel_hi:[0,1]
    s_waitcnt lgkmcnt(0)
    v_mfma_f32_32x32x16_f16 v[4:19], v[236:239], v[224:227], v[4:19]
    ds_read_b128 v[232:235], v1 offset:17680
    v_pk_mul_f16 v220, v165, v166 op_sel_hi:[0,1]
    v_pk_mul_f16 v221, v165, v167 op_sel_hi:[0,1]
    v_pk_mul_f16 v222, v165, v168 op_sel_hi:[0,1]
    v_pk_mul_f16 v223, v165, v169 op_sel_hi:[0,1]
    v_mov_b32 v3, 160088
    v_mfma_f32_32x32x16_f16 v[20:35], v[236:239], v[216:219], v[20:35]
    v_pk_mul_f16 v224, v179, v180 op_sel_hi:[0,1]
    v_pk_mul_f16 v225, v179, v181 op_sel_hi:[0,1]
    v_pk_mul_f16 v226, v179, v182 op_sel_hi:[0,1]
    v_pk_mul_f16 v227, v179, v183 op_sel_hi:[0,1]
    ds_read_b32 v2, v3
    v_mfma_f32_32x32x16_f16 v[36:51], v[236:239], v[220:223], v[36:51]
    v_pk_mul_f16 v216, v137, v142 op_sel_hi:[0,1]
    v_pk_mul_f16 v217, v137, v143 op_sel_hi:[0,1]
    v_pk_mul_f16 v218, v137, v144 op_sel_hi:[0,1]
    v_pk_mul_f16 v219, v138, v138 op_sel_hi:[0,1]
    v_mfma_f32_32x32x16_f16 v[52:67], v[236:239], v[224:227], v[52:67]
    v_pk_mul_f16 v220, v151, v156 op_sel_hi:[0,1]
    v_pk_mul_f16 v221, v151, v157 op_sel_hi:[0,1]
    v_pk_mul_f16 v222, v151, v158 op_sel_hi:[0,1]
    v_pk_mul_f16 v223, v152, v152 op_sel_hi:[0,1]
    v_mfma_f32_32x32x16_f16 v[4:19], v[240:243], v[216:219], v[4:19]
    ds_read_b128 v[236:239], v1 offset:18720
    v_pk_mul_f16 v224, v165, v170 op_sel_hi:[0,1]
    v_pk_mul_f16 v225, v165, v171 op_sel_hi:[0,1]
    v_pk_mul_f16 v226, v165, v172 op_sel_hi:[0,1]
    v_pk_mul_f16 v227, v166, v166 op_sel_hi:[0,1]
    v_mfma_f32_32x32x16_f16 v[20:35], v[240:243], v[220:223], v[20:35]
    v_pk_mul_f16 v216, v179, v184 op_sel_hi:[0,1]
    v_pk_mul_f16 v217, v179, v185 op_sel_hi:[0,1]
    v_pk_mul_f16 v218, v179, v186 op_sel_hi:[0,1]
    v_pk_mul_f16 v219, v180, v180 op_sel_hi:[0,1]
    v_mfma_f32_32x32x16_f16 v[36:51], v[240:243], v[224:227], v[36:51]
    v_pk_mul_f16 v220, v138, v139 op_sel_hi:[0,1]
    v_pk_mul_f16 v221, v138, v140 op_sel_hi:[0,1]
    v_pk_mul_f16 v222, v138, v141 op_sel_hi:[0,1]
    v_pk_mul_f16 v223, v138, v142 op_sel_hi:[0,1]
    v_mfma_f32_32x32x16_f16 v[52:67], v[240:243], v[216:219], v[52:67]
    v_pk_mul_f16 v224, v152, v153 op_sel_hi:[0,1]
    v_pk_mul_f16 v225, v152, v154 op_sel_hi:[0,1]
    v_pk_mul_f16 v226, v152, v155 op_sel_hi:[0,1]
    v_pk_mul_f16 v227, v152, v156 op_sel_hi:[0,1]
    v_mfma_f32_32x32x16_f16 v[4:19], v[228:231], v[220:223], v[4:19]
    ds_read_b128 v[240:243], v1 offset:19760
    v_pk_mul_f16 v216, v166, v167 op_sel_hi:[0,1]
    v_pk_mul_f16 v217, v166, v168 op_sel_hi:[0,1]
    v_pk_mul_f16 v218, v166, v169 op_sel_hi:[0,1]
    v_pk_mul_f16 v219, v166, v170 op_sel_hi:[0,1]
    v_mfma_f32_32x32x16_f16 v[20:35], v[228:231], v[224:227], v[20:35]
    v_pk_mul_f16 v220, v180, v181 op_sel_hi:[0,1]
    v_pk_mul_f16 v221, v180, v182 op_sel_hi:[0,1]
    v_pk_mul_f16 v222, v180, v183 op_sel_hi:[0,1]
    v_pk_mul_f16 v223, v180, v184 op_sel_hi:[0,1]
    v_mfma_f32_32x32x16_f16 v[36:51], v[228:231], v[216:219], v[36:51]
    v_pk_mul_f16 v224, v138, v143 op_sel_hi:[0,1]
    v_pk_mul_f16 v225, v138, v144 op_sel_hi:[0,1]
    v_pk_mul_f16 v226, v139, v139 op_sel_hi:[0,1]
    v_pk_mul_f16 v227, v139, v140 op_sel_hi:[0,1]
    v_mfma_f32_32x32x16_f16 v[52:67], v[228:231], v[220:223], v[52:67]
    v_pk_mul_f16 v216, v152, v157 op_sel_hi:[0,1]
    v_pk_mul_f16 v217, v152, v158 op_sel_hi:[0,1]
    v_pk_mul_f16 v218, v153, v153 op_sel_hi:[0,1]
    v_pk_mul_f16 v219, v153, v154 op_sel_hi:[0,1]
    s_waitcnt lgkmcnt(0)
    v_mfma_f32_32x32x16_f16 v[4:19], v[232:235], v[224:227], v[4:19]
    ds_read_b128 v[228:231], v1 offset:20800
    v_pk_mul_f16 v220, v166, v171 op_sel_hi:[0,1]
    v_pk_mul_f16 v221, v166, v172 op_sel_hi:[0,1]
    v_pk_mul_f16 v222, v167, v167 op_sel_hi:[0,1]
    v_pk_mul_f16 v223, v167, v168 op_sel_hi:[0,1]
    v_readfirstlane_b32 s74, v2
    v_mfma_f32_32x32x16_f16 v[20:35], v[232:235], v[216:219], v[20:35]
    v_pk_mul_f16 v224, v180, v185 op_sel_hi:[0,1]
    v_pk_mul_f16 v225, v180, v186 op_sel_hi:[0,1]
    v_pk_mul_f16 v226, v181, v181 op_sel_hi:[0,1]
    v_pk_mul_f16 v227, v181, v182 op_sel_hi:[0,1]
    s_cmp_lt_u32 s74, 4
    s_cbranch_scc1 L_cs_6
L_cb_7:
    v_mfma_f32_32x32x16_f16 v[36:51], v[232:235], v[220:223], v[36:51]
    v_pk_mul_f16 v216, v139, v141 op_sel_hi:[0,1]
    v_pk_mul_f16 v217, v139, v142 op_sel_hi:[0,1]
    v_pk_mul_f16 v218, v139, v143 op_sel_hi:[0,1]
    v_pk_mul_f16 v219, v139, v144 op_sel_hi:[0,1]
    v_mfma_f32_32x32x16_f16 v[52:67], v[232:235], v[224:227], v[52:67]
    v_pk_mul_f16 v220, v153, v155 op_sel_hi:[0,1]
    v_pk_mul_f16 v221, v153, v156 op_sel_hi:[0,1]
    v_pk_mul_f16 v222, v153, v157 op_sel_hi:[0,1]
    v_pk_mul_f16 v223, v153, v158 op_sel_hi:[0,1]
    v_mfma_f32_32x32x16_f16 v[4:19], v[236:239], v[216:219], v[4:19]
    ds_read_b128 v[232:235], v1 offset:21840
    v_pk_mul_f16 v224, v167, v169 op_sel_hi:[0,1]
    v_pk_mul_f16 v225, v167, v170 op_sel_hi:[0,1]
    v_pk_mul_f16 v226, v167, v171 op_sel_hi:[0,1]
    v_pk_mul_f16 v227, v167, v172 op_sel_hi:[0,1]
    v_mfma_f32_32x32x16_f16 v[20:35], v[236:239], v[220:223], v[20:35]
    v_pk_mul_f16 v216, v181, v183 op_sel_hi:[0,1]
    v_pk_mul_f16 v217, v181, v184 op_sel_hi:[0,1]
    v_pk_mul_f16 v218, v181, v185 op_sel_hi:[0,1]
    v_pk_mul_f16 v219, v181, v186 op_sel_hi:[0,1]
    v_mfma_f32_32x32x16_f16 v[36:51], v[236:239], v[224:227], v[36:51]
    v_pk_mul_f16 v220, v140, v140 op_sel_hi:[0,1]
    v_pk_mul_f16 v221, v140, v141 op_sel_hi:[0,1]
    v_pk_mul_f16 v222, v140, v142 op_sel_hi:[0,1]
    v_pk_mul_f16 v223, v140, v143 op_sel_hi:[0,1]
    v_mfma_f32_32x32x16_f16 v[52:67], v[236:239], v[216:219], v[52:67]
    v_pk_mul_f16 v224, v154, v154 op_sel_hi:[0,1]
    v_pk_mul_f16 v225, v154, v155 op_sel_hi:[0,1]
    v_pk_mul_f16 v226, v154, v156 op_sel_hi:[0,1]
    v_pk_mul_f16 v227, v154, v157 op_sel_hi:[0,1]
    v_mfma_f32_32x32x16_f16 v[4:19], v[240:243], v[220:223], v[4:19]
    ds_read_b128 v[236:239], v1 offset:22880
    v_pk_mul_f16 v216, v168, v168 op_sel_hi:[0,1]
    v_pk_mul_f16 v217, v168, v169 op_sel_hi:[0,1]
    v_pk_mul_f16 v218, v168, v170 op_sel_hi:[0,1]
    v_pk_mul_f16 v219, v168, v171 op_sel_hi:[0,1]
    v_mfma_f32_32x32x16_f16 v[20:35], v[240:243], v[224:227], v[20:35]
    v_pk_mul_f16 v220, v182, v182 op_sel_hi:[0,1]
    v_pk_mul_f16 v221, v182, v183 op_sel_hi:[0,1]
    v_pk_mul_f16 v222, v182, v184 op_sel_hi:[0,1]
    v_pk_mul_f16 v223, v182, v185 op_sel_hi:[0,1]
    v_mfma_f32_32x32x16_f16 v[36:51], v[240:243], v[216:219], v[36:51]
    v_pk_mul_f16 v224, v140, v144 op_sel_hi:[0,1]
    v_pk_mul_f16 v225, v141, v141 op_sel_hi:[0,1]
    v_pk_mul_f16 v226, v141, v142 op_sel_hi:[0,1]
    v_pk_mul_f16 v227, v141, v143 op_sel_hi:[0,1]
    v_mfma_f32_32x32x16_f16 v[52:67], v[240:243], v[220:223], v[52:67]
    v_pk_mul_f16 v216, v154, v158 op_sel_hi:[0,1]
    v_pk_mul_f16 v217, v155, v155 op_sel_hi:[0,1]
    v_pk_mul_f16 v218, v155, v156 op_sel_hi:[0,1]
    v_pk_mul_f16 v219, v155, v157 op_sel_hi:[0,1]
    s_waitcnt lgkmcnt(0)
    v_mfma_f32_32x32x16_f16 v[4:19], v[228:231], v[224:227], v[4:19]
    ds_read_b128 v[240:243], v1 offset:45056
    v_pk_mul_f16 v220, v168, v172 op_sel_hi:[0,1]
    v_pk_mul_f16 v221, v169, v169 op_sel_hi:[0,1]
    v_pk_mul_f16 v222, v169, v170 op_sel_hi:[0,1]
    v_pk_mul_f16 v223, v169, v171 op_sel_hi:[0,1]
    v_mfma_f32_32x32x16_f16 v[20:35], v[228:231], v[216:219], v[20:35]
    v_pk_mul_f16 v224, v182, v186 op_sel_hi:[0,1]
    v_pk_mul_f16 v225, v183, v183 op_sel_hi:[0,1]
    v_pk_mul_f16 v226, v183, v184 op_sel_hi:[0,1]
    v_pk_mul_f16 v227, v183, v185 op_sel_hi:[0,1]
    v_mfma_f32_32x32x16_f16 v[36:51], v[228:231], v[220:223], v[36:51]
    v_pk_mul_f16 v216, v141, v144 op_sel_hi:[0,1]
    v_pk_mul_f16 v217, v142, v142 op_sel_hi:[0,1]
    v_pk_mul_f16 v218, v142, v143 op_sel_hi:[0,1]
    v_pk_mul_f16 v219, v142, v144 op_sel_hi:[0,1]
    v_mfma_f32_32x32x16_f16 v[52:67], v[228:231], v[224:227], v[52:67]
    v_pk_mul_f16 v220, v143, v143 op_sel_hi:[0,1]
    v_pk_mul_f16 v221, v143, v144 op_sel_hi:[0,1]
    v_pk_mul_f16 v222, v144, v144 op_sel_hi:[0,1]
    v_mfma_f32_32x32x16_f16 v[4:19], v[232:235], v[216:219], v[4:19]
    ds_read_b128 v[228:231], v1 offset:46096
    v_pk_mul_f16 v224, v155, v158 op_sel_hi:[0,1]
    v_pk_mul_f16 v225, v156, v156 op_sel_hi:[0,1]
    v_pk_mul_f16 v226, v156, v157 op_sel_hi:[0,1]
    v_pk_mul_f16 v227, v156, v158 op_sel_hi:[0,1]
    v_mov_b32 v2, 1
    v_mfma_f32_32x32x16_f16 v[4:19], v[236:239], v[220:223], v[4:19]
    v_pk_mul_f16 v216, v157, v157 op_sel_hi:[0,1]
    v_pk_mul_f16 v217, v157, v158 op_sel_hi:[0,1]
    v_pk_mul_f16 v218, v158, v158 op_sel_hi:[0,1]
    v_add_u32 v3, 160112, v1
    ds_add_u32 v3, v2
    v_mfma_f32_32x32x16_f16 v[20:35], v[232:235], v[224:227], v[20:35]
    v_pk_mul_f16 v220, v169, v172 op_sel_hi:[0,1]
    v_pk_mul_f16 v221, v170, v170 op_sel_hi:[0,1]
    v_pk_mul_f16 v222, v170, v171 op_sel_hi:[0,1]
    v_pk_mul_f16 v223, v170, v172 op_sel_hi:[0,1]
    v_mfma_f32_32x32x16_f16 v[20:35], v[236:239], v[216:219], v[20:35]
    s_nop 0
    v_max3_f32 v244, |v4|, |v5|, |v6|
    v_max3_f32 v252, |v7|, |v8|, |v9|
    v_max3_f32 v244, v244, |v10|, |v11|
    v_max3_f32 v252, v252, |v12|, |v13|
    v_max3_f32 v244, v244, |v14|, |v15|
    v_pk_mul_f16 v224, v171, v171 op_sel_hi:[0,1]
    v_pk_mul_f16 v225, v171, v172 op_sel_hi:[0,1]
    v_pk_mul_f16 v226, v172, v172 op_sel_hi:[0,1]
    v_mfma_f32_32x32x16_f16 v[36:51], v[232:235], v[220:223], v[36:51]
    v_max3_f32 v244, v244, v252, |v16|
    v_mov_b32 v252, v244
    v_cvt_pk_f16_f32 v188, v4, v5
    v_cvt_pk_f16_f32 v189, v6, v7
    v_permlane32_swap_b32 v244, v252
    v_pk_mul_f16 v216, v183, v186 op_sel_hi:[0,1]
    v_pk_mul_f16 v217, v184, v184 op_sel_hi:[0,1]
    v_pk_mul_f16 v218, v184, v185 op_sel_hi:[0,1]
    v_pk_mul_f16 v219, v184, v186 op_sel_hi:[0,1]
    v_mfma_f32_32x32x16_f16 v[36:51], v[236:239], v[224:227], v[36:51]
    v_max3_f32 v244, v244, v252, s81
    v_lshrrev_b32 v145, 23, v244
    v_sub_u32 v244, s80, v145
    v_lshlrev_b32 v244, 10, v244
    v_pk_mul_f16 v188, v188, v244 op_sel_hi:[1,0]
    v_pk_mul_f16 v220, v185, v185 op_sel_hi:[0,1]
    v_pk_mul_f16 v221, v185, v186 op_sel_hi:[0,1]
    v_pk_mul_f16 v222, v186, v186 op_sel_hi:[0,1]
    v_mfma_f32_32x32x16_f16 v[52:67], v[232:235], v[216:219], v[52:67]
    v_max3_f32 v245, |v20|, |v21|, |v22|
    v_max3_f32 v253, |v23|, |v24|, |v25|
    v_max3_f32 v245, v245, |v26|, |v27|
    v_max3_f32 v253, v253, |v28|, |v29|
    v_max3_f32 v245, v245, |v30|, |v31|
    v_pk_mul_f16 v224, v188, v132 op_sel_hi:[0,1]
    v_pk_mul_f16 v225, v188, v133 op_sel_hi:[0,1]
    v_pk_mul_f16 v226, v188, v134 op_sel_hi:[0,1]
    v_pk_mul_f16 v227, v188, v135 op_sel_hi:[0,1]
    v_mfma_f32_32x32x16_f16 v[52:67], v[236:239], v[220:223], v[52:67]
    ds_read_b128 v[232:235], v1 offset:47136
    v_max3_f32 v245, v245, v253, |v32|
    v_mov_b32 v253, v245
    v_cvt_pk_f16_f32 v195, v20, v21
    v_cvt_pk_f16_f32 v196, v22, v23
    v_permlane32_swap_b32 v245, v253
    v_pk_mul_f16 v216, v188, v136 op_sel_hi:[0,1]
    v_pk_mul_f16 v217, v188, v137 op_sel_hi:[0,1]
    v_pk_mul_f16 v218, v188, v138 op_sel_hi:[0,1]
    v_pk_mul_f16 v219, v188, v139 op_sel_hi:[0,1]
    s_waitcnt lgkmcnt(1)
    v_mfma_f32_32x32x16_f16 v[68:83], v[240:243], v[224:227], 0
    ds_read_b128 v[236:239], v1 offset:48176
    v_max3_f32 v245, v245, v253, s81
    v_lshrrev_b32 v159, 23, v245
    v_sub_u32 v245, s80, v159
    v_lshlrev_b32 v245, 10, v245
    v_pk_mul_f16 v195, v195, v245 op_sel_hi:[1,0]
    v_pk_mul_f16 v220, v195, v146 op_sel_hi:[0,1]
    v_pk_mul_f16 v221, v195, v147 op_sel_hi:[0,1]
    v_pk_mul_f16 v222, v195, v148 op_sel_hi:[0,1]
    v_pk_mul_f16 v223, v195, v149 op_sel_hi:[0,1]
    v_mfma_f32_32x32x16_f16 v[68:83], v[228:231], v[216:219], v[68:83]
    v_max3_f32 v246, |v36|, |v37|, |v38|
    v_max3_f32 v254, |v39|, |v40|, |v41|
    v_max3_f32 v246, v246, |v42|, |v43|
    v_max3_f32 v254, v254, |v44|, |v45|
    v_max3_f32 v246, v246, |v46|, |v47|
    v_pk_mul_f16 v224, v195, v150 op_sel_hi:[0,1]
    v_pk_mul_f16 v225, v195, v151 op_sel_hi:[0,1]
    v_pk_mul_f16 v226, v195, v152 op_sel_hi:[0,1]
    v_pk_mul_f16 v227, v195, v153 op_sel_hi:[0,1]
    v_mfma_f32_32x32x16_f16 v[84:99], v[240:243], v[220:223], 0
    v_max3_f32 v246, v246, v254, |v48|
    v_mov_b32 v254, v246
    v_cvt_pk_f16_f32 v202, v36, v37
    v_cvt_pk_f16_f32 v203, v38, v39
    v_permlane32_swap_b32 v246, v254
    v_max3_f32 v246, v246, v254, s81
    v_lshrrev_b32 v173, 23, v246
    v_sub_u32 v246, s80, v173
    v_lshlrev_b32 v246, 10, v246
    v_pk_mul_f16 v202, v202, v246 op_sel_hi:[1,0]
    v_pk_mul_f16 v216, v202, v160 op_sel_hi:[0,1]
    v_pk_mul_f16 v217, v202, v161 op_sel_hi:[0,1]
    v_pk_mul_f16 v218, v202, v162 op_sel_hi:[0,1]
    v_pk_mul_f16 v219, v202, v163 op_sel_hi:[0,1]
    v_mfma_f32_32x32x16_f16 v[84:99], v[228:231], v[224:227], v[84:99]
    v_max3_f32 v247, |v52|, |v53|, |v54|
    v_max3_f32 v255, |v55|, |v56|, |v57|
    v_max3_f32 v247, v247, |v58|, |v59|
    v_max3_f32 v255, v255, |v60|, |v61|
    v_max3_f32 v247, v247, |v62|, |v63|
    v_pk_mul_f16 v220, v202, v164 op_sel_hi:[0,1]
    v_pk_mul_f16 v221, v202, v165 op_sel_hi:[0,1]
    v_pk_mul_f16 v222, v202, v166 op_sel_hi:[0,1]
    v_pk_mul_f16 v223, v202, v167 op_sel_hi:[0,1]
    v_mfma_f32_32x32x16_f16 v[100:115], v[240:243], v[216:219], 0
    v_max3_f32 v247, v247, v255, |v64|
    v_mov_b32 v255, v247
    v_cvt_pk_f16_f32 v209, v52, v53
    v_cvt_pk_f16_f32 v210, v54, v55
    v_permlane32_swap_b32 v247, v255
    v_max3_f32 v247, v247, v255, s81
    v_lshrrev_b32 v187, 23, v247
    v_sub_u32 v247, s80, v187
    v_lshlrev_b32 v247, 10, v247
    v_pk_mul_f16 v209, v209, v247 op_sel_hi:[1,0]
    v_pk_mul_f16 v224, v209, v174 op_sel_hi:[0,1]
    v_pk_mul_f16 v225, v209, v175 op_sel_hi:[0,1]
    v_pk_mul_f16 v226, v209, v176 op_sel_hi:[0,1]
    v_pk_mul_f16 v227, v209, v177 op_sel_hi:[0,1]
    v_mfma_f32_32x32x16_f16 v[100:115], v[228:231], v[220:223], v[100:115]
    v_pk_mul_f16 v216, v209, v178 op_sel_hi:[0,1]
    v_pk_mul_f16 v217, v209, v179 op_sel_hi:[0,1]
    v_pk_mul_f16 v218, v209, v180 op_sel_hi:[0,1]
    v_pk_mul_f16 v219, v209, v181 op_sel_hi:[0,1]
    v_mfma_f32_32x32x16_f16 v[116:131], v[240:243], v[224:227], 0
    v_pk_mul_f16 v220, v188, v140 op_sel_hi:[0,1]
    v_pk_mul_f16 v221, v188, v141 op_sel_hi:[0,1]
    v_pk_mul_f16 v222, v188, v142 op_sel_hi:[0,1]
    v_pk_mul_f16 v223, v188, v143 op_sel_hi:[0,1]
    v_mfma_f32_32x32x16_f16 v[116:131], v[228:231], v[216:219], v[116:131]
    ds_read_b128 v[240:243], v1 offset:49216
    v_pk_mul_f16 v224, v195, v154 op_sel_hi:[0,1]
    v_pk_mul_f16 v225, v195, v155 op_sel_hi:[0,1]
    v_pk_mul_f16 v226, v195, v156 op_sel_hi:[0,1]
    v_pk_mul_f16 v227, v195, v157 op_sel_hi:[0,1]
    s_waitcnt lgkmcnt(1)
    v_mfma_f32_32x32x16_f16 v[68:83], v[232:235], v[220:223], v[68:83]
    ds_read_b128 v[228:231], v1 offset:50256
    v_pk_mul_f16 v216, v202, v168 op_sel_hi:[0,1]
    v_pk_mul_f16 v217, v202, v169 op_sel_hi:[0,1]
    v_pk_mul_f16 v218, v202, v170 op_sel_hi:[0,1]
    v_pk_mul_f16 v219, v202, v171 op_sel_hi:[0,1]
    v_pk_mul_f16 v189, v189, v244 op_sel_hi:[1,0]
    v_mfma_f32_32x32x16_f16 v[84:99], v[232:235], v[224:227], v[84:99]
    v_pk_mul_f16 v220, v209, v182 op_sel_hi:[0,1]
    v_pk_mul_f16 v221, v209, v183 op_sel_hi:[0,1]
    v_pk_mul_f16 v222, v209, v184 op_sel_hi:[0,1]
    v_pk_mul_f16 v223, v209, v185 op_sel_hi:[0,1]
    v_pk_mul_f16 v196, v196, v245 op_sel_hi:[1,0]
    v_mfma_f32_32x32x16_f16 v[100:115], v[232:235], v[216:219], v[100:115]
    v_pk_mul_f16 v224, v188, v144 op_sel_hi:[0,1]
    v_pk_mul_f16 v225, v188, v132 op_sel:[1,0] op_sel_hi:[1,1]
    v_pk_mul_f16 v226, v188, v133 op_sel:[1,0] op_sel_hi:[1,1]
    v_pk_mul_f16 v227, v188, v134 op_sel:[1,0] op_sel_hi:[1,1]
    v_pk_mul_f16 v203, v203, v246 op_sel_hi:[1,0]
    v_mfma_f32_32x32x16_f16 v[116:131], v[232:235], v[220:223], v[116:131]
    v_pk_mul_f16 v216, v195, v158 op_sel_hi:[0,1]
    v_pk_mul_f16 v217, v195, v146 op_sel:[1,0] op_sel_hi:[1,1]
    v_pk_mul_f16 v218, v195, v147 op_sel:[1,0] op_sel_hi:[1,1]
    v_pk_mul_f16 v219, v195, v148 op_sel:[1,0] op_sel_hi:[1,1]
    v_mfma_f32_32x32x16_f16 v[68:83], v[236:239], v[224:227], v[68:83]
    ds_read_b128 v[232:235], v1 offset:51296
    v_pk_mul_f16 v220, v202, v172 op_sel_hi:[0,1]
    v_pk_mul_f16 v221, v202, v160 op_sel:[1,0] op_sel_hi:[1,1]
    v_pk_mul_f16 v222, v202, v161 op_sel:[1,0] op_sel_hi:[1,1]
    v_pk_mul_f16 v223, v202, v162 op_sel:[1,0] op_sel_hi:[1,1]
    v_pk_mul_f16 v210, v210, v247 op_sel_hi:[1,0]
    v_mfma_f32_32x32x16_f16 v[84:99], v[236:239], v[216:219], v[84:99]
    v_pk_mul_f16 v224, v209, v186 op_sel_hi:[0,1]
    v_pk_mul_f16 v225, v209, v174 op_sel:[1,0] op_sel_hi:[1,1]
    v_pk_mul_f16 v226, v209, v175 op_sel:[1,0] op_sel_hi:[1,1]
    v_pk_mul_f16 v227, v209, v176 op_sel:[1,0] op_sel_hi:[1,1]
    v_mfma_f32_32x32x16_f16 v[100:115], v[236:239], v[220:223], v[100:115]
    v_pk_mul_f16 v216, v188, v135 op_sel:[1,0] op_sel_hi:[1,1]
    v_pk_mul_f16 v217, v188, v136 op_sel:[1,0] op_sel_hi:[1,1]
    v_pk_mul_f16 v218, v188, v137 op_sel:[1,0] op_sel_hi:[1,1]
    v_pk_mul_f16 v219, v188, v138 op_sel:[1,0] op_sel_hi:[1,1]
    v_cvt_pk_f16_f32 v190, v8, v9
    v_mfma_f32_32x32x16_f16 v[116:131], v[236:239], v[224:227], v[116:131]
    v_pk_mul_f16 v220, v195, v149 op_sel:[1,0] op_sel_hi:[1,1]
    v_pk_mul_f16 v221, v195, v150 op_sel:[1,0] op_sel_hi:[1,1]
    v_pk_mul_f16 v222, v195, v151 op_sel:[1,0] op_sel_hi:[1,1]
    v_pk_mul_f16 v223, v195, v152 op_sel:[1,0] op_sel_hi:[1,1]
    s_waitcnt lgkmcnt(0)
    v_mfma_f32_32x32x16_f16 v[68:83], v[240:243], v[216:219], v[68:83]
    ds_read_b128 v[236:239], v1 offset:52336
    v_pk_mul_f16 v224, v202, v163 op_sel:[1,0] op_sel_hi:[1,1]
    v_pk_mul_f16 v225, v202, v164 op_sel:[1,0] op_sel_hi:[1,1]
    v_pk_mul_f16 v226, v202, v165 op_sel:[1,0] op_sel_hi:[1,1]
    v_pk_mul_f16 v227, v202, v166 op_sel:[1,0] op_sel_hi:[1,1]
    v_cvt_pk_f16_f32 v197, v24, v25
    v_mfma_f32_32x32x16_f16 v[84:99], v[240:243], v[220:223], v[84:99]
    v_pk_mul_f16 v216, v209, v177 op_sel:[1,0] op_sel_hi:[1,1]
    v_pk_mul_f16 v217, v209, v178 op_sel:[1,0] op_sel_hi:[1,1]
    v_pk_mul_f16 v218, v209, v179 op_sel:[1,0] op_sel_hi:[1,1]
    v_pk_mul_f16 v219, v209, v180 op_sel:[1,0] op_sel_hi:[1,1]
    v_mfma_f32_32x32x16_f16 v[100:115], v[240:243], v[224:227], v[100:115]
    v_pk_mul_f16 v220, v188, v139 op_sel:[1,0] op_sel_hi:[1,1]
    v_pk_mul_f16 v221, v188, v140 op_sel:[1,0] op_sel_hi:[1,1]
    v_pk_mul_f16 v222, v188, v141 op_sel:[1,0] op_sel_hi:[1,1]
    v_pk_mul_f16 v223, v188, v142 op_sel:[1,0] op_sel_hi:[1,1]
    v_cvt_pk_f16_f32 v204, v40, v41
    v_mfma_f32_32x32x16_f16 v[116:131], v[240:243], v[216:219], v[116:131]
    v_pk_mul_f16 v224, v195, v153 op_sel:[1,0] op_sel_hi:[1,1]
    v_pk_mul_f16 v225, v195, v154 op_sel:[1,0] op_sel_hi:[1,1]
    v_pk_mul_f16 v226, v195, v155 op_sel:[1,0] op_sel_hi:[1,1]
    v_pk_mul_f16 v227, v195, v156 op_sel:[1,0] op_sel_hi:[1,1]
    v_mfma_f32_32x32x16_f16 v[68:83], v[228:231], v[220:223], v[68:83]
    ds_read_b128 v[240:243], v1 offset:53376
    v_pk_mul_f16 v216, v202, v167 op_sel:[1,0] op_sel_hi:[1,1]
    v_pk_mul_f16 v217, v202, v168 op_sel:[1,0] op_sel_hi:[1,1]
    v_pk_mul_f16 v218, v202, v169 op_sel:[1,0] op_sel_hi:[1,1]
    v_pk_mul_f16 v219, v202, v170 op_sel:[1,0] op_sel_hi:[1,1]
    v_cvt_pk_f16_f32 v211, v56, v57
    v_mfma_f32_32x32x16_f16 v[84:99], v[228:231], v[224:227], v[84:99]
    v_pk_mul_f16 v220, v209, v181 op_sel:[1,0] op_sel_hi:[1,1]
    v_pk_mul_f16 v221, v209, v182 op_sel:[1,0] op_sel_hi:[1,1]
    v_pk_mul_f16 v222, v209, v183 op_sel:[1,0] op_sel_hi:[1,1]
    v_pk_mul_f16 v223, v209, v184 op_sel:[1,0] op_sel_hi:[1,1]
    v_mfma_f32_32x32x16_f16 v[100:115], v[228:231], v[216:219], v[100:115]
    v_pk_mul_f16 v224, v188, v143 op_sel:[1,0] op_sel_hi:[1,1]
    v_pk_mul_f16 v225, v188, v144 op_sel:[1,0] op_sel_hi:[1,1]
    v_pk_mul_f16 v226, v189, v132 op_sel_hi:[0,1]
    v_pk_mul_f16 v227, v189, v133 op_sel_hi:[0,1]
    v_pk_mul_f16 v190, v190, v244 op_sel_hi:[1,0]
    v_mfma_f32_32x32x16_f16 v[116:131], v[228:231], v[220:223], v[116:131]
    v_pk_mul_f16 v216, v195, v157 op_sel:[1,0] op_sel_hi:[1,1]
    v_pk_mul_f16 v217, v195, v158 op_sel:[1,0] op_sel_hi:[1,1]
    v_pk_mul_f16 v218, v196, v146 op_sel_hi:[0,1]
    v_pk_mul_f16 v219, v196, v147 op_sel_hi:[0,1]
    v_mfma_f32_32x32x16_f16 v[68:83], v[232:235], v[224:227], v[68:83]
    ds_read_b128 v[228:231], v1 offset:54416
    v_pk_mul_f16 v220, v202, v171 op_sel:[1,0] op_sel_hi:[1,1]
    v_pk_mul_f16 v221, v202, v172 op_sel:[1,0] op_sel_hi:[1,1]
    v_pk_mul_f16 v222, v203, v160 op_sel_hi:[0,1]
    v_pk_mul_f16 v223, v203, v161 op_sel_hi:[0,1]
    v_pk_mul_f16 v197, v197, v245 op_sel_hi:[1,0]
    v_mfma_f32_32x32x16_f16 v[84:99], v[232:235], v[216:219], v[84:99]
    v_pk_mul_f16 v224, v209, v185 op_sel:[1,0] op_sel_hi:[1,1]
    v_pk_mul_f16 v225, v209, v186 op_sel:[1,0] op_sel_hi:[1,1]
    v_pk_mul_f16 v226, v210, v174 op_sel_hi:[0,1]
    v_pk_mul_f16 v227, v210, v175 op_sel_hi:[0,1]
    v_mfma_f32_32x32x16_f16 v[100:115], v[232:235], v[220:223], v[100:115]
    v_pk_mul_f16 v216, v189, v134 op_sel_hi:[0,1]
    v_pk_mul_f16 v217, v189, v135 op_sel_hi:[0,1]
    v_pk_mul_f16 v218, v189, v136 op_sel_hi:[0,1]
    v_pk_mul_f16 v219, v189, v137 op_sel_hi:[0,1]
    v_pk_mul_f16 v204, v204, v246 op_sel_hi:[1,0]
    v_mfma_f32_32x32x16_f16 v[116:131], v[232:235], v[224:227], v[116:131]
    v_pk_mul_f16 v220, v196, v148 op_sel_hi:[0,1]
    v_pk_mul_f16 v221, v196, v149 op_sel_hi:[0,1]
    v_pk_mul_f16 v222, v196, v150 op_sel_hi:[0,1]
    v_pk_mul_f16 v223, v196, v151 op_sel_hi:[0,1]
    s_waitcnt lgkmcnt(0)
    v_mfma_f32_32x32x16_f16 v[68:83], v[236:239], v[216:219], v[68:83]
    ds_read_b128 v[232:235], v1 offset:55456
    v_pk_mul_f16 v224, v203, v162 op_sel_hi:[0,1]
    v_pk_mul_f16 v225, v203, v163 op_sel_hi:[0,1]
    v_pk_mul_f16 v226, v203, v164 op_sel_hi:[0,1]
    v_pk_mul_f16 v227, v203, v165 op_sel_hi:[0,1]
    v_pk_mul_f16 v211, v211, v247 op_sel_hi:[1,0]
    v_mfma_f32_32x32x16_f16 v[84:99], v[236:239], v[220:223], v[84:99]
    v_pk_mul_f16 v216, v210, v176 op_sel_hi:[0,1]
    v_pk_mul_f16 v217, v210, v177 op_sel_hi:[0,1]
    v_pk_mul_f16 v218, v210, v178 op_sel_hi:[0,1]
    v_pk_mul_f16 v219, v210, v179 op_sel_hi:[0,1]
    v_mfma_f32_32x32x16_f16 v[100:115], v[236:239], v[224:227], v[100:115]
    v_pk_mul_f16 v220, v189, v138 op_sel_hi:[0,1]
    v_pk_mul_f16 v221, v189, v139 op_sel_hi:[0,1]
    v_pk_mul_f16 v222, v189, v140 op_sel_hi:[0,1]
    v_pk_mul_f16 v223, v189, v141 op_sel_hi:[0,1]
    v_cvt_pk_f16_f32 v191, v10, v11
    v_mfma_f32_32x32x16_f16 v[116:131], v[236:239], v[216:219], v[116:131]
    v_pk_mul_f16 v224, v196, v152 op_sel_hi:[0,1]
    v_pk_mul_f16 v225, v196, v153 op_sel_hi:[0,1]
    v_pk_mul_f16 v226, v196, v154 op_sel_hi:[0,1]
    v_pk_mul_f16 v227, v196, v155 op_sel_hi:[0,1]
    v_mfma_f32_32x32x16_f16 v[68:83], v[240:243], v[220:223], v[68:83]
    ds_read_b128 v[236:239], v1 offset:56496
    v_pk_mul_f16 v216, v203, v166 op_sel_hi:[0,1]
    v_pk_mul_f16 v217, v203, v167 op_sel_hi:[0,1]
    v_pk_mul_f16 v218, v203, v168 op_sel_hi:[0,1]
    v_pk_mul_f16 v219, v203, v169 op_sel_hi:[0,1]
    v_cvt_pk_f16_f32 v198, v26, v27
    v_mfma_f32_32x32x16_f16 v[84:99], v[240:243], v[224:227], v[84:99]
    v_pk_mul_f16 v220, v210, v180 op_sel_hi:[0,1]
    v_pk_mul_f16 v221, v210, v181 op_sel_hi:[0,1]
    v_pk_mul_f16 v222, v210, v182 op_sel_hi:[0,1]
    v_pk_mul_f16 v223, v210, v183 op_sel_hi:[0,1]
    v_mfma_f32_32x32x16_f16 v[100:115], v[240:243], v[216:219], v[100:115]
    v_pk_mul_f16 v224, v189, v142 op_sel_hi:[0,1]
    v_pk_mul_f16 v225, v189, v143 op_sel_hi:[0,1]
    v_pk_mul_f16 v226, v189, v144 op_sel_hi:[0,1]
    v_pk_mul_f16 v227, v189, v132 op_sel:[1,0] op_sel_hi:[1,1]
    v_cvt_pk_f16_f32 v205, v42, v43
    v_mfma_f32_32x32x16_f16 v[116:131], v[240:243], v[220:223], v[116:131]
    v_pk_mul_f16 v216, v196, v156 op_sel_hi:[0,1]
    v_pk_mul_f16 v217, v196, v157 op_sel_hi:[0,1]
    v_pk_mul_f16 v218, v196, v158 op_sel_hi:[0,1]
    v_pk_mul_f16 v219, v196, v146 op_sel:[1,0] op_sel_hi:[1,1]
    v_mfma_f32_32x32x16_f16 v[68:83], v[228:231], v[224:227], v[68:83]
    ds_read_b128 v[240:243], v1 offset:57536
    v_pk_mul_f16 v220, v203, v170 op_sel_hi:[0,1]
    v_pk_mul_f16 v221, v203, v171 op_sel_hi:[0,1]
    v_pk_mul_f16 v222, v203, v172 op_sel_hi:[0,1]
    v_pk_mul_f16 v223, v203, v160 op_sel:[1,0] op_sel_hi:[1,1]
    v_cvt_pk_f16_f32 v212, v58, v59
    v_mfma_f32_32x32x16_f16 v[84:99], v[228:231], v[216:219], v[84:99]
    v_pk_mul_f16 v224, v210, v184 op_sel_hi:[0,1]
    v_pk_mul_f16 v225, v210, v185 op_sel_hi:[0,1]
    v_pk_mul_f16 v226, v210, v186 op_sel_hi:[0,1]
    v_pk_mul_f16 v227, v210, v174 op_sel:[1,0] op_sel_hi:[1,1]
    v_mfma_f32_32x32x16_f16 v[100:115], v[228:231], v[220:223], v[100:115]
    v_pk_mul_f16 v216, v189, v133 op_sel:[1,0] op_sel_hi:[1,1]
    v_pk_mul_f16 v217, v189, v134 op_sel:[1,0] op_sel_hi:[1,1]
    v_pk_mul_f16 v218, v189, v135 op_sel:[1,0] op_sel_hi:[1,1]
    v_pk_mul_f16 v219, v189, v136 op_sel:[1,0] op_sel_hi:[1,1]
    v_pk_mul_f16 v191, v191, v244 op_sel_hi:[1,0]
    v_mfma_f32_32x32x16_f16 v[116:131], v[228:231], v[224:227], v[116:131]
    v_pk_mul_f16 v220, v196, v147 op_sel:[1,0] op_sel_hi:[1,1]
    v_pk_mul_f16 v221, v196, v148 op_sel:[1,0] op_sel_hi:[1,1]
    v_pk_mul_f16 v222, v196, v149 op_sel:[1,0] op_sel_hi:[1,1]
    v_pk_mul_f16 v223, v196, v150 op_sel:[1,0] op_sel_hi:[1,1]
    s_waitcnt lgkmcnt(0)
    v_mfma_f32_32x32x16_f16 v[68:83], v[232:235], v[216:219], v[68:83]
    ds_read_b128 v[228:231], v1 offset:58576
    v_pk_mul_f16 v224, v203, v161 op_sel:[1,0] op_sel_hi:[1,1]
    v_pk_mul_f16 v225, v203, v162 op_sel:[1,0] op_sel_hi:[1,1]
    v_pk_mul_f16 v226, v203, v163 op_sel:[1,0] op_sel_hi:[1,1]
    v_pk_mul_f16 v227, v203, v164 op_sel:[1,0] op_sel_hi:[1,1]
    v_pk_mul_f16 v198, v198, v245 op_sel_hi:[1,0]
    v_mfma_f32_32x32x16_f16 v[84:99], v[232:235], v[220:223], v[84:99]
    v_pk_mul_f16 v216, v210, v175 op_sel:[1,0] op_sel_hi:[1,1]
    v_pk_mul_f16 v217, v210, v176 op_sel:[1,0] op_sel_hi:[1,1]
    v_pk_mul_f16 v218, v210, v177 op_sel:[1,0] op_sel_hi:[1,1]
    v_pk_mul_f16 v219, v210, v178 op_sel:[1,0] op_sel_hi:[1,1]
    v_mfma_f32_32x32x16_f16 v[100:115], v[232:235], v[224:227], v[100:115]
    v_pk_mul_f16 v220, v189, v137 op_sel:[1,0] op_sel_hi:[1,1]
    v_pk_mul_f16 v221, v189, v138 op_sel:[1,0] op_sel_hi:[1,1]
    v_pk_mul_f16 v222, v189, v139 op_sel:[1,0] op_sel_hi:[1,1]
    v_pk_mul_f16 v223, v189, v140 op_sel:[1,0] op_sel_hi:[1,1]
    v_pk_mul_f16 v205, v205, v246 op_sel_hi:[1,0]
    v_mfma_f32_32x32x16_f16 v[116:131], v[232:235], v[216:219], v[116:131]
    v_pk_mul_f16 v224, v196, v151 op_sel:[1,0] op_sel_hi:[1,1]
    v_pk_mul_f16 v225, v196, v152 op_sel:[1,0] op_sel_hi:[1,1]
    v_pk_mul_f16 v226, v196, v153 op_sel:[1,0] op_sel_hi:[1,1]
    v_pk_mul_f16 v227, v196, v154 op_sel:[1,0] op_sel_hi:[1,1]
    v_mfma_f32_32x32x16_f16 v[68:83], v[236:239], v[220:223], v[68:83]
    ds_read_b128 v[232:235], v1 offset:59616
    v_pk_mul_f16 v216, v203, v165 op_sel:[1,0] op_sel_hi:[1,1]
    v_pk_mul_f16 v217, v203, v166 op_sel:[1,0] op_sel_hi:[1,1]
    v_pk_mul_f16 v218, v203, v167 op_sel:[1,0] op_sel_hi:[1,1]
    v_pk_mul_f16 v219, v203, v168 op_sel:[1,0] op_sel_hi:[1,1]
    v_pk_mul_f16 v212, v212, v247 op_sel_hi:[1,0]
    v_mfma_f32_32x32x16_f16 v[84:99], v[236:239], v[224:227], v[84:99]
    v_pk_mul_f16 v220, v210, v179 op_sel:[1,0] op_sel_hi:[1,1]
    v_pk_mul_f16 v221, v210, v180 op_sel:[1,0] op_sel_hi:[1,1]
    v_pk_mul_f16 v222, v210, v181 op_sel:[1,0] op_sel_hi:[1,1]
    v_pk_mul_f16 v223, v210, v182 op_sel:[1,0] op_sel_hi:[1,1]
    v_mfma_f32_32x32x16_f16 v[100:115], v[236:239], v[216:219], v[100:115]
    v_pk_mul_f16 v224, v189, v141 op_sel:[1,0] op_sel_hi:[1,1]
    v_pk_mul_f16 v225, v189, v142 op_sel:[1,0] op_sel_hi:[1,1]
    v_pk_mul_f16 v226, v189, v143 op_sel:[1,0] op_sel_hi:[1,1]
    v_pk_mul_f16 v227, v189, v144 op_sel:[1,0] op_sel_hi:[1,1]
    v_cvt_pk_f16_f32 v192, v12, v13
    v_mfma_f32_32x32x16_f16 v[116:131], v[236:239], v[220:223], v[116:131]
    v_pk_mul_f16 v216, v196, v155 op_sel:[1,0] op_sel_hi:[1,1]
    v_pk_mul_f16 v217, v196, v156 op_sel:[1,0] op_sel_hi:[1,1]
    v_pk_mul_f16 v218, v196, v157 op_sel:[1,0] op_sel_hi:[1,1]
    v_pk_mul_f16 v219, v196, v158 op_sel:[1,0] op_sel_hi:[1,1]
    v_mfma_f32_32x32x16_f16 v[68:83], v[240:243], v[224:227], v[68:83]
    ds_read_b128 v[236:239], v1 offset:60656
    v_pk_mul_f16 v220, v203, v169 op_sel:[1,0] op_sel_hi:[1,1]
    v_pk_mul_f16 v221, v203, v170 op_sel:[1,0] op_sel_hi:[1,1]
    v_pk_mul_f16 v222, v203, v171 op_sel:[1,0] op_sel_hi:[1,1]
    v_pk_mul_f16 v223, v203, v172 op_sel:[1,0] op_sel_hi:[1,1]
    v_cvt_pk_f16_f32 v199, v28, v29
    v_mfma_f32_32x32x16_f16 v[84:99], v[240:243], v[216:219], v[84:99]
    v_pk_mul_f16 v224, v210, v183 op_sel:[1,0] op_sel_hi:[1,1]
    v_pk_mul_f16 v225, v210, v184 op_sel:[1,0] op_sel_hi:[1,1]
    v_pk_mul_f16 v226, v210, v185 op_sel:[1,0] op_sel_hi:[1,1]
    v_pk_mul_f16 v227, v210, v186 op_sel:[1,0] op_sel_hi:[1,1]
    v_mfma_f32_32x32x16_f16 v[100:115], v[240:243], v[220:223], v[100:115]
    v_pk_mul_f16 v216, v190, v132 op_sel_hi:[0,1]
    v_pk_mul_f16 v217, v190, v133 op_sel_hi:[0,1]
    v_pk_mul_f16 v218, v190, v134 op_sel_hi:[0,1]
    v_pk_mul_f16 v219, v190, v135 op_sel_hi:[0,1]
    v_cvt_pk_f16_f32 v206, v44, v45
    v_mfma_f32_32x32x16_f16 v[116:131], v[240:243], v[224:227], v[116:131]
    v_pk_mul_f16 v220, v197, v146 op_sel_hi:[0,1]
    v_pk_mul_f16 v221, v197, v147 op_sel_hi:[0,1]
    v_pk_mul_f16 v222, v197, v148 op_sel_hi:[0,1]
    v_pk_mul_f16 v223, v197, v149 op_sel_hi:[0,1]
    s_waitcnt lgkmcnt(0)
    v_mfma_f32_32x32x16_f16 v[68:83], v[228:231], v[216:219], v[68:83]
    ds_read_b128 v[240:243], v1 offset:61696
    v_pk_mul_f16 v224, v204, v160 op_sel_hi:[0,1]
    v_pk_mul_f16 v225, v204, v161 op_sel_hi:[0,1]
    v_pk_mul_f16 v226, v204, v162 op_sel_hi:[0,1]
    v_pk_mul_f16 v227, v204, v163 op_sel_hi:[0,1]
    v_cvt_pk_f16_f32 v213, v60, v61
    v_mfma_f32_32x32x16_f16 v[84:99], v[228:231], v[220:223], v[84:99]
    v_pk_mul_f16 v216, v211, v174 op_sel_hi:[0,1]
    v_pk_mul_f16 v217, v211, v175 op_sel_hi:[0,1]
    v_pk_mul_f16 v218, v211, v176 op_sel_hi:[0,1]
    v_pk_mul_f16 v219, v211, v177 op_sel_hi:[0,1]
    v_mfma_f32_32x32x16_f16 v[100:115], v[228:231], v[224:227], v[100:115]
    v_pk_mul_f16 v220, v190, v136 op_sel_hi:[0,1]
    v_pk_mul_f16 v221, v190, v137 op_sel_hi:[0,1]
    v_pk_mul_f16 v222, v190, v138 op_sel_hi:[0,1]
    v_pk_mul_f16 v223, v190, v139 op_sel_hi:[0,1]
    v_pk_mul_f16 v192, v192, v244 op_sel_hi:[1,0]
    v_mfma_f32_32x32x16_f16 v[116:131], v[228:231], v[216:219], v[116:131]
    v_pk_mul_f16 v224, v197, v150 op_sel_hi:[0,1]
    v_pk_mul_f16 v225, v197, v151 op_sel_hi:[0,1]
    v_pk_mul_f16 v226, v197, v152 op_sel_hi:[0,1]
    v_pk_mul_f16 v227, v197, v153 op_sel_hi:[0,1]
    v_mfma_f32_32x32x16_f16 v[68:83], v[232:235], v[220:223], v[68:83]
    ds_read_b128 v[228:231], v1 offset:62736
    v_pk_mul_f16 v216, v204, v164 op_sel_hi:[0,1]
    v_pk_mul_f16 v217, v204, v165 op_sel_hi:[0,1]
    v_pk_mul_f16 v218, v204, v166 op_sel_hi:[0,1]
    v_pk_mul_f16 v219, v204, v167 op_sel_hi:[0,1]
    v_pk_mul_f16 v199, v199, v245 op_sel_hi:[1,0]
    v_mfma_f32_32x32x16_f16 v[84:99], v[232:235], v[224:227], v[84:99]
    v_pk_mul_f16 v220, v211, v178 op_sel_hi:[0,1]
    v_pk_mul_f16 v221, v211, v179 op_sel_hi:[0,1]
    v_pk_mul_f16 v222, v211, v180 op_sel_hi:[0,1]
    v_pk_mul_f16 v223, v211, v181 op_sel_hi:[0,1]
    v_mfma_f32_32x32x16_f16 v[100:115], v[232:235], v[216:219], v[100:115]
    v_pk_mul_f16 v224, v190, v140 op_sel_hi:[0,1]
    v_pk_mul_f16 v225, v190, v141 op_sel_hi:[0,1]
    v_pk_mul_f16 v226, v190, v142 op_sel_hi:[0,1]
    v_pk_mul_f16 v227, v190, v143 op_sel_hi:[0,1]
    v_pk_mul_f16 v206, v206, v246 op_sel_hi:[1,0]
    v_mfma_f32_32x32x16_f16 v[116:131], v[232:235], v[220:223], v[116:131]
    v_pk_mul_f16 v216, v197, v154 op_sel_hi:[0,1]
    v_pk_mul_f16 v217, v197, v155 op_sel_hi:[0,1]
    v_pk_mul_f16 v218, v197, v156 op_sel_hi:[0,1]
    v_pk_mul_f16 v219, v197, v157 op_sel_hi:[0,1]
    v_mfma_f32_32x32x16_f16 v[68:83], v[236:239], v[224:227], v[68:83]
    ds_read_b128 v[232:235], v1 offset:63776
    v_pk_mul_f16 v220, v204, v168 op_sel_hi:[0,1]
    v_pk_mul_f16 v221, v204, v169 op_sel_hi:[0,1]
    v_pk_mul_f16 v222, v204, v170 op_sel_hi:[0,1]
    v_pk_mul_f16 v223, v204, v171 op_sel_hi:[0,1]
    v_pk_mul_f16 v213, v213, v247 op_sel_hi:[1,0]
    v_mfma_f32_32x32x16_f16 v[84:99], v[236:239], v[216:219], v[84:99]
    v_pk_mul_f16 v224, v211, v182 op_sel_hi:[0,1]
    v_pk_mul_f16 v225, v211, v183 op_sel_hi:[0,1]
    v_pk_mul_f16 v226, v211, v184 op_sel_hi:[0,1]
    v_pk_mul_f16 v227, v211, v185 op_sel_hi:[0,1]
    v_mfma_f32_32x32x16_f16 v[100:115], v[236:239], v[220:223], v[100:115]
    v_pk_mul_f16 v216, v190, v144 op_sel_hi:[0,1]
    v_pk_mul_f16 v217, v190, v132 op_sel:[1,0] op_sel_hi:[1,1]
    v_pk_mul_f16 v218, v190, v133 op_sel:[1,0] op_sel_hi:[1,1]
    v_pk_mul_f16 v219, v190, v134 op_sel:[1,0] op_sel_hi:[1,1]
    v_cvt_pk_f16_f32 v193, v14, v15
    v_mfma_f32_32x32x16_f16 v[116:131], v[236:239], v[224:227], v[116:131]
    v_pk_mul_f16 v220, v197, v158 op_sel_hi:[0,1]
    v_pk_mul_f16 v221, v197, v146 op_sel:[1,0] op_sel_hi:[1,1]
    v_pk_mul_f16 v222, v197, v147 op_sel:[1,0] op_sel_hi:[1,1]
    v_pk_mul_f16 v223, v197, v148 op_sel:[1,0] op_sel_hi:[1,1]
    s_waitcnt lgkmcnt(0)
    v_mfma_f32_32x32x16_f16 v[68:83], v[240:243], v[216:219], v[68:83]
    ds_read_b128 v[236:239], v1 offset:64816
    v_pk_mul_f16 v224, v204, v172 op_sel_hi:[0,1]
    v_pk_mul_f16 v225, v204, v160 op_sel:[1,0] op_sel_hi:[1,1]
    v_pk_mul_f16 v226, v204, v161 op_sel:[1,0] op_sel_hi:[1,1]
    v_pk_mul_f16 v227, v204, v162 op_sel:[1,0] op_sel_hi:[1,1]
    v_cvt_pk_f16_f32 v200, v30, v31
    v_mfma_f32_32x32x16_f16 v[84:99], v[240:243], v[220:223], v[84:99]
    v_pk_mul_f16 v216, v211, v186 op_sel_hi:[0,1]
    v_pk_mul_f16 v217, v211, v174 op_sel:[1,0] op_sel_hi:[1,1]
    v_pk_mul_f16 v218, v211, v175 op_sel:[1,0] op_sel_hi:[1,1]
    v_pk_mul_f16 v219, v211, v176 op_sel:[1,0] op_sel_hi:[1,1]
    v_mfma_f32_32x32x16_f16 v[100:115], v[240:243], v[224:227], v[100:115]
    v_pk_mul_f16 v220, v190, v135 op_sel:[1,0] op_sel_hi:[1,1]
    v_pk_mul_f16 v221, v190, v136 op_sel:[1,0] op_sel_hi:[1,1]
    v_pk_mul_f16 v222, v190, v137 op_sel:[1,0] op_sel_hi:[1,1]
    v_pk_mul_f16 v223, v190, v138 op_sel:[1,0] op_sel_hi:[1,1]
    v_cvt_pk_f16_f32 v207, v46, v47
    v_mfma_f32_32x32x16_f16 v[116:131], v[240:243], v[216:219], v[116:131]
    v_pk_mul_f16 v224, v197, v149 op_sel:[1,0] op_sel_hi:[1,1]
    v_pk_mul_f16 v225, v197, v150 op_sel:[1,0] op_sel_hi:[1,1]
    v_pk_mul_f16 v226, v197, v151 op_sel:[1,0] op_sel_hi:[1,1]
    v_pk_mul_f16 v227, v197, v152 op_sel:[1,0] op_sel_hi:[1,1]
    v_mfma_f32_32x32x16_f16 v[68:83], v[228:231], v[220:223], v[68:83]
    v_add_u32 v1, 65856, v1
    ds_read_b128 v[240:243], v1 offset:0
    v_pk_mul_f16 v216, v204, v163 op_sel:[1,0] op_sel_hi:[1,1]
    v_pk_mul_f16 v217, v204, v164 op_sel:[1,0] op_sel_hi:[1,1]
    v_pk_mul_f16 v218, v204, v165 op_sel:[1,0] op_sel_hi:[1,1]
    v_pk_mul_f16 v219, v204, v166 op_sel:[1,0] op_sel_hi:[1,1]
    v_mfma_f32_32x32x16_f16 v[84:99], v[228:231], v[224:227], v[84:99]
    v_pk_mul_f16 v220, v211, v177 op_sel:[1,0] op_sel_hi:[1,1]
    v_pk_mul_f16 v221, v211, v178 op_sel:[1,0] op_sel_hi:[1,1]
    v_pk_mul_f16 v222, v211, v179 op_sel:[1,0] op_sel_hi:[1,1]
    v_pk_mul_f16 v223, v211, v180 op_sel:[1,0] op_sel_hi:[1,1]
    v_cvt_pk_f16_f32 v214, v62, v63
    v_mfma_f32_32x32x16_f16 v[100:115], v[228:231], v[216:219], v[100:115]
    v_pk_mul_f16 v224, v190, v139 op_sel:[1,0] op_sel_hi:[1,1]
    v_pk_mul_f16 v225, v190, v140 op_sel:[1,0] op_sel_hi:[1,1]
    v_pk_mul_f16 v226, v190, v141 op_sel:[1,0] op_sel_hi:[1,1]
    v_pk_mul_f16 v227, v190, v142 op_sel:[1,0] op_sel_hi:[1,1]
    v_pk_mul_f16 v193, v193, v244 op_sel_hi:[1,0]
    v_mfma_f32_32x32x16_f16 v[116:131], v[228:231], v[220:223], v[116:131]
    v_pk_mul_f16 v216, v197, v153 op_sel:[1,0] op_sel_hi:[1,1]
    v_pk_mul_f16 v217, v197, v154 op_sel:[1,0] op_sel_hi:[1,1]
    v_pk_mul_f16 v218, v197, v155 op_sel:[1,0] op_sel_hi:[1,1]
    v_pk_mul_f16 v219, v197, v156 op_sel:[1,0] op_sel_hi:[1,1]
    v_mfma_f32_32x32x16_f16 v[68:83], v[232:235], v[224:227], v[68:83]
    ds_read_b128 v[228:231], v1 offset:1040
    v_pk_mul_f16 v220, v204, v167 op_sel:[1,0] op_sel_hi:[1,1]
    v_pk_mul_f16 v221, v204, v168 op_sel:[1,0] op_sel_hi:[1,1]
    v_pk_mul_f16 v222, v204, v169 op_sel:[1,0] op_sel_hi:[1,1]
    v_pk_mul_f16 v223, v204, v170 op_sel:[1,0] op_sel_hi:[1,1]
    v_pk_mul_f16 v200, v200, v245 op_sel_hi:[1,0]
    v_mfma_f32_32x32x16_f16 v[84:99], v[232:235], v[216:219], v[84:99]
    v_pk_mul_f16 v224, v211, v181 op_sel:[1,0] op_sel_hi:[1,1]
    v_pk_mul_f16 v225, v211, v182 op_sel:[1,0] op_sel_hi:[1,1]
    v_pk_mul_f16 v226, v211, v183 op_sel:[1,0] op_sel_hi:[1,1]
    v_pk_mul_f16 v227, v211, v184 op_sel:[1,0] op_sel_hi:[1,1]
    v_mfma_f32_32x32x16_f16 v[100:115], v[232:235], v[220:223], v[100:115]
    v_pk_mul_f16 v216, v190, v143 op_sel:[1,0] op_sel_hi:[1,1]
    v_pk_mul_f16 v217, v190, v144 op_sel:[1,0] op_sel_hi:[1,1]
    v_pk_mul_f16 v218, v191, v132 op_sel_hi:[0,1]
    v_pk_mul_f16 v219, v191, v133 op_sel_hi:[0,1]
    v_pk_mul_f16 v207, v207, v246 op_sel_hi:[1,0]
    v_mfma_f32_32x32x16_f16 v[116:131], v[232:235], v[224:227], v[116:131]
    v_pk_mul_f16 v220, v197, v157 op_sel:[1,0] op_sel_hi:[1,1]
    v_pk_mul_f16 v221, v197, v158 op_sel:[1,0] op_sel_hi:[1,1]
    v_pk_mul_f16 v222, v198, v146 op_sel_hi:[0,1]
    v_pk_mul_f16 v223, v198, v147 op_sel_hi:[0,1]
    s_waitcnt lgkmcnt(0)
    v_mfma_f32_32x32x16_f16 v[68:83], v[236:239], v[216:219], v[68:83]
    ds_read_b128 v[232:235], v1 offset:2080
    v_pk_mul_f16 v224, v204, v171 op_sel:[1,0] op_sel_hi:[1,1]
    v_pk_mul_f16 v225, v204, v172 op_sel:[1,0] op_sel_hi:[1,1]
    v_pk_mul_f16 v226, v205, v160 op_sel_hi:[0,1]
    v_pk_mul_f16 v227, v205, v161 op_sel_hi:[0,1]
    v_pk_mul_f16 v214, v214, v247 op_sel_hi:[1,0]
    v_mfma_f32_32x32x16_f16 v[84:99], v[236:239], v[220:223], v[84:99]
    v_pk_mul_f16 v216, v211, v185 op_sel:[1,0] op_sel_hi:[1,1]
    v_pk_mul_f16 v217, v211, v186 op_sel:[1,0] op_sel_hi:[1,1]
    v_pk_mul_f16 v218, v212, v174 op_sel_hi:[0,1]
    v_pk_mul_f16 v219, v212, v175 op_sel_hi:[0,1]
    v_mfma_f32_32x32x16_f16 v[100:115], v[236:239], v[224:227], v[100:115]
    v_pk_mul_f16 v220, v191, v134 op_sel_hi:[0,1]
    v_pk_mul_f16 v221, v191, v135 op_sel_hi:[0,1]
    v_pk_mul_f16 v222, v191, v136 op_sel_hi:[0,1]
    v_pk_mul_f16 v223, v191, v137 op_sel_hi:[0,1]
    v_cvt_pk_f16_f32 v194, v16, 0
    v_mfma_f32_32x32x16_f16 v[116:131], v[236:239], v[216:219], v[116:131]
    v_pk_mul_f16 v224, v198, v148 op_sel_hi:[0,1]
    v_pk_mul_f16 v225, v198, v149 op_sel_hi:[0,1]
    v_pk_mul_f16 v226, v198, v150 op_sel_hi:[0,1]
    v_pk_mul_f16 v227, v198, v151 op_sel_hi:[0,1]
    v_mfma_f32_32x32x16_f16 v[68:83], v[240:243], v[220:223], v[68:83]
    ds_read_b128 v[236:239], v1 offset:3120
    v_pk_mul_f16 v216, v205, v162 op_sel_hi:[0,1]
    v_pk_mul_f16 v217, v205, v163 op_sel_hi:[0,1]
    v_pk_mul_f16 v218, v205, v164 op_sel_hi:[0,1]
    v_pk_mul_f16 v219, v205, v165 op_sel_hi:[0,1]
    v_cvt_pk_f16_f32 v201, v32, 0
    v_mfma_f32_32x32x16_f16 v[84:99], v[240:243], v[224:227], v[84:99]
    v_pk_mul_f16 v220, v212, v176 op_sel_hi:[0,1]
    v_pk_mul_f16 v221, v212, v177 op_sel_hi:[0,1]
    v_pk_mul_f16 v222, v212, v178 op_sel_hi:[0,1]
    v_pk_mul_f16 v223, v212, v179 op_sel_hi:[0,1]
    v_mfma_f32_32x32x16_f16 v[100:115], v[240:243], v[216:219], v[100:115]
    v_pk_mul_f16 v224, v191, v138 op_sel_hi:[0,1]
    v_pk_mul_f16 v225, v191, v139 op_sel_hi:[0,1]
    v_pk_mul_f16 v226, v191, v140 op_sel_hi:[0,1]
    v_pk_mul_f16 v227, v191, v141 op_sel_hi:[0,1]
    v_cvt_pk_f16_f32 v208, v48, 0
    v_mfma_f32_32x32x16_f16 v[116:131], v[240:243], v[220:223], v[116:131]
    v_pk_mul_f16 v216, v198, v152 op_sel_hi:[0,1]
    v_pk_mul_f16 v217, v198, v153 op_sel_hi:[0,1]
    v_pk_mul_f16 v218, v198, v154 op_sel_hi:[0,1]
    v_pk_mul_f16 v219, v198, v155 op_sel_hi:[0,1]
    v_mfma_f32_32x32x16_f16 v[68:83], v[228:231], v[224:227], v[68:83]
    ds_read_b128 v[240:243], v1 offset:4160
    v_pk_mul_f16 v220, v205, v166 op_sel_hi:[0,1]
    v_pk_mul_f16 v221, v205, v167 op_sel_hi:[0,1]
    v_pk_mul_f16 v222, v205, v168 op_sel_hi:[0,1]
    v_pk_mul_f16 v223, v205, v169 op_sel_hi:[0,1]
    v_cvt_pk_f16_f32 v215, v64, 0
    v_mfma_f32_32x32x16_f16 v[84:99], v[228:231], v[216:219], v[84:99]
    v_pk_mul_f16 v224, v212, v180 op_sel_hi:[0,1]
    v_pk_mul_f16 v225, v212, v181 op_sel_hi:[0,1]
    v_pk_mul_f16 v226, v212, v182 op_sel_hi:[0,1]
    v_pk_mul_f16 v227, v212, v183 op_sel_hi:[0,1]
    v_mfma_f32_32x32x16_f16 v[100:115], v[228:231], v[220:223], v[100:115]
    v_pk_mul_f16 v216, v191, v142 op_sel_hi:[0,1]
    v_pk_mul_f16 v217, v191, v143 op_sel_hi:[0,1]
    v_pk_mul_f16 v218, v191, v144 op_sel_hi:[0,1]
    v_pk_mul_f16 v219, v191, v132 op_sel:[1,0] op_sel_hi:[1,1]
    v_pk_mul_f16 v194, v194, v244 op_sel_hi:[1,0]
    v_mfma_f32_32x32x16_f16 v[116:131], v[228:231], v[224:227], v[116:131]
    v_pk_mul_f16 v220, v198, v156 op_sel_hi:[0,1]
    v_pk_mul_f16 v221, v198, v157 op_sel_hi:[0,1]
    v_pk_mul_f16 v222, v198, v158 op_sel_hi:[0,1]
    v_pk_mul_f16 v223, v198, v146 op_sel:[1,0] op_sel_hi:[1,1]
    s_waitcnt lgkmcnt(0)
    v_mfma_f32_32x32x16_f16 v[68:83], v[232:235], v[216:219], v[68:83]
    ds_read_b128 v[228:231], v1 offset:5200
    v_pk_mul_f16 v224, v205, v170 op_sel_hi:[0,1]
    v_pk_mul_f16 v225, v205, v171 op_sel_hi:[0,1]
    v_pk_mul_f16 v226, v205, v172 op_sel_hi:[0,1]
    v_pk_mul_f16 v227, v205, v160 op_sel:[1,0] op_sel_hi:[1,1]
    v_pk_mul_f16 v201, v201, v245 op_sel_hi:[1,0]
    v_mfma_f32_32x32x16_f16 v[84:99], v[232:235], v[220:223], v[84:99]
    v_pk_mul_f16 v216, v212, v184 op_sel_hi:[0,1]
    v_pk_mul_f16 v217, v212, v185 op_sel_hi:[0,1]
    v_pk_mul_f16 v218, v212, v186 op_sel_hi:[0,1]
    v_pk_mul_f16 v219, v212, v174 op_sel:[1,0] op_sel_hi:[1,1]
    v_mfma_f32_32x32x16_f16 v[100:115], v[232:235], v[224:227], v[100:115]
    v_pk_mul_f16 v220, v191, v133 op_sel:[1,0] op_sel_hi:[1,1]
    v_pk_mul_f16 v221, v191, v134 op_sel:[1,0] op_sel_hi:[1,1]
    v_pk_mul_f16 v222, v191, v135 op_sel:[1,0] op_sel_hi:[1,1]
    v_pk_mul_f16 v223, v191, v136 op_sel:[1,0] op_sel_hi:[1,1]
    v_pk_mul_f16 v208, v208, v246 op_sel_hi:[1,0]
    v_mfma_f32_32x32x16_f16 v[116:131], v[232:235], v[216:219], v[116:131]
    v_pk_mul_f16 v224, v198, v147 op_sel:[1,0] op_sel_hi:[1,1]
    v_pk_mul_f16 v225, v198, v148 op_sel:[1,0] op_sel_hi:[1,1]
    v_pk_mul_f16 v226, v198, v149 op_sel:[1,0] op_sel_hi:[1,1]
    v_pk_mul_f16 v227, v198, v150 op_sel:[1,0] op_sel_hi:[1,1]
    v_mfma_f32_32x32x16_f16 v[68:83], v[236:239], v[220:223], v[68:83]
    ds_read_b128 v[232:235], v1 offset:6240
    v_pk_mul_f16 v216, v205, v161 op_sel:[1,0] op_sel_hi:[1,1]
    v_pk_mul_f16 v217, v205, v162 op_sel:[1,0] op_sel_hi:[1,1]
    v_pk_mul_f16 v218, v205, v163 op_sel:[1,0] op_sel_hi:[1,1]
    v_pk_mul_f16 v219, v205, v164 op_sel:[1,0] op_sel_hi:[1,1]
    v_pk_mul_f16 v215, v215, v247 op_sel_hi:[1,0]
    v_mfma_f32_32x32x16_f16 v[84:99], v[236:239], v[224:227], v[84:99]
    v_pk_mul_f16 v220, v212, v175 op_sel:[1,0] op_sel_hi:[1,1]
    v_pk_mul_f16 v221, v212, v176 op_sel:[1,0] op_sel_hi:[1,1]
    v_pk_mul_f16 v222, v212, v177 op_sel:[1,0] op_sel_hi:[1,1]
    v_pk_mul_f16 v223, v212, v178 op_sel:[1,0] op_sel_hi:[1,1]
    v_mfma_f32_32x32x16_f16 v[100:115], v[236:239], v[216:219], v[100:115]
    v_pk_mul_f16 v224, v191, v137 op_sel:[1,0] op_sel_hi:[1,1]
    v_pk_mul_f16 v225, v191, v138 op_sel:[1,0] op_sel_hi:[1,1]
    v_pk_mul_f16 v226, v191, v139 op_sel:[1,0] op_sel_hi:[1,1]
    v_pk_mul_f16 v227, v191, v140 op_sel:[1,0] op_sel_hi:[1,1]
    v_mfma_f32_32x32x16_f16 v[116:131], v[236:239], v[220:223], v[116:131]
    v_pk_mul_f16 v216, v198, v151 op_sel:[1,0] op_sel_hi:[1,1]
    v_pk_mul_f16 v217, v198, v152 op_sel:[1,0] op_sel_hi:[1,1]
    v_pk_mul_f16 v218, v198, v153 op_sel:[1,0] op_sel_hi:[1,1]
    v_pk_mul_f16 v219, v198, v154 op_sel:[1,0] op_sel_hi:[1,1]
    v_mfma_f32_32x32x16_f16 v[68:83], v[240:243], v[224:227], v[68:83]
    ds_read_b128 v[236:239], v1 offset:7280
    v_pk_mul_f16 v220, v205, v165 op_sel:[1,0] op_sel_hi:[1,1]
    v_pk_mul_f16 v221, v205, v166 op_sel:[1,0] op_sel_hi:[1,1]
    v_pk_mul_f16 v222, v205, v167 op_sel:[1,0] op_sel_hi:[1,1]
    v_pk_mul_f16 v223, v205, v168 op_sel:[1,0] op_sel_hi:[1,1]
    v_mfma_f32_32x32x16_f16 v[84:99], v[240:243], v[216:219], v[84:99]
    v_pk_mul_f16 v224, v212, v179 op_sel:[1,0] op_sel_hi:[1,1]
    v_pk_mul_f16 v225, v212, v180 op_sel:[1,0] op_sel_hi:[1,1]
    v_pk_mul_f16 v226, v212, v181 op_sel:[1,0] op_sel_hi:[1,1]
    v_pk_mul_f16 v227, v212, v182 op_sel:[1,0] op_sel_hi:[1,1]
    v_mfma_f32_32x32x16_f16 v[100:115], v[240:243], v[220:223], v[100:115]
    v_pk_mul_f16 v216, v191, v141 op_sel:[1,0] op_sel_hi:[1,1]
    v_pk_mul_f16 v217, v191, v142 op_sel:[1,0] op_sel_hi:[1,1]
    v_pk_mul_f16 v218, v191, v143 op_sel:[1,0] op_sel_hi:[1,1]
    v_pk_mul_f16 v219, v191, v144 op_sel:[1,0] op_sel_hi:[1,1]
    v_mfma_f32_32x32x16_f16 v[116:131], v[240:243], v[224:227], v[116:131]
    v_pk_mul_f16 v220, v198, v155 op_sel:[1,0] op_sel_hi:[1,1]
    v_pk_mul_f16 v221, v198, v156 op_sel:[1,0] op_sel_hi:[1,1]
    v_pk_mul_f16 v222, v198, v157 op_sel:[1,0] op_sel_hi:[1,1]
    v_pk_mul_f16 v223, v198, v158 op_sel:[1,0] op_sel_hi:[1,1]
    s_waitcnt lgkmcnt(0)
    v_mfma_f32_32x32x16_f16 v[68:83], v[228:231], v[216:219], v[68:83]
    ds_read_b128 v[240:243], v1 offset:8320
    v_pk_mul_f16 v224, v205, v169 op_sel:[1,0] op_sel_hi:[1,1]
    v_pk_mul_f16 v225, v205, v170 op_sel:[1,0] op_sel_hi:[1,1]
    v_pk_mul_f16 v226, v205, v171 op_sel:[1,0] op_sel_hi:[1,1]
    v_pk_mul_f16 v227, v205, v172 op_sel:[1,0] op_sel_hi:[1,1]
    v_mfma_f32_32x32x16_f16 v[84:99], v[228:231], v[220:223], v[84:99]
    v_pk_mul_f16 v216, v212, v183 op_sel:[1,0] op_sel_hi:[1,1]
    v_pk_mul_f16 v217, v212, v184 op_sel:[1,0] op_sel_hi:[1,1]
    v_pk_mul_f16 v218, v212, v185 op_sel:[1,0] op_sel_hi:[1,1]
    v_pk_mul_f16 v219, v212, v186 op_sel:[1,0] op_sel_hi:[1,1]
    v_mfma_f32_32x32x16_f16 v[100:115], v[228:231], v[224:227], v[100:115]
    v_pk_mul_f16 v220, v192, v132 op_sel_hi:[0,1]
    v_pk_mul_f16 v221, v192, v133 op_sel_hi:[0,1]
    v_pk_mul_f16 v222, v192, v134 op_sel_hi:[0,1]
    v_pk_mul_f16 v223, v192, v135 op_sel_hi:[0,1]
    v_mfma_f32_32x32x16_f16 v[116:131], v[228:231], v[216:219], v[116:131]
    v_pk_mul_f16 v224, v199, v146 op_sel_hi:[0,1]
    v_pk_mul_f16 v225, v199, v147 op_sel_hi:[0,1]
    v_pk_mul_f16 v226, v199, v148 op_sel_hi:[0,1]
    v_pk_mul_f16 v227, v199, v149 op_sel_hi:[0,1]
    v_mfma_f32_32x32x16_f16 v[68:83], v[232:235], v[220:223], v[68:83]
    ds_read_b128 v[228:231], v1 offset:9360
    v_pk_mul_f16 v216, v206, v160 op_sel_hi:[0,1]
    v_pk_mul_f16 v217, v206, v161 op_sel_hi:[0,1]
    v_pk_mul_f16 v218, v206, v162 op_sel_hi:[0,1]
    v_pk_mul_f16 v219, v206, v163 op_sel_hi:[0,1]
    v_mfma_f32_32x32x16_f16 v[84:99], v[232:235], v[224:227], v[84:99]
    v_pk_mul_f16 v220, v213, v174 op_sel_hi:[0,1]
    v_pk_mul_f16 v221, v213, v175 op_sel_hi:[0,1]
    v_pk_mul_f16 v222, v213, v176 op_sel_hi:[0,1]
    v_pk_mul_f16 v223, v213, v177 op_sel_hi:[0,1]
    v_mfma_f32_32x32x16_f16 v[100:115], v[232:235], v[216:219], v[100:115]
    v_pk_mul_f16 v224, v192, v136 op_sel_hi:[0,1]
    v_pk_mul_f16 v225, v192, v137 op_sel_hi:[0,1]
    v_pk_mul_f16 v226, v192, v138 op_sel_hi:[0,1]
    v_pk_mul_f16 v227, v192, v139 op_sel_hi:[0,1]
    v_mfma_f32_32x32x16_f16 v[116:131], v[232:235], v[220:223], v[116:131]
    v_pk_mul_f16 v216, v199, v150 op_sel_hi:[0,1]
    v_pk_mul_f16 v217, v199, v151 op_sel_hi:[0,1]
    v_pk_mul_f16 v218, v199, v152 op_sel_hi:[0,1]
    v_pk_mul_f16 v219, v199, v153 op_sel_hi:[0,1]
    v_mfma_f32_32x32x16_f16 v[68:83], v[236:239], v[224:227], v[68:83]
    ds_read_b128 v[232:235], v1 offset:10400
    v_pk_mul_f16 v220, v206, v164 op_sel_hi:[0,1]
    v_pk_mul_f16 v221, v206, v165 op_sel_hi:[0,1]
    v_pk_mul_f16 v222, v206, v166 op_sel_hi:[0,1]
    v_pk_mul_f16 v223, v206, v167 op_sel_hi:[0,1]
    v_mfma_f32_32x32x16_f16 v[84:99], v[236:239], v[216:219], v[84:99]
    v_pk_mul_f16 v224, v213, v178 op_sel_hi:[0,1]
    v_pk_mul_f16 v225, v213, v179 op_sel_hi:[0,1]
    v_pk_mul_f16 v226, v213, v180 op_sel_hi:[0,1]
    v_pk_mul_f16 v227, v213, v181 op_sel_hi:[0,1]
    v_mfma_f32_32x32x16_f16 v[100:115], v[236:239], v[220:223], v[100:115]
    v_pk_mul_f16 v216, v192, v140 op_sel_hi:[0,1]
    v_pk_mul_f16 v217, v192, v141 op_sel_hi:[0,1]
    v_pk_mul_f16 v218, v192, v142 op_sel_hi:[0,1]
    v_pk_mul_f16 v219, v192, v143 op_sel_hi:[0,1]
    v_mfma_f32_32x32x16_f16 v[116:131], v[236:239], v[224:227], v[116:131]
    v_pk_mul_f16 v220, v199, v154 op_sel_hi:[0,1]
    v_pk_mul_f16 v221, v199, v155 op_sel_hi:[0,1]
    v_pk_mul_f16 v222, v199, v156 op_sel_hi:[0,1]
    v_pk_mul_f16 v223, v199, v157 op_sel_hi:[0,1]
    s_waitcnt lgkmcnt(0)
    v_mfma_f32_32x32x16_f16 v[68:83], v[240:243], v[216:219], v[68:83]
    ds_read_b128 v[236:239], v1 offset:11440
    v_pk_mul_f16 v224, v206, v168 op_sel_hi:[0,1]
    v_pk_mul_f16 v225, v206, v169 op_sel_hi:[0,1]
    v_pk_mul_f16 v226, v206, v170 op_sel_hi:[0,1]
    v_pk_mul_f16 v227, v206, v171 op_sel_hi:[0,1]
    v_mfma_f32_32x32x16_f16 v[84:99], v[240:243], v[220:223], v[84:99]
    v_pk_mul_f16 v216, v213, v182 op_sel_hi:[0,1]
    v_pk_mul_f16 v217, v213, v183 op_sel_hi:[0,1]
    v_pk_mul_f16 v218, v213, v184 op_sel_hi:[0,1]
    v_pk_mul_f16 v219, v213, v185 op_sel_hi:[0,1]
    v_mfma_f32_32x32x16_f16 v[100:115], v[240:243], v[224:227], v[100:115]
    v_pk_mul_f16 v220, v192, v144 op_sel_hi:[0,1]
    v_pk_mul_f16 v221, v192, v132 op_sel:[1,0] op_sel_hi:[1,1]
    v_pk_mul_f16 v222, v192, v133 op_sel:[1,0] op_sel_hi:[1,1]
    v_pk_mul_f16 v223, v192, v134 op_sel:[1,0] op_sel_hi:[1,1]
    v_mfma_f32_32x32x16_f16 v[116:131], v[240:243], v[216:219], v[116:131]
    v_pk_mul_f16 v224, v199, v158 op_sel_hi:[0,1]
    v_pk_mul_f16 v225, v199, v146 op_sel:[1,0] op_sel_hi:[1,1]
    v_pk_mul_f16 v226, v199, v147 op_sel:[1,0] op_sel_hi:[1,1]
    v_pk_mul_f16 v227, v199, v148 op_sel:[1,0] op_sel_hi:[1,1]
    v_mfma_f32_32x32x16_f16 v[68:83], v[228:231], v[220:223], v[68:83]
    ds_read_b128 v[240:243], v1 offset:12480
    v_pk_mul_f16 v216, v206, v172 op_sel_hi:[0,1]
    v_pk_mul_f16 v217, v206, v160 op_sel:[1,0] op_sel_hi:[1,1]
    v_pk_mul_f16 v218, v206, v161 op_sel:[1,0] op_sel_hi:[1,1]
    v_pk_mul_f16 v219, v206, v162 op_sel:[1,0] op_sel_hi:[1,1]
    v_mfma_f32_32x32x16_f16 v[84:99], v[228:231], v[224:227], v[84:99]
    v_pk_mul_f16 v220, v213, v186 op_sel_hi:[0,1]
    v_pk_mul_f16 v221, v213, v174 op_sel:[1,0] op_sel_hi:[1,1]
    v_pk_mul_f16 v222, v213, v175 op_sel:[1,0] op_sel_hi:[1,1]
    v_pk_mul_f16 v223, v213, v176 op_sel:[1,0] op_sel_hi:[1,1]
    v_mfma_f32_32x32x16_f16 v[100:115], v[228:231], v[216:219], v[100:115]
    v_pk_mul_f16 v224, v192, v135 op_sel:[1,0] op_sel_hi:[1,1]
    v_pk_mul_f16 v225, v192, v136 op_sel:[1,0] op_sel_hi:[1,1]
    v_pk_mul_f16 v226, v192, v137 op_sel:[1,0] op_sel_hi:[1,1]
    v_pk_mul_f16 v227, v192, v138 op_sel:[1,0] op_sel_hi:[1,1]
    v_mfma_f32_32x32x16_f16 v[116:131], v[228:231], v[220:223], v[116:131]
    v_pk_mul_f16 v216, v199, v149 op_sel:[1,0] op_sel_hi:[1,1]
    v_pk_mul_f16 v217, v199, v150 op_sel:[1,0] op_sel_hi:[1,1]
    v_pk_mul_f16 v218, v199, v151 op_sel:[1,0] op_sel_hi:[1,1]
    v_pk_mul_f16 v219, v199, v152 op_sel:[1,0] op_sel_hi:[1,1]
    v_mfma_f32_32x32x16_f16 v[68:83], v[232:235], v[224:227], v[68:83]
    ds_read_b128 v[228:231], v1 offset:13520
    v_pk_mul_f16 v220, v206, v163 op_sel:[1,0] op_sel_hi:[1,1]
    v_pk_mul_f16 v221, v206, v164 op_sel:[1,0] op_sel_hi:[1,1]
    v_pk_mul_f16 v222, v206, v165 op_sel:[1,0] op_sel_hi:[1,1]
    v_pk_mul_f16 v223, v206, v166 op_sel:[1,0] op_sel_hi:[1,1]
    v_mfma_f32_32x32x16_f16 v[84:99], v[232:235], v[216:219], v[84:99]
    v_pk_mul_f16 v224, v213, v177 op_sel:[1,0] op_sel_hi:[1,1]
    v_pk_mul_f16 v225, v213, v178 op_sel:[1,0] op_sel_hi:[1,1]
    v_pk_mul_f16 v226, v213, v179 op_sel:[1,0] op_sel_hi:[1,1]
    v_pk_mul_f16 v227, v213, v180 op_sel:[1,0] op_sel_hi:[1,1]
    v_mfma_f32_32x32x16_f16 v[100:115], v[232:235], v[220:223], v[100:115]
    v_pk_mul_f16 v216, v192, v139 op_sel:[1,0] op_sel_hi:[1,1]
    v_pk_mul_f16 v217, v192, v140 op_sel:[1,0] op_sel_hi:[1,1]
    v_pk_mul_f16 v218, v192, v141 op_sel:[1,0] op_sel_hi:[1,1]
    v_pk_mul_f16 v219, v192, v142 op_sel:[1,0] op_sel_hi:[1,1]
    v_mfma_f32_32x32x16_f16 v[116:131], v[232:235], v[224:227], v[116:131]
    v_pk_mul_f16 v220, v199, v153 op_sel:[1,0] op_sel_hi:[1,1]
    v_pk_mul_f16 v221, v199, v154 op_sel:[1,0] op_sel_hi:[1,1]
    v_pk_mul_f16 v222, v199, v155 op_sel:[1,0] op_sel_hi:[1,1]
    v_pk_mul_f16 v223, v199, v156 op_sel:[1,0] op_sel_hi:[1,1]
    s_waitcnt lgkmcnt(0)
    v_mfma_f32_32x32x16_f16 v[68:83], v[236:239], v[216:219], v[68:83]
    ds_read_b128 v[232:235], v1 offset:14560
    v_pk_mul_f16 v224, v206, v167 op_sel:[1,0] op_sel_hi:[1,1]
    v_pk_mul_f16 v225, v206, v168 op_sel:[1,0] op_sel_hi:[1,1]
    v_pk_mul_f16 v226, v206, v169 op_sel:[1,0] op_sel_hi:[1,1]
    v_pk_mul_f16 v227, v206, v170 op_sel:[1,0] op_sel_hi:[1,1]
    v_mfma_f32_32x32x16_f16 v[84:99], v[236:239], v[220:223], v[84:99]
    v_pk_mul_f16 v216, v213, v181 op_sel:[1,0] op_sel_hi:[1,1]
    v_pk_mul_f16 v217, v213, v182 op_sel:[1,0] op_sel_hi:[1,1]
    v_pk_mul_f16 v218, v213, v183 op_sel:[1,0] op_sel_hi:[1,1]
    v_pk_mul_f16 v219, v213, v184 op_sel:[1,0] op_sel_hi:[1,1]
    v_mfma_f32_32x32x16_f16 v[100:115], v[236:239], v[224:227], v[100:115]
    v_pk_mul_f16 v220, v192, v143 op_sel:[1,0] op_sel_hi:[1,1]
    v_pk_mul_f16 v221, v192, v144 op_sel:[1,0] op_sel_hi:[1,1]
    v_pk_mul_f16 v222, v193, v132 op_sel_hi:[0,1]
    v_pk_mul_f16 v223, v193, v133 op_sel_hi:[0,1]
    v_mfma_f32_32x32x16_f16 v[116:131], v[236:239], v[216:219], v[116:131]
    v_pk_mul_f16 v224, v199, v157 op_sel:[1,0] op_sel_hi:[1,1]
    v_pk_mul_f16 v225, v199, v158 op_sel:[1,0] op_sel_hi:[1,1]
    v_pk_mul_f16 v226, v200, v146 op_sel_hi:[0,1]
    v_pk_mul_f16 v227, v200, v147 op_sel_hi:[0,1]
    v_mfma_f32_32x32x16_f16 v[68:83], v[240:243], v[220:223], v[68:83]
    ds_read_b128 v[236:239], v1 offset:15600
    v_pk_mul_f16 v216, v206, v171 op_sel:[1,0] op_sel_hi:[1,1]
    v_pk_mul_f16 v217, v206, v172 op_sel:[1,0] op_sel_hi:[1,1]
    v_pk_mul_f16 v218, v207, v160 op_sel_hi:[0,1]
    v_pk_mul_f16 v219, v207, v161 op_sel_hi:[0,1]
    v_mfma_f32_32x32x16_f16 v[84:99], v[240:243], v[224:227], v[84:99]
    v_pk_mul_f16 v220, v213, v185 op_sel:[1,0] op_sel_hi:[1,1]
    v_pk_mul_f16 v221, v213, v186 op_sel:[1,0] op_sel_hi:[1,1]
    v_pk_mul_f16 v222, v214, v174 op_sel_hi:[0,1]
    v_pk_mul_f16 v223, v214, v175 op_sel_hi:[0,1]
    v_mfma_f32_32x32x16_f16 v[100:115], v[240:243], v[216:219], v[100:115]
    v_pk_mul_f16 v224, v193, v134 op_sel_hi:[0,1]
    v_pk_mul_f16 v225, v193, v135 op_sel_hi:[0,1]
    v_pk_mul_f16 v226, v193, v136 op_sel_hi:[0,1]
    v_pk_mul_f16 v227, v193, v137 op_sel_hi:[0,1]
    v_mfma_f32_32x32x16_f16 v[116:131], v[240:243], v[220:223], v[116:131]
    v_pk_mul_f16 v216, v200, v148 op_sel_hi:[0,1]
    v_pk_mul_f16 v217, v200, v149 op_sel_hi:[0,1]
    v_pk_mul_f16 v218, v200, v150 op_sel_hi:[0,1]
    v_pk_mul_f16 v219, v200, v151 op_sel_hi:[0,1]
    v_mfma_f32_32x32x16_f16 v[68:83], v[228:231], v[224:227], v[68:83]
    ds_read_b128 v[240:243], v1 offset:16640
    v_pk_mul_f16 v220, v207, v162 op_sel_hi:[0,1]
    v_pk_mul_f16 v221, v207, v163 op_sel_hi:[0,1]
    v_pk_mul_f16 v222, v207, v164 op_sel_hi:[0,1]
    v_pk_mul_f16 v223, v207, v165 op_sel_hi:[0,1]
    v_mfma_f32_32x32x16_f16 v[84:99], v[228:231], v[216:219], v[84:99]
    v_pk_mul_f16 v224, v214, v176 op_sel_hi:[0,1]
    v_pk_mul_f16 v225, v214, v177 op_sel_hi:[0,1]
    v_pk_mul_f16 v226, v214, v178 op_sel_hi:[0,1]
    v_pk_mul_f16 v227, v214, v179 op_sel_hi:[0,1]
    v_mfma_f32_32x32x16_f16 v[100:115], v[228:231], v[220:223], v[100:115]
    v_pk_mul_f16 v216, v193, v138 op_sel_hi:[0,1]
    v_pk_mul_f16 v217, v193, v139 op_sel_hi:[0,1]
    v_pk_mul_f16 v218, v193, v140 op_sel_hi:[0,1]
    v_pk_mul_f16 v219, v193, v141 op_sel_hi:[0,1]
    v_mfma_f32_32x32x16_f16 v[116:131], v[228:231], v[224:227], v[116:131]
    v_pk_mul_f16 v220, v200, v152 op_sel_hi:[0,1]
    v_pk_mul_f16 v221, v200, v153 op_sel_hi:[0,1]
    v_pk_mul_f16 v222, v200, v154 op_sel_hi:[0,1]
    v_pk_mul_f16 v223, v200, v155 op_sel_hi:[0,1]
    s_waitcnt lgkmcnt(0)
    v_mfma_f32_32x32x16_f16 v[68:83], v[232:235], v[216:219], v[68:83]
    ds_read_b128 v[228:231], v1 offset:17680
    v_pk_mul_f16 v224, v207, v166 op_sel_hi:[0,1]
    v_pk_mul_f16 v225, v207, v167 op_sel_hi:[0,1]
    v_pk_mul_f16 v226, v207, v168 op_sel_hi:[0,1]
    v_pk_mul_f16 v227, v207, v169 op_sel_hi:[0,1]
    v_mfma_f32_32x32x16_f16 v[84:99], v[232:235], v[220:223], v[84:99]
    v_pk_mul_f16 v216, v214, v180 op_sel_hi:[0,1]
    v_pk_mul_f16 v217, v214, v181 op_sel_hi:[0,1]
    v_pk_mul_f16 v218, v214, v182 op_sel_hi:[0,1]
    v_pk_mul_f16 v219, v214, v183 op_sel_hi:[0,1]
    v_mfma_f32_32x32x16_f16 v[100:115], v[232:235], v[224:227], v[100:115]
    v_pk_mul_f16 v220, v193, v142 op_sel_hi:[0,1]
    v_pk_mul_f16 v221, v193, v143 op_sel_hi:[0,1]
    v_pk_mul_f16 v222, v193, v144 op_sel_hi:[0,1]
    v_pk_mul_f16 v223, v193, v132 op_sel:[1,0] op_sel_hi:[1,1]
    v_mfma_f32_32x32x16_f16 v[116:131], v[232:235], v[216:219], v[116:131]
    v_pk_mul_f16 v224, v200, v156 op_sel_hi:[0,1]
    v_pk_mul_f16 v225, v200, v157 op_sel_hi:[0,1]
    v_pk_mul_f16 v226, v200, v158 op_sel_hi:[0,1]
    v_pk_mul_f16 v227, v200, v146 op_sel:[1,0] op_sel_hi:[1,1]
    v_mfma_f32_32x32x16_f16 v[68:83], v[236:239], v[220:223], v[68:83]
    ds_read_b128 v[232:235], v1 offset:18720
    v_pk_mul_f16 v216, v207, v170 op_sel_hi:[0,1]
    v_pk_mul_f16 v217, v207, v171 op_sel_hi:[0,1]
    v_pk_mul_f16 v218, v207, v172 op_sel_hi:[0,1]
    v_pk_mul_f16 v219, v207, v160 op_sel:[1,0] op_sel_hi:[1,1]
    v_mov_b32 v3, 160016
    v_mfma_f32_32x32x16_f16 v[84:99], v[236:239], v[224:227], v[84:99]
    v_pk_mul_f16 v220, v214, v184 op_sel_hi:[0,1]
    v_pk_mul_f16 v221, v214, v185 op_sel_hi:[0,1]
    v_pk_mul_f16 v222, v214, v186 op_sel_hi:[0,1]
    v_pk_mul_f16 v223, v214, v174 op_sel:[1,0] op_sel_hi:[1,1]
    ds_read_b32 v2, v3
    v_mfma_f32_32x32x16_f16 v[100:115], v[236:239], v[216:219], v[100:115]
    v_pk_mul_f16 v224, v193, v133 op_sel:[1,0] op_sel_hi:[1,1]
    v_pk_mul_f16 v225, v193, v134 op_sel:[1,0] op_sel_hi:[1,1]
    v_pk_mul_f16 v226, v193, v135 op_sel:[1,0] op_sel_hi:[1,1]
    v_pk_mul_f16 v227, v193, v136 op_sel:[1,0] op_sel_hi:[1,1]
    v_mfma_f32_32x32x16_f16 v[116:131], v[236:239], v[220:223], v[116:131]
    v_pk_mul_f16 v216, v200, v147 op_sel:[1,0] op_sel_hi:[1,1]
    v_pk_mul_f16 v217, v200, v148 op_sel:[1,0] op_sel_hi:[1,1]
    v_pk_mul_f16 v218, v200, v149 op_sel:[1,0] op_sel_hi:[1,1]
    v_pk_mul_f16 v219, v200, v150 op_sel:[1,0] op_sel_hi:[1,1]
    v_mfma_f32_32x32x16_f16 v[68:83], v[240:243], v[224:227], v[68:83]
    ds_read_b128 v[236:239], v1 offset:19760
    v_pk_mul_f16 v220, v207, v161 op_sel:[1,0] op_sel_hi:[1,1]
    v_pk_mul_f16 v221, v207, v162 op_sel:[1,0] op_sel_hi:[1,1]
    v_pk_mul_f16 v222, v207, v163 op_sel:[1,0] op_sel_hi:[1,1]
    v_pk_mul_f16 v223, v207, v164 op_sel:[1,0] op_sel_hi:[1,1]
    v_mfma_f32_32x32x16_f16 v[84:99], v[240:243], v[216:219], v[84:99]
    v_pk_mul_f16 v224, v214, v175 op_sel:[1,0] op_sel_hi:[1,1]
    v_pk_mul_f16 v225, v214, v176 op_sel:[1,0] op_sel_hi:[1,1]
    v_pk_mul_f16 v226, v214, v177 op_sel:[1,0] op_sel_hi:[1,1]
    v_pk_mul_f16 v227, v214, v178 op_sel:[1,0] op_sel_hi:[1,1]
    v_mfma_f32_32x32x16_f16 v[100:115], v[240:243], v[220:223], v[100:115]
    v_pk_mul_f16 v216, v193, v137 op_sel:[1,0] op_sel_hi:[1,1]
    v_pk_mul_f16 v217, v193, v138 op_sel:[1,0] op_sel_hi:[1,1]
    v_pk_mul_f16 v218, v193, v139 op_sel:[1,0] op_sel_hi:[1,1]
    v_pk_mul_f16 v219, v193, v140 op_sel:[1,0] op_sel_hi:[1,1]
    v_mfma_f32_32x32x16_f16 v[116:131], v[240:243], v[224:227], v[116:131]
    v_pk_mul_f16 v220, v200, v151 op_sel:[1,0] op_sel_hi:[1,1]
    v_pk_mul_f16 v221, v200, v152 op_sel:[1,0] op_sel_hi:[1,1]
    v_pk_mul_f16 v222, v200, v153 op_sel:[1,0] op_sel_hi:[1,1]
    v_pk_mul_f16 v223, v200, v154 op_sel:[1,0] op_sel_hi:[1,1]
    s_waitcnt lgkmcnt(0)
    v_mfma_f32_32x32x16_f16 v[68:83], v[228:231], v[216:219], v[68:83]
    ds_read_b128 v[240:243], v1 offset:20800
    v_pk_mul_f16 v224, v207, v165 op_sel:[1,0] op_sel_hi:[1,1]
    v_pk_mul_f16 v225, v207, v166 op_sel:[1,0] op_sel_hi:[1,1]
    v_pk_mul_f16 v226, v207, v167 op_sel:[1,0] op_sel_hi:[1,1]
    v_pk_mul_f16 v227, v207, v168 op_sel:[1,0] op_sel_hi:[1,1]
    v_readfirstlane_b32 s74, v2
    v_mfma_f32_32x32x16_f16 v[84:99], v[228:231], v[220:223], v[84:99]
    v_pk_mul_f16 v216, v214, v179 op_sel:[1,0] op_sel_hi:[1,1]
    v_pk_mul_f16 v217, v214, v180 op_sel:[1,0] op_sel_hi:[1,1]
    v_pk_mul_f16 v218, v214, v181 op_sel:[1,0] op_sel_hi:[1,1]
    v_pk_mul_f16 v219, v214, v182 op_sel:[1,0] op_sel_hi:[1,1]
    s_cmp_lt_u32 s74, 4
    s_cbranch_scc1 L_cs_9
L_cb_10:
    v_mfma_f32_32x32x16_f16 v[100:115], v[228:231], v[224:227], v[100:115]
    v_pk_mul_f16 v220, v193, v141 op_sel:[1,0] op_sel_hi:[1,1]
    v_pk_mul_f16 v221, v193, v142 op_sel:[1,0] op_sel_hi:[1,1]
    v_pk_mul_f16 v222, v193, v143 op_sel:[1,0] op_sel_hi:[1,1]
    v_pk_mul_f16 v223, v193, v144 op_sel:[1,0] op_sel_hi:[1,1]
    v_mfma_f32_32x32x16_f16 v[116:131], v[228:231], v[216:219], v[116:131]
    v_pk_mul_f16 v224, v200, v155 op_sel:[1,0] op_sel_hi:[1,1]
    v_pk_mul_f16 v225, v200, v156 op_sel:[1,0] op_sel_hi:[1,1]
    v_pk_mul_f16 v226, v200, v157 op_sel:[1,0] op_sel_hi:[1,1]
    v_pk_mul_f16 v227, v200, v158 op_sel:[1,0] op_sel_hi:[1,1]
    v_mfma_f32_32x32x16_f16 v[68:83], v[232:235], v[220:223], v[68:83]
    ds_read_b128 v[228:231], v1 offset:21840
    v_pk_mul_f16 v216, v207, v169 op_sel:[1,0] op_sel_hi:[1,1]
    v_pk_mul_f16 v217, v207, v170 op_sel:[1,0] op_sel_hi:[1,1]
    v_pk_mul_f16 v218, v207, v171 op_sel:[1,0] op_sel_hi:[1,1]
    v_pk_mul_f16 v219, v207, v172 op_sel:[1,0] op_sel_hi:[1,1]
    v_mfma_f32_32x32x16_f16 v[84:99], v[232:235], v[224:227], v[84:99]
    v_pk_mul_f16 v220, v214, v183 op_sel:[1,0] op_sel_hi:[1,1]
    v_pk_mul_f16 v221, v214, v184 op_sel:[1,0] op_sel_hi:[1,1]
    v_pk_mul_f16 v222, v214, v185 op_sel:[1,0] op_sel_hi:[1,1]
    v_pk_mul_f16 v223, v214, v186 op_sel:[1,0] op_sel_hi:[1,1]
    v_mfma_f32_32x32x16_f16 v[100:115], v[232:235], v[216:219], v[100:115]
    v_pk_mul_f16 v224, v194, v132 op_sel_hi:[0,1]
    v_pk_mul_f16 v225, v194, v133 op_sel_hi:[0,1]
    v_pk_mul_f16 v226, v194, v134 op_sel_hi:[0,1]
    v_pk_mul_f16 v227, v194, v135 op_sel_hi:[0,1]
    v_mfma_f32_32x32x16_f16 v[116:131], v[232:235], v[220:223], v[116:131]
    v_pk_mul_f16 v216, v201, v146 op_sel_hi:[0,1]
    v_pk_mul_f16 v217, v201, v147 op_sel_hi:[0,1]
    v_pk_mul_f16 v218, v201, v148 op_sel_hi:[0,1]
    v_pk_mul_f16 v219, v201, v149 op_sel_hi:[0,1]
    v_mfma_f32_32x32x16_f16 v[68:83], v[236:239], v[224:227], v[68:83]
    ds_read_b128 v[232:235], v1 offset:22880
    v_pk_mul_f16 v220, v208, v160 op_sel_hi:[0,1]
    v_pk_mul_f16 v221, v208, v161 op_sel_hi:[0,1]
    v_pk_mul_f16 v222, v208, v162 op_sel_hi:[0,1]
    v_pk_mul_f16 v223, v208, v163 op_sel_hi:[0,1]
    v_mfma_f32_32x32x16_f16 v[84:99], v[236:239], v[216:219], v[84:99]
    v_pk_mul_f16 v224, v215, v174 op_sel_hi:[0,1]
    v_pk_mul_f16 v225, v215, v175 op_sel_hi:[0,1]
    v_pk_mul_f16 v226, v215, v176 op_sel_hi:[0,1]
    v_pk_mul_f16 v227, v215, v177 op_sel_hi:[0,1]
    v_mfma_f32_32x32x16_f16 v[100:115], v[236:239], v[220:223], v[100:115]
    v_pk_mul_f16 v216, v194, v136 op_sel_hi:[0,1]
    v_pk_mul_f16 v217, v194, v137 op_sel_hi:[0,1]
    v_pk_mul_f16 v218, v194, v138 op_sel_hi:[0,1]
    v_pk_mul_f16 v219, v194, v139 op_sel_hi:[0,1]
    v_mfma_f32_32x32x16_f16 v[116:131], v[236:239], v[224:227], v[116:131]
    v_pk_mul_f16 v220, v201, v150 op_sel_hi:[0,1]
    v_pk_mul_f16 v221, v201, v151 op_sel_hi:[0,1]
    v_pk_mul_f16 v222, v201, v152 op_sel_hi:[0,1]
    v_pk_mul_f16 v223, v201, v153 op_sel_hi:[0,1]
    s_waitcnt lgkmcnt(0)
    v_mfma_f32_32x32x16_f16 v[68:83], v[240:243], v[216:219], v[68:83]
    v_add_u32 v1, 4294901440, v1
    ds_read_b128 v[236:239], v1 offset:0
    v_pk_mul_f16 v224, v208, v164 op_sel_hi:[0,1]
    v_pk_mul_f16 v225, v208, v165 op_sel_hi:[0,1]
    v_pk_mul_f16 v226, v208, v166 op_sel_hi:[0,1]
    v_pk_mul_f16 v227, v208, v167 op_sel_hi:[0,1]
    v_mfma_f32_32x32x16_f16 v[84:99], v[240:243], v[220:223], v[84:99]
    v_pk_mul_f16 v216, v215, v178 op_sel_hi:[0,1]
    v_pk_mul_f16 v217, v215, v179 op_sel_hi:[0,1]
    v_pk_mul_f16 v218, v215, v180 op_sel_hi:[0,1]
    v_pk_mul_f16 v219, v215, v181 op_sel_hi:[0,1]
    v_mfma_f32_32x32x16_f16 v[100:115], v[240:243], v[224:227], v[100:115]
    v_pk_mul_f16 v220, v194, v140 op_sel_hi:[0,1]
    v_pk_mul_f16 v221, v194, v141 op_sel_hi:[0,1]
    v_pk_mul_f16 v222, v194, v142 op_sel_hi:[0,1]
    v_pk_mul_f16 v223, v194, v143 op_sel_hi:[0,1]
    v_mfma_f32_32x32x16_f16 v[116:131], v[240:243], v[216:219], v[116:131]
    v_pk_mul_f16 v224, v194, v144 op_sel_hi:[0,1]
    v_mov_b32 v225, 0
    v_mov_b32 v226, 0
    v_mov_b32 v227, 0
    v_mfma_f32_32x32x16_f16 v[68:83], v[228:231], v[220:223], v[68:83]
    ds_read_b128 v[240:243], v1 offset:1024
    v_pk_mul_f16 v216, v201, v154 op_sel_hi:[0,1]
    v_pk_mul_f16 v217, v201, v155 op_sel_hi:[0,1]
    v_pk_mul_f16 v218, v201, v156 op_sel_hi:[0,1]
    v_pk_mul_f16 v219, v201, v157 op_sel_hi:[0,1]
    v_mov_b32 v2, 1
    v_mfma_f32_32x32x16_f16 v[68:83], v[232:235], v[224:227], v[68:83]
    v_pk_mul_f16 v220, v201, v158 op_sel_hi:[0,1]
    v_mov_b32 v221, 0
    v_mov_b32 v222, 0
    v_mov_b32 v223, 0
    v_add_u32 v3, 160116, v1
    ds_add_u32 v3, v2
    v_mfma_f32_32x32x16_f16 v[84:99], v[228:231], v[216:219], v[84:99]
    v_pk_mul_f16 v224, v208, v168 op_sel_hi:[0,1]
    v_pk_mul_f16 v225, v208, v169 op_sel_hi:[0,1]
    v_pk_mul_f16 v226, v208, v170 op_sel_hi:[0,1]
    v_pk_mul_f16 v227, v208, v171 op_sel_hi:[0,1]
    v_mfma_f32_32x32x16_f16 v[84:99], v[232:235], v[220:223], v[84:99]
    v_max3_f32 v244, |v68|, |v69|, |v70|
    v_max3_f32 v252, |v71|, |v72|, |v73|
    v_max3_f32 v244, v244, |v74|, |v75|
    v_max3_f32 v252, v252, |v76|, |v77|
    v_max3_f32 v244, v244, |v78|, |v79|
    v_pk_mul_f16 v216, v208, v172 op_sel_hi:[0,1]
    v_mov_b32 v217, 0
    v_mov_b32 v218, 0
    v_mov_b32 v219, 0
    v_mfma_f32_32x32x16_f16 v[100:115], v[228:231], v[224:227], v[100:115]
    v_max3_f32 v244, v244, v252, |v80|
    v_mov_b32 v252, v244
    v_cvt_pk_f16_f32 v188, v68, v69
    v_cvt_pk_f16_f32 v189, v70, v71
    v_permlane32_swap_b32 v244, v252
    v_pk_mul_f16 v220, v215, v182 op_sel_hi:[0,1]
    v_pk_mul_f16 v221, v215, v183 op_sel_hi:[0,1]
    v_pk_mul_f16 v222, v215, v184 op_sel_hi:[0,1]
    v_pk_mul_f16 v223, v215, v185 op_sel_hi:[0,1]
    v_mfma_f32_32x32x16_f16 v[100:115], v[232:235], v[216:219], v[100:115]
    v_max3_f32 v244, v244, v252, s81
    v_lshrrev_b32 v252, 23, v244
    v_sub_u32 v244, s80, v252
    v_lshlrev_b32 v244, 10, v244
    v_pk_mul_f16 v188, v188, v244 op_sel_hi:[1,0]
    v_pk_mul_f16 v224, v215, v186 op_sel_hi:[0,1]
    v_mov_b32 v225, 0
    v_mov_b32 v226, 0
    v_mov_b32 v227, 0
    v_mfma_f32_32x32x16_f16 v[116:131], v[228:231], v[220:223], v[116:131]
    v_max3_f32 v245, |v84|, |v85|, |v86|
    v_max3_f32 v253, |v87|, |v88|, |v89|
    v_max3_f32 v245, v245, |v90|, |v91|
    v_max3_f32 v253, v253, |v92|, |v93|
    v_max3_f32 v245, v245, |v94|, |v95|
    v_pk_mul_f16 v216, v188, v132 op_sel_hi:[0,1]
    v_pk_mul_f16 v217, v188, v133 op_sel_hi:[0,1]
    v_pk_mul_f16 v218, v188, v134 op_sel_hi:[0,1]
    v_pk_mul_f16 v219, v188, v135 op_sel_hi:[0,1]
    v_mfma_f32_32x32x16_f16 v[116:131], v[232:235], v[224:227], v[116:131]
    ds_read_b128 v[228:231], v1 offset:2048
    v_max3_f32 v245, v245, v253, |v96|
    v_mov_b32 v253, v245
    v_cvt_pk_f16_f32 v195, v84, v85
    v_cvt_pk_f16_f32 v196, v86, v87
    v_permlane32_swap_b32 v245, v253
    v_pk_mul_f16 v220, v188, v136 op_sel_hi:[0,1]
    v_pk_mul_f16 v221, v188, v137 op_sel_hi:[0,1]
    v_pk_mul_f16 v222, v188, v138 op_sel_hi:[0,1]
    v_pk_mul_f16 v223, v188, v139 op_sel_hi:[0,1]
    s_waitcnt lgkmcnt(1)
    v_mfma_f32_32x32x16_f16 v[4:19], v[236:239], v[216:219], 0
    ds_read_b128 v[232:235], v1 offset:3072
    v_max3_f32 v245, v245, v253, s81
    v_lshrrev_b32 v253, 23, v245
    v_sub_u32 v245, s80, v253
    v_lshlrev_b32 v245, 10, v245
    v_pk_mul_f16 v195, v195, v245 op_sel_hi:[1,0]
    v_pk_mul_f16 v224, v195, v146 op_sel_hi:[0,1]
    v_pk_mul_f16 v225, v195, v147 op_sel_hi:[0,1]
    v_pk_mul_f16 v226, v195, v148 op_sel_hi:[0,1]
    v_pk_mul_f16 v227, v195, v149 op_sel_hi:[0,1]
    v_mfma_f32_32x32x16_f16 v[4:19], v[240:243], v[220:223], v[4:19]
    v_max3_f32 v246, |v100|, |v101|, |v102|
    v_max3_f32 v254, |v103|, |v104|, |v105|
    v_max3_f32 v246, v246, |v106|, |v107|
    v_max3_f32 v254, v254, |v108|, |v109|
    v_max3_f32 v246, v246, |v110|, |v111|
    v_pk_mul_f16 v216, v195, v150 op_sel_hi:[0,1]
    v_pk_mul_f16 v217, v195, v151 op_sel_hi:[0,1]
    v_pk_mul_f16 v218, v195, v152 op_sel_hi:[0,1]
    v_pk_mul_f16 v219, v195, v153 op_sel_hi:[0,1]
    v_mfma_f32_32x32x16_f16 v[20:35], v[236:239], v[224:227], 0
    v_max3_f32 v246, v246, v254, |v112|
    v_mov_b32 v254, v246
    v_cvt_pk_f16_f32 v202, v100, v101
    v_cvt_pk_f16_f32 v203, v102, v103
    v_permlane32_swap_b32 v246, v254
    v_max3_f32 v246, v246, v254, s81
    v_lshrrev_b32 v254, 23, v246
    v_sub_u32 v246, s80, v254
    v_lshlrev_b32 v246, 10, v246
    v_pk_mul_f16 v202, v202, v246 op_sel_hi:[1,0]
    v_pk_mul_f16 v220, v202, v160 op_sel_hi:[0,1]
    v_pk_mul_f16 v221, v202, v161 op_sel_hi:[0,1]
    v_pk_mul_f16 v222, v202, v162 op_sel_hi:[0,1]
    v_pk_mul_f16 v223, v202, v163 op_sel_hi:[0,1]
    v_mfma_f32_32x32x16_f16 v[20:35], v[240:243], v[216:219], v[20:35]
    v_max3_f32 v247, |v116|, |v117|, |v118|
    v_max3_f32 v255, |v119|, |v120|, |v121|
    v_max3_f32 v247, v247, |v122|, |v123|
    v_max3_f32 v255, v255, |v124|, |v125|
    v_max3_f32 v247, v247, |v126|, |v127|
    v_pk_mul_f16 v224, v202, v164 op_sel_hi:[0,1]
    v_pk_mul_f16 v225, v202, v165 op_sel_hi:[0,1]
    v_pk_mul_f16 v226, v202, v166 op_sel_hi:[0,1]
    v_pk_mul_f16 v227, v202, v167 op_sel_hi:[0,1]
    v_mfma_f32_32x32x16_f16 v[36:51], v[236:239], v[220:223], 0
    v_max3_f32 v247, v247, v255, |v128|
    v_mov_b32 v255, v247
    v_cvt_pk_f16_f32 v209, v116, v117
    v_cvt_pk_f16_f32 v210, v118, v119
    v_permlane32_swap_b32 v247, v255
    v_max3_f32 v247, v247, v255, s81
    v_lshrrev_b32 v255, 23, v247
    v_sub_u32 v247, s80, v255
    v_lshlrev_b32 v247, 10, v247
    v_pk_mul_f16 v209, v209, v247 op_sel_hi:[1,0]
    v_pk_mul_f16 v216, v209, v174 op_sel_hi:[0,1]
    v_pk_mul_f16 v217, v209, v175 op_sel_hi:[0,1]
    v_pk_mul_f16 v218, v209, v176 op_sel_hi:[0,1]
    v_pk_mul_f16 v219, v209, v177 op_sel_hi:[0,1]
    v_mfma_f32_32x32x16_f16 v[36:51], v[240:243], v[224:227], v[36:51]
    v_pk_mul_f16 v220, v209, v178 op_sel_hi:[0,1]
    v_pk_mul_f16 v221, v209, v179 op_sel_hi:[0,1]
    v_pk_mul_f16 v222, v209, v180 op_sel_hi:[0,1]
    v_pk_mul_f16 v223, v209, v181 op_sel_hi:[0,1]
    v_mfma_f32_32x32x16_f16 v[52:67], v[236:239], v[216:219], 0
    v_pk_mul_f16 v224, v188, v140 op_sel_hi:[0,1]
    v_pk_mul_f16 v225, v188, v141 op_sel_hi:[0,1]
    v_pk_mul_f16 v226, v188, v142 op_sel_hi:[0,1]
    v_pk_mul_f16 v227, v188, v143 op_sel_hi:[0,1]
    v_mfma_f32_32x32x16_f16 v[52:67], v[240:243], v[220:223], v[52:67]
    ds_read_b128 v[236:239], v1 offset:4096
    v_pk_mul_f16 v216, v195, v154 op_sel_hi:[0,1]
    v_pk_mul_f16 v217, v195, v155 op_sel_hi:[0,1]
    v_pk_mul_f16 v218, v195, v156 op_sel_hi:[0,1]
    v_pk_mul_f16 v219, v195, v157 op_sel_hi:[0,1]
    s_waitcnt lgkmcnt(1)
    v_mfma_f32_32x32x16_f16 v[4:19], v[228:231], v[224:227], v[4:19]
    ds_read_b128 v[240:243], v1 offset:5120
    v_pk_mul_f16 v220, v202, v168 op_sel_hi:[0,1]
    v_pk_mul_f16 v221, v202, v169 op_sel_hi:[0,1]
    v_pk_mul_f16 v222, v202, v170 op_sel_hi:[0,1]
    v_pk_mul_f16 v223, v202, v171 op_sel_hi:[0,1]
    v_pk_mul_f16 v189, v189, v244 op_sel_hi:[1,0]
    v_mfma_f32_32x32x16_f16 v[20:35], v[228:231], v[216:219], v[20:35]
    v_pk_mul_f16 v224, v209, v182 op_sel_hi:[0,1]
    v_pk_mul_f16 v225, v209, v183 op_sel_hi:[0,1]
    v_pk_mul_f16 v226, v209, v184 op_sel_hi:[0,1]
    v_pk_mul_f16 v227, v209, v185 op_sel_hi:[0,1]
    v_pk_mul_f16 v196, v196, v245 op_sel_hi:[1,0]
    v_pk_mul_f16 v203, v203, v246 op_sel_hi:[1,0]
    v_mfma_f32_32x32x16_f16 v[36:51], v[228:231], v[220:223], v[36:51]
    v_pk_mul_f16 v216, v188, v144 op_sel_hi:[0,1]
    v_pk_mul_f16 v217, v188, v132 op_sel:[1,0] op_sel_hi:[1,1]
    v_pk_mul_f16 v218, v188, v133 op_sel:[1,0] op_sel_hi:[1,1]
    v_pk_mul_f16 v219, v188, v134 op_sel:[1,0] op_sel_hi:[1,1]
    v_pk_mul_f16 v210, v210, v247 op_sel_hi:[1,0]
    v_mfma_f32_32x32x16_f16 v[52:67], v[228:231], v[224:227], v[52:67]
    v_pk_mul_f16 v220, v195, v158 op_sel_hi:[0,1]
    v_pk_mul_f16 v221, v195, v146 op_sel:[1,0] op_sel_hi:[1,1]
    v_pk_mul_f16 v222, v195, v147 op_sel:[1,0] op_sel_hi:[1,1]
    v_pk_mul_f16 v223, v195, v148 op_sel:[1,0] op_sel_hi:[1,1]
    v_cvt_pk_f16_f32 v190, v72, v73
    v_mfma_f32_32x32x16_f16 v[4:19], v[232:235], v[216:219], v[4:19]
    ds_read_b128 v[228:231], v1 offset:6144
    v_pk_mul_f16 v224, v202, v172 op_sel_hi:[0,1]
    v_pk_mul_f16 v225, v202, v160 op_sel:[1,0] op_sel_hi:[1,1]
    v_pk_mul_f16 v226, v202, v161 op_sel:[1,0] op_sel_hi:[1,1]
    v_pk_mul_f16 v227, v202, v162 op_sel:[1,0] op_sel_hi:[1,1]
    v_cvt_pk_f16_f32 v197, v88, v89
    v_mfma_f32_32x32x16_f16 v[20:35], v[232:235], v[220:223], v[20:35]
    v_pk_mul_f16 v216, v209, v186 op_sel_hi:[0,1]
    v_pk_mul_f16 v217, v209, v174 op_sel:[1,0] op_sel_hi:[1,1]
    v_pk_mul_f16 v218, v209, v175 op_sel:[1,0] op_sel_hi:[1,1]
    v_pk_mul_f16 v219, v209, v176 op_sel:[1,0] op_sel_hi:[1,1]
    v_cvt_pk_f16_f32 v204, v104, v105
    v_mfma_f32_32x32x16_f16 v[36:51], v[232:235], v[224:227], v[36:51]
    v_pk_mul_f16 v220, v188, v135 op_sel:[1,0] op_sel_hi:[1,1]
    v_pk_mul_f16 v221, v188, v136 op_sel:[1,0] op_sel_hi:[1,1]
    v_pk_mul_f16 v222, v188, v137 op_sel:[1,0] op_sel_hi:[1,1]
    v_pk_mul_f16 v223, v188, v138 op_sel:[1,0] op_sel_hi:[1,1]
    v_cvt_pk_f16_f32 v211, v120, v121
    v_mfma_f32_32x32x16_f16 v[52:67], v[232:235], v[216:219], v[52:67]
    v_pk_mul_f16 v224, v195, v149 op_sel:[1,0] op_sel_hi:[1,1]
    v_pk_mul_f16 v225, v195, v150 op_sel:[1,0] op_sel_hi:[1,1]
    v_pk_mul_f16 v226, v195, v151 op_sel:[1,0] op_sel_hi:[1,1]
    v_pk_mul_f16 v227, v195, v152 op_sel:[1,0] op_sel_hi:[1,1]
    v_pk_mul_f16 v190, v190, v244 op_sel_hi:[1,0]
    s_waitcnt lgkmcnt(0)
    v_mfma_f32_32x32x16_f16 v[4:19], v[236:239], v[220:223], v[4:19]
    ds_read_b128 v[232:235], v1 offset:7168
    v_pk_mul_f16 v216, v202, v163 op_sel:[1,0] op_sel_hi:[1,1]
    v_pk_mul_f16 v217, v202, v164 op_sel:[1,0] op_sel_hi:[1,1]
    v_pk_mul_f16 v218, v202, v165 op_sel:[1,0] op_sel_hi:[1,1]
    v_pk_mul_f16 v219, v202, v166 op_sel:[1,0] op_sel_hi:[1,1]
    v_mov_b32 v3, 464
    v_mfma_f32_32x32x16_f16 v[20:35], v[236:239], v[224:227], v[20:35]
    v_pk_mul_f16 v220, v209, v177 op_sel:[1,0] op_sel_hi:[1,1]
    v_pk_mul_f16 v221, v209, v178 op_sel:[1,0] op_sel_hi:[1,1]
    v_pk_mul_f16 v222, v209, v179 op_sel:[1,0] op_sel_hi:[1,1]
    v_pk_mul_f16 v223, v209, v180 op_sel:[1,0] op_sel_hi:[1,1]
    ds_read_b64 v[2:3], v3
    v_mfma_f32_32x32x16_f16 v[36:51], v[236:239], v[216:219], v[36:51]
    v_pk_mul_f16 v224, v188, v139 op_sel:[1,0] op_sel_hi:[1,1]
    v_pk_mul_f16 v225, v188, v140 op_sel:[1,0] op_sel_hi:[1,1]
    v_pk_mul_f16 v226, v188, v141 op_sel:[1,0] op_sel_hi:[1,1]
    v_pk_mul_f16 v227, v188, v142 op_sel:[1,0] op_sel_hi:[1,1]
    v_pk_mul_f16 v197, v197, v245 op_sel_hi:[1,0]
    v_mfma_f32_32x32x16_f16 v[52:67], v[236:239], v[220:223], v[52:67]
    v_pk_mul_f16 v216, v195, v153 op_sel:[1,0] op_sel_hi:[1,1]
    v_pk_mul_f16 v217, v195, v154 op_sel:[1,0] op_sel_hi:[1,1]
    v_pk_mul_f16 v218, v195, v155 op_sel:[1,0] op_sel_hi:[1,1]
    v_pk_mul_f16 v219, v195, v156 op_sel:[1,0] op_sel_hi:[1,1]
    v_pk_mul_f16 v204, v204, v246 op_sel_hi:[1,0]
    v_mfma_f32_32x32x16_f16 v[4:19], v[240:243], v[224:227], v[4:19]
    ds_read_b128 v[236:239], v1 offset:8192
    v_pk_mul_f16 v220, v202, v167 op_sel:[1,0] op_sel_hi:[1,1]
    v_pk_mul_f16 v221, v202, v168 op_sel:[1,0] op_sel_hi:[1,1]
    v_pk_mul_f16 v222, v202, v169 op_sel:[1,0] op_sel_hi:[1,1]
    v_pk_mul_f16 v223, v202, v170 op_sel:[1,0] op_sel_hi:[1,1]
    v_pk_mul_f16 v211, v211, v247 op_sel_hi:[1,0]
    v_mfma_f32_32x32x16_f16 v[20:35], v[240:243], v[216:219], v[20:35]
    v_pk_mul_f16 v224, v209, v181 op_sel:[1,0] op_sel_hi:[1,1]
    v_pk_mul_f16 v225, v209, v182 op_sel:[1,0] op_sel_hi:[1,1]
    v_pk_mul_f16 v226, v209, v183 op_sel:[1,0] op_sel_hi:[1,1]
    v_pk_mul_f16 v227, v209, v184 op_sel:[1,0] op_sel_hi:[1,1]
    v_cvt_pk_f16_f32 v191, v74, v75
    v_mfma_f32_32x32x16_f16 v[36:51], v[240:243], v[220:223], v[36:51]
    v_pk_mul_f16 v216, v188, v143 op_sel:[1,0] op_sel_hi:[1,1]
    v_pk_mul_f16 v217, v188, v144 op_sel:[1,0] op_sel_hi:[1,1]
    v_pk_mul_f16 v218, v189, v132 op_sel_hi:[0,1]
    v_pk_mul_f16 v219, v189, v133 op_sel_hi:[0,1]
    v_cvt_pk_f16_f32 v198, v90, v91
    v_mfma_f32_32x32x16_f16 v[52:67], v[240:243], v[224:227], v[52:67]
    v_pk_mul_f16 v220, v195, v157 op_sel:[1,0] op_sel_hi:[1,1]
    v_pk_mul_f16 v221, v195, v158 op_sel:[1,0] op_sel_hi:[1,1]
    v_pk_mul_f16 v222, v196, v146 op_sel_hi:[0,1]
    v_pk_mul_f16 v223, v196, v147 op_sel_hi:[0,1]
    v_cvt_pk_f16_f32 v205, v106, v107
    v_mfma_f32_32x32x16_f16 v[4:19], v[228:231], v[216:219], v[4:19]
    ds_read_b128 v[240:243], v1 offset:9216
    v_pk_mul_f16 v224, v202, v171 op_sel:[1,0] op_sel_hi:[1,1]
    v_pk_mul_f16 v225, v202, v172 op_sel:[1,0] op_sel_hi:[1,1]
    v_pk_mul_f16 v226, v203, v160 op_sel_hi:[0,1]
    v_pk_mul_f16 v227, v203, v161 op_sel_hi:[0,1]
    v_cvt_pk_f16_f32 v212, v122, v123
    v_mfma_f32_32x32x16_f16 v[20:35], v[228:231], v[220:223], v[20:35]
    v_pk_mul_f16 v216, v209, v185 op_sel:[1,0] op_sel_hi:[1,1]
    v_pk_mul_f16 v217, v209, v186 op_sel:[1,0] op_sel_hi:[1,1]
    v_pk_mul_f16 v218, v210, v174 op_sel_hi:[0,1]
    v_pk_mul_f16 v219, v210, v175 op_sel_hi:[0,1]
    v_pk_mul_f16 v191, v191, v244 op_sel_hi:[1,0]
    v_mfma_f32_32x32x16_f16 v[36:51], v[228:231], v[224:227], v[36:51]
    v_pk_mul_f16 v220, v189, v134 op_sel_hi:[0,1]
    v_pk_mul_f16 v221, v189, v135 op_sel_hi:[0,1]
    v_pk_mul_f16 v222, v189, v136 op_sel_hi:[0,1]
    v_pk_mul_f16 v223, v189, v137 op_sel_hi:[0,1]
    v_pk_mul_f16 v198, v198, v245 op_sel_hi:[1,0]
    v_mfma_f32_32x32x16_f16 v[52:67], v[228:231], v[216:219], v[52:67]
    v_pk_mul_f16 v224, v196, v148 op_sel_hi:[0,1]
    v_pk_mul_f16 v225, v196, v149 op_sel_hi:[0,1]
    v_pk_mul_f16 v226, v196, v150 op_sel_hi:[0,1]
    v_pk_mul_f16 v227, v196, v151 op_sel_hi:[0,1]
    v_pk_mul_f16 v205, v205, v246 op_sel_hi:[1,0]
    s_waitcnt lgkmcnt(0)
    v_mfma_f32_32x32x16_f16 v[4:19], v[232:235], v[220:223], v[4:19]
    ds_read_b128 v[228:231], v1 offset:10240
    v_pk_mul_f16 v216, v203, v162 op_sel_hi:[0,1]
    v_pk_mul_f16 v217, v203, v163 op_sel_hi:[0,1]
    v_pk_mul_f16 v218, v203, v164 op_sel_hi:[0,1]
    v_pk_mul_f16 v219, v203, v165 op_sel_hi:[0,1]
    v_readfirstlane_b32 s52, v2
    v_mfma_f32_32x32x16_f16 v[20:35], v[232:235], v[224:227], v[20:35]
    v_pk_mul_f16 v220, v210, v176 op_sel_hi:[0,1]
    v_pk_mul_f16 v221, v210, v177 op_sel_hi:[0,1]
    v_pk_mul_f16 v222, v210, v178 op_sel_hi:[0,1]
    v_pk_mul_f16 v223, v210, v179 op_sel_hi:[0,1]
    v_readfirstlane_b32 s53, v3
    s_add_u32 s72, s48, s50
    v_mfma_f32_32x32x16_f16 v[36:51], v[232:235], v[216:219], v[36:51]
    v_pk_mul_f16 v224, v189, v138 op_sel_hi:[0,1]
    v_pk_mul_f16 v225, v189, v139 op_sel_hi:[0,1]
    v_pk_mul_f16 v226, v189, v140 op_sel_hi:[0,1]
    v_pk_mul_f16 v227, v189, v141 op_sel_hi:[0,1]
    s_add_u32 s72, s72, s53
    s_sub_u32 s72, s72, 780
    v_mfma_f32_32x32x16_f16 v[52:67], v[232:235], v[220:223], v[52:67]
    v_pk_mul_f16 v216, v196, v152 op_sel_hi:[0,1]
    v_pk_mul_f16 v217, v196, v153 op_sel_hi:[0,1]
    v_pk_mul_f16 v218, v196, v154 op_sel_hi:[0,1]
    v_pk_mul_f16 v219, v196, v155 op_sel_hi:[0,1]
    s_lshl2_add_u32 s64, s60, s72
    s_lshl2_add_u32 s65, s61, s72
    v_mfma_f32_32x32x16_f16 v[4:19], v[236:239], v[224:227], v[4:19]
    ds_read_b128 v[232:235], v1 offset:11264
    v_pk_mul_f16 v220, v203, v166 op_sel_hi:[0,1]
    v_pk_mul_f16 v221, v203, v167 op_sel_hi:[0,1]
    v_pk_mul_f16 v222, v203, v168 op_sel_hi:[0,1]
    v_pk_mul_f16 v223, v203, v169 op_sel_hi:[0,1]
    s_lshl2_add_u32 s66, s62, s72
    v_mfma_f32_32x32x16_f16 v[20:35], v[236:239], v[216:219], v[20:35]
    v_pk_mul_f16 v224, v210, v180 op_sel_hi:[0,1]
    v_pk_mul_f16 v225, v210, v181 op_sel_hi:[0,1]
    v_pk_mul_f16 v226, v210, v182 op_sel_hi:[0,1]
    v_pk_mul_f16 v227, v210, v183 op_sel_hi:[0,1]
    s_lshl2_add_u32 s67, s63, s72
    v_mov_b32 v3, 472
    v_mfma_f32_32x32x16_f16 v[36:51], v[236:239], v[220:223], v[36:51]
    v_pk_mul_f16 v216, v189, v142 op_sel_hi:[0,1]
    v_pk_mul_f16 v217, v189, v143 op_sel_hi:[0,1]
    v_pk_mul_f16 v218, v189, v144 op_sel_hi:[0,1]
    v_pk_mul_f16 v219, v189, v132 op_sel:[1,0] op_sel_hi:[1,1]
    ds_read_b64 v[2:3], v3
    v_mfma_f32_32x32x16_f16 v[52:67], v[236:239], v[224:227], v[52:67]
    v_pk_mul_f16 v220, v196, v156 op_sel_hi:[0,1]
    v_pk_mul_f16 v221, v196, v157 op_sel_hi:[0,1]
    v_pk_mul_f16 v222, v196, v158 op_sel_hi:[0,1]
    v_pk_mul_f16 v223, v196, v146 op_sel:[1,0] op_sel_hi:[1,1]
    v_pk_mul_f16 v212, v212, v247 op_sel_hi:[1,0]
    v_mfma_f32_32x32x16_f16 v[4:19], v[240:243], v[216:219], v[4:19]
    ds_read_b128 v[236:239], v1 offset:12288
    v_pk_mul_f16 v224, v203, v170 op_sel_hi:[0,1]
    v_pk_mul_f16 v225, v203, v171 op_sel_hi:[0,1]
    v_pk_mul_f16 v226, v203, v172 op_sel_hi:[0,1]
    v_pk_mul_f16 v227, v203, v160 op_sel:[1,0] op_sel_hi:[1,1]
    v_cvt_pk_f16_f32 v192, v76, v77
    v_mfma_f32_32x32x16_f16 v[20:35], v[240:243], v[220:223], v[20:35]
    v_pk_mul_f16 v216, v210, v184 op_sel_hi:[0,1]
    v_pk_mul_f16 v217, v210, v185 op_sel_hi:[0,1]
    v_pk_mul_f16 v218, v210, v186 op_sel_hi:[0,1]
    v_pk_mul_f16 v219, v210, v174 op_sel:[1,0] op_sel_hi:[1,1]
    v_cvt_pk_f16_f32 v199, v92, v93
    v_mfma_f32_32x32x16_f16 v[36:51], v[240:243], v[224:227], v[36:51]
    v_pk_mul_f16 v220, v189, v133 op_sel:[1,0] op_sel_hi:[1,1]
    v_pk_mul_f16 v221, v189, v134 op_sel:[1,0] op_sel_hi:[1,1]
    v_pk_mul_f16 v222, v189, v135 op_sel:[1,0] op_sel_hi:[1,1]
    v_pk_mul_f16 v223, v189, v136 op_sel:[1,0] op_sel_hi:[1,1]
    v_cvt_pk_f16_f32 v206, v108, v109
    v_mfma_f32_32x32x16_f16 v[52:67], v[240:243], v[216:219], v[52:67]
    v_pk_mul_f16 v224, v196, v147 op_sel:[1,0] op_sel_hi:[1,1]
    v_pk_mul_f16 v225, v196, v148 op_sel:[1,0] op_sel_hi:[1,1]
    v_pk_mul_f16 v226, v196, v149 op_sel:[1,0] op_sel_hi:[1,1]
    v_pk_mul_f16 v227, v196, v150 op_sel:[1,0] op_sel_hi:[1,1]
    v_cvt_pk_f16_f32 v213, v124, v125
    s_waitcnt lgkmcnt(0)
    v_mfma_f32_32x32x16_f16 v[4:19], v[228:231], v[220:223], v[4:19]
    ds_read_b128 v[240:243], v1 offset:13312
    v_pk_mul_f16 v216, v203, v161 op_sel:[1,0] op_sel_hi:[1,1]
    v_pk_mul_f16 v217, v203, v162 op_sel:[1,0] op_sel_hi:[1,1]
    v_pk_mul_f16 v218, v203, v163 op_sel:[1,0] op_sel_hi:[1,1]
    v_pk_mul_f16 v219, v203, v164 op_sel:[1,0] op_sel_hi:[1,1]
    v_readfirstlane_b32 s51, v2
    v_mfma_f32_32x32x16_f16 v[20:35], v[228:231], v[224:227], v[20:35]
    v_pk_mul_f16 v220, v210, v175 op_sel:[1,0] op_sel_hi:[1,1]
    v_pk_mul_f16 v221, v210, v176 op_sel:[1,0] op_sel_hi:[1,1]
    v_pk_mul_f16 v222, v210, v177 op_sel:[1,0] op_sel_hi:[1,1]
    v_pk_mul_f16 v223, v210, v178 op_sel:[1,0] op_sel_hi:[1,1]
    s_sub_u32 s72, s51, s53
    s_add_u32 s72, s72, 130
    v_mfma_f32_32x32x16_f16 v[36:51], v[228:231], v[216:219], v[36:51]
    v_pk_mul_f16 v224, v189, v137 op_sel:[1,0] op_sel_hi:[1,1]
    v_pk_mul_f16 v225, v189, v138 op_sel:[1,0] op_sel_hi:[1,1]
    v_pk_mul_f16 v226, v189, v139 op_sel:[1,0] op_sel_hi:[1,1]
    v_pk_mul_f16 v227, v189, v140 op_sel:[1,0] op_sel_hi:[1,1]
    s_sub_u32 s4, s72, s60
    s_sub_u32 s5, s72, s61
    v_mfma_f32_32x32x16_f16 v[52:67], v[228:231], v[220:223], v[52:67]
    v_pk_mul_f16 v216, v196, v151 op_sel:[1,0] op_sel_hi:[1,1]
    v_pk_mul_f16 v217, v196, v152 op_sel:[1,0] op_sel_hi:[1,1]
    v_pk_mul_f16 v218, v196, v153 op_sel:[1,0] op_sel_hi:[1,1]
    v_pk_mul_f16 v219, v196, v154 op_sel:[1,0] op_sel_hi:[1,1]
    s_sub_u32 s6, s72, s62
    s_sub_u32 s7, s72, s63
    v_mfma_f32_32x32x16_f16 v[4:19], v[232:235], v[224:227], v[4:19]
    ds_read_b128 v[228:231], v1 offset:14336
    v_pk_mul_f16 v220, v203, v165 op_sel:[1,0] op_sel_hi:[1,1]
    v_pk_mul_f16 v221, v203, v166 op_sel:[1,0] op_sel_hi:[1,1]
    v_pk_mul_f16 v222, v203, v167 op_sel:[1,0] op_sel_hi:[1,1]
    v_pk_mul_f16 v223, v203, v168 op_sel:[1,0] op_sel_hi:[1,1]
    v_pk_mul_f16 v192, v192, v244 op_sel_hi:[1,0]
    v_mfma_f32_32x32x16_f16 v[20:35], v[232:235], v[216:219], v[20:35]
    v_pk_mul_f16 v224, v210, v179 op_sel:[1,0] op_sel_hi:[1,1]
    v_pk_mul_f16 v225, v210, v180 op_sel:[1,0] op_sel_hi:[1,1]
    v_pk_mul_f16 v226, v210, v181 op_sel:[1,0] op_sel_hi:[1,1]
    v_pk_mul_f16 v227, v210, v182 op_sel:[1,0] op_sel_hi:[1,1]
    v_pk_mul_f16 v199, v199, v245 op_sel_hi:[1,0]
    v_mfma_f32_32x32x16_f16 v[36:51], v[232:235], v[220:223], v[36:51]
    v_pk_mul_f16 v216, v189, v141 op_sel:[1,0] op_sel_hi:[1,1]
    v_pk_mul_f16 v217, v189, v142 op_sel:[1,0] op_sel_hi:[1,1]
    v_pk_mul_f16 v218, v189, v143 op_sel:[1,0] op_sel_hi:[1,1]
    v_pk_mul_f16 v219, v189, v144 op_sel:[1,0] op_sel_hi:[1,1]
    v_pk_mul_f16 v206, v206, v246 op_sel_hi:[1,0]
    v_mfma_f32_32x32x16_f16 v[52:67], v[232:235], v[224:227], v[52:67]
    v_pk_mul_f16 v220, v196, v155 op_sel:[1,0] op_sel_hi:[1,1]
    v_pk_mul_f16 v221, v196, v156 op_sel:[1,0] op_sel_hi:[1,1]
    v_pk_mul_f16 v222, v196, v157 op_sel:[1,0] op_sel_hi:[1,1]
    v_pk_mul_f16 v223, v196, v158 op_sel:[1,0] op_sel_hi:[1,1]
    v_pk_mul_f16 v213, v213, v247 op_sel_hi:[1,0]
    v_mfma_f32_32x32x16_f16 v[4:19], v[236:239], v[216:219], v[4:19]
    ds_read_b128 v[232:235], v1 offset:15360
    v_pk_mul_f16 v224, v203, v169 op_sel:[1,0] op_sel_hi:[1,1]
    v_pk_mul_f16 v225, v203, v170 op_sel:[1,0] op_sel_hi:[1,1]
    v_pk_mul_f16 v226, v203, v171 op_sel:[1,0] op_sel_hi:[1,1]
    v_pk_mul_f16 v227, v203, v172 op_sel:[1,0] op_sel_hi:[1,1]
    v_cvt_pk_f16_f32 v193, v78, v79
    v_mfma_f32_32x32x16_f16 v[20:35], v[236:239], v[220:223], v[20:35]
    v_pk_mul_f16 v216, v210, v183 op_sel:[1,0] op_sel_hi:[1,1]
    v_pk_mul_f16 v217, v210, v184 op_sel:[1,0] op_sel_hi:[1,1]
    v_pk_mul_f16 v218, v210, v185 op_sel:[1,0] op_sel_hi:[1,1]
    v_pk_mul_f16 v219, v210, v186 op_sel:[1,0] op_sel_hi:[1,1]
    v_cvt_pk_f16_f32 v200, v94, v95
    v_mfma_f32_32x32x16_f16 v[36:51], v[236:239], v[224:227], v[36:51]
    v_pk_mul_f16 v220, v190, v132 op_sel_hi:[0,1]
    v_pk_mul_f16 v221, v190, v133 op_sel_hi:[0,1]
    v_pk_mul_f16 v222, v190, v134 op_sel_hi:[0,1]
    v_pk_mul_f16 v223, v190, v135 op_sel_hi:[0,1]
    v_cvt_pk_f16_f32 v207, v110, v111
    v_mfma_f32_32x32x16_f16 v[52:67], v[236:239], v[216:219], v[52:67]
    v_pk_mul_f16 v224, v197, v146 op_sel_hi:[0,1]
    v_pk_mul_f16 v225, v197, v147 op_sel_hi:[0,1]
    v_pk_mul_f16 v226, v197, v148 op_sel_hi:[0,1]
    v_pk_mul_f16 v227, v197, v149 op_sel_hi:[0,1]
    v_cvt_pk_f16_f32 v214, v126, v127
    s_waitcnt lgkmcnt(0)
    v_mfma_f32_32x32x16_f16 v[4:19], v[240:243], v[220:223], v[4:19]
    ds_read_b128 v[236:239], v1 offset:16384
    v_pk_mul_f16 v216, v204, v160 op_sel_hi:[0,1]
    v_pk_mul_f16 v217, v204, v161 op_sel_hi:[0,1]
    v_pk_mul_f16 v218, v204, v162 op_sel_hi:[0,1]
    v_pk_mul_f16 v219, v204, v163 op_sel_hi:[0,1]
    v_pk_mul_f16 v193, v193, v244 op_sel_hi:[1,0]
    v_mfma_f32_32x32x16_f16 v[20:35], v[240:243], v[224:227], v[20:35]
    v_pk_mul_f16 v220, v211, v174 op_sel_hi:[0,1]
    v_pk_mul_f16 v221, v211, v175 op_sel_hi:[0,1]
    v_pk_mul_f16 v222, v211, v176 op_sel_hi:[0,1]
    v_pk_mul_f16 v223, v211, v177 op_sel_hi:[0,1]
    v_pk_mul_f16 v200, v200, v245 op_sel_hi:[1,0]
    v_mfma_f32_32x32x16_f16 v[36:51], v[240:243], v[216:219], v[36:51]
    v_pk_mul_f16 v224, v190, v136 op_sel_hi:[0,1]
    v_pk_mul_f16 v225, v190, v137 op_sel_hi:[0,1]
    v_pk_mul_f16 v226, v190, v138 op_sel_hi:[0,1]
    v_pk_mul_f16 v227, v190, v139 op_sel_hi:[0,1]
    v_pk_mul_f16 v207, v207, v246 op_sel_hi:[1,0]
    v_mfma_f32_32x32x16_f16 v[52:67], v[240:243], v[220:223], v[52:67]
    v_pk_mul_f16 v216, v197, v150 op_sel_hi:[0,1]
    v_pk_mul_f16 v217, v197, v151 op_sel_hi:[0,1]
    v_pk_mul_f16 v218, v197, v152 op_sel_hi:[0,1]
    v_pk_mul_f16 v219, v197, v153 op_sel_hi:[0,1]
    v_pk_mul_f16 v214, v214, v247 op_sel_hi:[1,0]
    v_mfma_f32_32x32x16_f16 v[4:19], v[228:231], v[224:227], v[4:19]
    ds_read_b128 v[240:243], v1 offset:17408
    v_pk_mul_f16 v220, v204, v164 op_sel_hi:[0,1]
    v_pk_mul_f16 v221, v204, v165 op_sel_hi:[0,1]
    v_pk_mul_f16 v222, v204, v166 op_sel_hi:[0,1]
    v_pk_mul_f16 v223, v204, v167 op_sel_hi:[0,1]
    v_cvt_pk_f16_f32 v194, v80, 0
    v_mfma_f32_32x32x16_f16 v[20:35], v[228:231], v[216:219], v[20:35]
    v_pk_mul_f16 v224, v211, v178 op_sel_hi:[0,1]
    v_pk_mul_f16 v225, v211, v179 op_sel_hi:[0,1]
    v_pk_mul_f16 v226, v211, v180 op_sel_hi:[0,1]
    v_pk_mul_f16 v227, v211, v181 op_sel_hi:[0,1]
    v_cvt_pk_f16_f32 v201, v96, 0
    v_mfma_f32_32x32x16_f16 v[36:51], v[228:231], v[220:223], v[36:51]
    v_pk_mul_f16 v216, v190, v140 op_sel_hi:[0,1]
    v_pk_mul_f16 v217, v190, v141 op_sel_hi:[0,1]
    v_pk_mul_f16 v218, v190, v142 op_sel_hi:[0,1]
    v_pk_mul_f16 v219, v190, v143 op_sel_hi:[0,1]
    v_cvt_pk_f16_f32 v208, v112, 0
    v_mfma_f32_32x32x16_f16 v[52:67], v[228:231], v[224:227], v[52:67]
    v_pk_mul_f16 v220, v197, v154 op_sel_hi:[0,1]
    v_pk_mul_f16 v221, v197, v155 op_sel_hi:[0,1]
    v_pk_mul_f16 v222, v197, v156 op_sel_hi:[0,1]
    v_pk_mul_f16 v223, v197, v157 op_sel_hi:[0,1]
    v_cvt_pk_f16_f32 v215, v128, 0
    v_mfma_f32_32x32x16_f16 v[4:19], v[232:235], v[216:219], v[4:19]
    ds_read_b128 v[228:231], v1 offset:18432
    v_pk_mul_f16 v224, v204, v168 op_sel_hi:[0,1]
    v_pk_mul_f16 v225, v204, v169 op_sel_hi:[0,1]
    v_pk_mul_f16 v226, v204, v170 op_sel_hi:[0,1]
    v_pk_mul_f16 v227, v204, v171 op_sel_hi:[0,1]
    v_pk_mul_f16 v194, v194, v244 op_sel_hi:[1,0]
    v_mfma_f32_32x32x16_f16 v[20:35], v[232:235], v[220:223], v[20:35]
    v_pk_mul_f16 v216, v211, v182 op_sel_hi:[0,1]
    v_pk_mul_f16 v217, v211, v183 op_sel_hi:[0,1]
    v_pk_mul_f16 v218, v211, v184 op_sel_hi:[0,1]
    v_pk_mul_f16 v219, v211, v185 op_sel_hi:[0,1]
    v_pk_mul_f16 v201, v201, v245 op_sel_hi:[1,0]
    v_mfma_f32_32x32x16_f16 v[36:51], v[232:235], v[224:227], v[36:51]
    v_pk_mul_f16 v220, v190, v144 op_sel_hi:[0,1]
    v_pk_mul_f16 v221, v190, v132 op_sel:[1,0] op_sel_hi:[1,1]
    v_pk_mul_f16 v222, v190, v133 op_sel:[1,0] op_sel_hi:[1,1]
    v_pk_mul_f16 v223, v190, v134 op_sel:[1,0] op_sel_hi:[1,1]
    v_pk_mul_f16 v208, v208, v246 op_sel_hi:[1,0]
    v_mfma_f32_32x32x16_f16 v[52:67], v[232:235], v[216:219], v[52:67]
    v_pk_mul_f16 v224, v197, v158 op_sel_hi:[0,1]
    v_pk_mul_f16 v225, v197, v146 op_sel:[1,0] op_sel_hi:[1,1]
    v_pk_mul_f16 v226, v197, v147 op_sel:[1,0] op_sel_hi:[1,1]
    v_pk_mul_f16 v227, v197, v148 op_sel:[1,0] op_sel_hi:[1,1]
    v_pk_mul_f16 v215, v215, v247 op_sel_hi:[1,0]
    s_waitcnt lgkmcnt(0)
    v_mfma_f32_32x32x16_f16 v[4:19], v[236:239], v[220:223], v[4:19]
    ds_read_b128 v[232:235], v1 offset:19456
    v_pk_mul_f16 v216, v204, v172 op_sel_hi:[0,1]
    v_pk_mul_f16 v217, v204, v160 op_sel:[1,0] op_sel_hi:[1,1]
    v_pk_mul_f16 v218, v204, v161 op_sel:[1,0] op_sel_hi:[1,1]
    v_pk_mul_f16 v219, v204, v162 op_sel:[1,0] op_sel_hi:[1,1]
    v_add3_u32 v145, v145, v252, s64
    v_mfma_f32_32x32x16_f16 v[20:35], v[236:239], v[224:227], v[20:35]
    v_pk_mul_f16 v220, v211, v186 op_sel_hi:[0,1]
    v_pk_mul_f16 v221, v211, v174 op_sel:[1,0] op_sel_hi:[1,1]
    v_pk_mul_f16 v222, v211, v175 op_sel:[1,0] op_sel_hi:[1,1]
    v_pk_mul_f16 v223, v211, v176 op_sel:[1,0] op_sel_hi:[1,1]
    v_add3_u32 v159, v159, v253, s65
    v_mfma_f32_32x32x16_f16 v[36:51], v[236:239], v[216:219], v[36:51]
    v_pk_mul_f16 v224, v190, v135 op_sel:[1,0] op_sel_hi:[1,1]
    v_pk_mul_f16 v225, v190, v136 op_sel:[1,0] op_sel_hi:[1,1]
    v_pk_mul_f16 v226, v190, v137 op_sel:[1,0] op_sel_hi:[1,1]
    v_pk_mul_f16 v227, v190, v138 op_sel:[1,0] op_sel_hi:[1,1]
    v_add3_u32 v173, v173, v254, s66
    v_mfma_f32_32x32x16_f16 v[52:67], v[236:239], v[220:223], v[52:67]
    v_pk_mul_f16 v216, v197, v149 op_sel:[1,0] op_sel_hi:[1,1]
    v_pk_mul_f16 v217, v197, v150 op_sel:[1,0] op_sel_hi:[1,1]
    v_pk_mul_f16 v218, v197, v151 op_sel:[1,0] op_sel_hi:[1,1]
    v_pk_mul_f16 v219, v197, v152 op_sel:[1,0] op_sel_hi:[1,1]
    v_add3_u32 v187, v187, v255, s67
    v_mfma_f32_32x32x16_f16 v[4:19], v[240:243], v[224:227], v[4:19]
    ds_read_b128 v[236:239], v1 offset:20480
    v_pk_mul_f16 v220, v204, v163 op_sel:[1,0] op_sel_hi:[1,1]
    v_pk_mul_f16 v221, v204, v164 op_sel:[1,0] op_sel_hi:[1,1]
    v_pk_mul_f16 v222, v204, v165 op_sel:[1,0] op_sel_hi:[1,1]
    v_pk_mul_f16 v223, v204, v166 op_sel:[1,0] op_sel_hi:[1,1]
    v_mfma_f32_32x32x16_f16 v[20:35], v[240:243], v[216:219], v[20:35]
    v_pk_mul_f16 v224, v211, v177 op_sel:[1,0] op_sel_hi:[1,1]
    v_pk_mul_f16 v225, v211, v178 op_sel:[1,0] op_sel_hi:[1,1]
    v_pk_mul_f16 v226, v211, v179 op_sel:[1,0] op_sel_hi:[1,1]
    v_pk_mul_f16 v227, v211, v180 op_sel:[1,0] op_sel_hi:[1,1]
    v_mfma_f32_32x32x16_f16 v[36:51], v[240:243], v[220:223], v[36:51]
    v_pk_mul_f16 v216, v190, v139 op_sel:[1,0] op_sel_hi:[1,1]
    v_pk_mul_f16 v217, v190, v140 op_sel:[1,0] op_sel_hi:[1,1]
    v_pk_mul_f16 v218, v190, v141 op_sel:[1,0] op_sel_hi:[1,1]
    v_pk_mul_f16 v219, v190, v142 op_sel:[1,0] op_sel_hi:[1,1]
    v_mfma_f32_32x32x16_f16 v[52:67], v[240:243], v[224:227], v[52:67]
    v_pk_mul_f16 v220, v197, v153 op_sel:[1,0] op_sel_hi:[1,1]
    v_pk_mul_f16 v221, v197, v154 op_sel:[1,0] op_sel_hi:[1,1]
    v_pk_mul_f16 v222, v197, v155 op_sel:[1,0] op_sel_hi:[1,1]
    v_pk_mul_f16 v223, v197, v156 op_sel:[1,0] op_sel_hi:[1,1]
    v_mfma_f32_32x32x16_f16 v[4:19], v[228:231], v[216:219], v[4:19]
    ds_read_b128 v[240:243], v1 offset:21504
    v_pk_mul_f16 v224, v204, v167 op_sel:[1,0] op_sel_hi:[1,1]
    v_pk_mul_f16 v225, v204, v168 op_sel:[1,0] op_sel_hi:[1,1]
    v_pk_mul_f16 v226, v204, v169 op_sel:[1,0] op_sel_hi:[1,1]
    v_pk_mul_f16 v227, v204, v170 op_sel:[1,0] op_sel_hi:[1,1]
    v_mfma_f32_32x32x16_f16 v[20:35], v[228:231], v[220:223], v[20:35]
    v_pk_mul_f16 v216, v211, v181 op_sel:[1,0] op_sel_hi:[1,1]
    v_pk_mul_f16 v217, v211, v182 op_sel:[1,0] op_sel_hi:[1,1]
    v_pk_mul_f16 v218, v211, v183 op_sel:[1,0] op_sel_hi:[1,1]
    v_pk_mul_f16 v219, v211, v184 op_sel:[1,0] op_sel_hi:[1,1]
    v_mfma_f32_32x32x16_f16 v[36:51], v[228:231], v[224:227], v[36:51]
    v_pk_mul_f16 v220, v190, v143 op_sel:[1,0] op_sel_hi:[1,1]
    v_pk_mul_f16 v221, v190, v144 op_sel:[1,0] op_sel_hi:[1,1]
    v_pk_mul_f16 v222, v191, v132 op_sel_hi:[0,1]
    v_pk_mul_f16 v223, v191, v133 op_sel_hi:[0,1]
    v_mfma_f32_32x32x16_f16 v[52:67], v[228:231], v[216:219], v[52:67]
    v_pk_mul_f16 v224, v197, v157 op_sel:[1,0] op_sel_hi:[1,1]
    v_pk_mul_f16 v225, v197, v158 op_sel:[1,0] op_sel_hi:[1,1]
    v_pk_mul_f16 v226, v198, v146 op_sel_hi:[0,1]
    v_pk_mul_f16 v227, v198, v147 op_sel_hi:[0,1]
    s_waitcnt lgkmcnt(0)
    v_mfma_f32_32x32x16_f16 v[4:19], v[232:235], v[220:223], v[4:19]
    ds_read_b128 v[228:231], v1 offset:22528
    v_pk_mul_f16 v216, v204, v171 op_sel:[1,0] op_sel_hi:[1,1]
    v_pk_mul_f16 v217, v204, v172 op_sel:[1,0] op_sel_hi:[1,1]
    v_pk_mul_f16 v218, v205, v160 op_sel_hi:[0,1]
    v_pk_mul_f16 v219, v205, v161 op_sel_hi:[0,1]
    v_mfma_f32_32x32x16_f16 v[20:35], v[232:235], v[224:227], v[20:35]
    v_pk_mul_f16 v220, v211, v185 op_sel:[1,0] op_sel_hi:[1,1]
    v_pk_mul_f16 v221, v211, v186 op_sel:[1,0] op_sel_hi:[1,1]
    v_pk_mul_f16 v222, v212, v174 op_sel_hi:[0,1]
    v_pk_mul_f16 v223, v212, v175 op_sel_hi:[0,1]
    v_mfma_f32_32x32x16_f16 v[36:51], v[232:235], v[216:219], v[36:51]
    v_pk_mul_f16 v224, v191, v134 op_sel_hi:[0,1]
    v_pk_mul_f16 v225, v191, v135 op_sel_hi:[0,1]
    v_pk_mul_f16 v226, v191, v136 op_sel_hi:[0,1]
    v_pk_mul_f16 v227, v191, v137 op_sel_hi:[0,1]
    v_mfma_f32_32x32x16_f16 v[52:67], v[232:235], v[220:223], v[52:67]
    v_pk_mul_f16 v216, v198, v148 op_sel_hi:[0,1]
    v_pk_mul_f16 v217, v198, v149 op_sel_hi:[0,1]
    v_pk_mul_f16 v218, v198, v150 op_sel_hi:[0,1]
    v_pk_mul_f16 v219, v198, v151 op_sel_hi:[0,1]
    v_mfma_f32_32x32x16_f16 v[4:19], v[236:239], v[224:227], v[4:19]
    ds_read_b128 v[232:235], v1 offset:23552
    v_pk_mul_f16 v220, v205, v162 op_sel_hi:[0,1]
    v_pk_mul_f16 v221, v205, v163 op_sel_hi:[0,1]
    v_pk_mul_f16 v222, v205, v164 op_sel_hi:[0,1]
    v_pk_mul_f16 v223, v205, v165 op_sel_hi:[0,1]
    v_mfma_f32_32x32x16_f16 v[20:35], v[236:239], v[216:219], v[20:35]
    v_pk_mul_f16 v224, v212, v176 op_sel_hi:[0,1]
    v_pk_mul_f16 v225, v212, v177 op_sel_hi:[0,1]
    v_pk_mul_f16 v226, v212, v178 op_sel_hi:[0,1]
    v_pk_mul_f16 v227, v212, v179 op_sel_hi:[0,1]
    v_mfma_f32_32x32x16_f16 v[36:51], v[236:239], v[220:223], v[36:51]
    v_pk_mul_f16 v216, v191, v138 op_sel_hi:[0,1]
    v_pk_mul_f16 v217, v191, v139 op_sel_hi:[0,1]
    v_pk_mul_f16 v218, v191, v140 op_sel_hi:[0,1]
    v_pk_mul_f16 v219, v191, v141 op_sel_hi:[0,1]
    v_mfma_f32_32x32x16_f16 v[52:67], v[236:239], v[224:227], v[52:67]
    v_pk_mul_f16 v220, v198, v152 op_sel_hi:[0,1]
    v_pk_mul_f16 v221, v198, v153 op_sel_hi:[0,1]
    v_pk_mul_f16 v222, v198, v154 op_sel_hi:[0,1]
    v_pk_mul_f16 v223, v198, v155 op_sel_hi:[0,1]
    v_mfma_f32_32x32x16_f16 v[4:19], v[240:243], v[216:219], v[4:19]
    ds_read_b128 v[236:239], v1 offset:24576
    v_pk_mul_f16 v224, v205, v166 op_sel_hi:[0,1]
    v_pk_mul_f16 v225, v205, v167 op_sel_hi:[0,1]
    v_pk_mul_f16 v226, v205, v168 op_sel_hi:[0,1]
    v_pk_mul_f16 v227, v205, v169 op_sel_hi:[0,1]
    v_mfma_f32_32x32x16_f16 v[20:35], v[240:243], v[220:223], v[20:35]
    v_pk_mul_f16 v216, v212, v180 op_sel_hi:[0,1]
    v_pk_mul_f16 v217, v212, v181 op_sel_hi:[0,1]
    v_pk_mul_f16 v218, v212, v182 op_sel_hi:[0,1]
    v_pk_mul_f16 v219, v212, v183 op_sel_hi:[0,1]
    v_mfma_f32_32x32x16_f16 v[36:51], v[240:243], v[224:227], v[36:51]
    v_pk_mul_f16 v220, v191, v142 op_sel_hi:[0,1]
    v_pk_mul_f16 v221, v191, v143 op_sel_hi:[0,1]
    v_pk_mul_f16 v222, v191, v144 op_sel_hi:[0,1]
    v_pk_mul_f16 v223, v191, v132 op_sel:[1,0] op_sel_hi:[1,1]
    v_mfma_f32_32x32x16_f16 v[52:67], v[240:243], v[216:219], v[52:67]
    v_pk_mul_f16 v224, v198, v156 op_sel_hi:[0,1]
    v_pk_mul_f16 v225, v198, v157 op_sel_hi:[0,1]
    v_pk_mul_f16 v226, v198, v158 op_sel_hi:[0,1]
    v_pk_mul_f16 v227, v198, v146 op_sel:[1,0] op_sel_hi:[1,1]
    s_waitcnt lgkmcnt(0)
    v_mfma_f32_32x32x16_f16 v[4:19], v[228:231], v[220:223], v[4:19]
    ds_read_b128 v[240:243], v1 offset:25600
    v_pk_mul_f16 v216, v205, v170 op_sel_hi:[0,1]
    v_pk_mul_f16 v217, v205, v171 op_sel_hi:[0,1]
    v_pk_mul_f16 v218, v205, v172 op_sel_hi:[0,1]
    v_pk_mul_f16 v219, v205, v160 op_sel:[1,0] op_sel_hi:[1,1]
    v_mfma_f32_32x32x16_f16 v[20:35], v[228:231], v[224:227], v[20:35]
    v_pk_mul_f16 v220, v212, v184 op_sel_hi:[0,1]
    v_pk_mul_f16 v221, v212, v185 op_sel_hi:[0,1]
    v_pk_mul_f16 v222, v212, v186 op_sel_hi:[0,1]
    v_pk_mul_f16 v223, v212, v174 op_sel:[1,0] op_sel_hi:[1,1]
    v_mfma_f32_32x32x16_f16 v[36:51], v[228:231], v[216:219], v[36:51]
    v_pk_mul_f16 v224, v191, v133 op_sel:[1,0] op_sel_hi:[1,1]
    v_pk_mul_f16 v225, v191, v134 op_sel:[1,0] op_sel_hi:[1,1]
    v_pk_mul_f16 v226, v191, v135 op_sel:[1,0] op_sel_hi:[1,1]
    v_pk_mul_f16 v227, v191, v136 op_sel:[1,0] op_sel_hi:[1,1]
    v_mfma_f32_32x32x16_f16 v[52:67], v[228:231], v[220:223], v[52:67]
    v_pk_mul_f16 v216, v198, v147 op_sel:[1,0] op_sel_hi:[1,1]
    v_pk_mul_f16 v217, v198, v148 op_sel:[1,0] op_sel_hi:[1,1]
    v_pk_mul_f16 v218, v198, v149 op_sel:[1,0] op_sel_hi:[1,1]
    v_pk_mul_f16 v219, v198, v150 op_sel:[1,0] op_sel_hi:[1,1]
    v_mfma_f32_32x32x16_f16 v[4:19], v[232:235], v[224:227], v[4:19]
    ds_read_b128 v[228:231], v1 offset:26624
    v_pk_mul_f16 v220, v205, v161 op_sel:[1,0] op_sel_hi:[1,1]
    v_pk_mul_f16 v221, v205, v162 op_sel:[1,0] op_sel_hi:[1,1]
    v_pk_mul_f16 v222, v205, v163 op_sel:[1,0] op_sel_hi:[1,1]
    v_pk_mul_f16 v223, v205, v164 op_sel:[1,0] op_sel_hi:[1,1]
    v_mfma_f32_32x32x16_f16 v[20:35], v[232:235], v[216:219], v[20:35]
    v_pk_mul_f16 v224, v212, v175 op_sel:[1,0] op_sel_hi:[1,1]
    v_pk_mul_f16 v225, v212, v176 op_sel:[1,0] op_sel_hi:[1,1]
    v_pk_mul_f16 v226, v212, v177 op_sel:[1,0] op_sel_hi:[1,1]
    v_pk_mul_f16 v227, v212, v178 op_sel:[1,0] op_sel_hi:[1,1]
    v_mfma_f32_32x32x16_f16 v[36:51], v[232:235], v[220:223], v[36:51]
    v_pk_mul_f16 v216, v191, v137 op_sel:[1,0] op_sel_hi:[1,1]
    v_pk_mul_f16 v217, v191, v138 op_sel:[1,0] op_sel_hi:[1,1]
    v_pk_mul_f16 v218, v191, v139 op_sel:[1,0] op_sel_hi:[1,1]
    v_pk_mul_f16 v219, v191, v140 op_sel:[1,0] op_sel_hi:[1,1]
    v_mfma_f32_32x32x16_f16 v[52:67], v[232:235], v[224:227], v[52:67]
    v_pk_mul_f16 v220, v198, v151 op_sel:[1,0] op_sel_hi:[1,1]
    v_pk_mul_f16 v221, v198, v152 op_sel:[1,0] op_sel_hi:[1,1]
    v_pk_mul_f16 v222, v198, v153 op_sel:[1,0] op_sel_hi:[1,1]
    v_pk_mul_f16 v223, v198, v154 op_sel:[1,0] op_sel_hi:[1,1]
    v_mfma_f32_32x32x16_f16 v[4:19], v[236:239], v[216:219], v[4:19]
    ds_read_b128 v[232:235], v1 offset:27648
    v_pk_mul_f16 v224, v205, v165 op_sel:[1,0] op_sel_hi:[1,1]
    v_pk_mul_f16 v225, v205, v166 op_sel:[1,0] op_sel_hi:[1,1]
    v_pk_mul_f16 v226, v205, v167 op_sel:[1,0] op_sel_hi:[1,1]
    v_pk_mul_f16 v227, v205, v168 op_sel:[1,0] op_sel_hi:[1,1]
    v_mfma_f32_32x32x16_f16 v[20:35], v[236:239], v[220:223], v[20:35]
    v_pk_mul_f16 v216, v212, v179 op_sel:[1,0] op_sel_hi:[1,1]
    v_pk_mul_f16 v217, v212, v180 op_sel:[1,0] op_sel_hi:[1,1]
    v_pk_mul_f16 v218, v212, v181 op_sel:[1,0] op_sel_hi:[1,1]
    v_pk_mul_f16 v219, v212, v182 op_sel:[1,0] op_sel_hi:[1,1]
    v_mfma_f32_32x32x16_f16 v[36:51], v[236:239], v[224:227], v[36:51]
    v_pk_mul_f16 v220, v191, v141 op_sel:[1,0] op_sel_hi:[1,1]
    v_pk_mul_f16 v221, v191, v142 op_sel:[1,0] op_sel_hi:[1,1]
    v_pk_mul_f16 v222, v191, v143 op_sel:[1,0] op_sel_hi:[1,1]
    v_pk_mul_f16 v223, v191, v144 op_sel:[1,0] op_sel_hi:[1,1]
    v_mfma_f32_32x32x16_f16 v[52:67], v[236:239], v[216:219], v[52:67]
    v_pk_mul_f16 v224, v198, v155 op_sel:[1,0] op_sel_hi:[1,1]
    v_pk_mul_f16 v225, v198, v156 op_sel:[1,0] op_sel_hi:[1,1]
    v_pk_mul_f16 v226, v198, v157 op_sel:[1,0] op_sel_hi:[1,1]
    v_pk_mul_f16 v227, v198, v158 op_sel:[1,0] op_sel_hi:[1,1]
    s_waitcnt lgkmcnt(0)
    v_mfma_f32_32x32x16_f16 v[4:19], v[240:243], v[220:223], v[4:19]
    ds_read_b128 v[236:239], v1 offset:28672
    v_pk_mul_f16 v216, v205, v169 op_sel:[1,0] op_sel_hi:[1,1]
    v_pk_mul_f16 v217, v205, v170 op_sel:[1,0] op_sel_hi:[1,1]
    v_pk_mul_f16 v218, v205, v171 op_sel:[1,0] op_sel_hi:[1,1]
    v_pk_mul_f16 v219, v205, v172 op_sel:[1,0] op_sel_hi:[1,1]
    v_mfma_f32_32x32x16_f16 v[20:35], v[240:243], v[224:227], v[20:35]
    v_pk_mul_f16 v220, v212, v183 op_sel:[1,0] op_sel_hi:[1,1]
    v_pk_mul_f16 v221, v212, v184 op_sel:[1,0] op_sel_hi:[1,1]
    v_pk_mul_f16 v222, v212, v185 op_sel:[1,0] op_sel_hi:[1,1]
    v_pk_mul_f16 v223, v212, v186 op_sel:[1,0] op_sel_hi:[1,1]
    v_mfma_f32_32x32x16_f16 v[36:51], v[240:243], v[216:219], v[36:51]
    v_pk_mul_f16 v224, v192, v132 op_sel_hi:[0,1]
    v_pk_mul_f16 v225, v192, v133 op_sel_hi:[0,1]
    v_pk_mul_f16 v226, v192, v134 op_sel_hi:[0,1]
    v_pk_mul_f16 v227, v192, v135 op_sel_hi:[0,1]
    v_mfma_f32_32x32x16_f16 v[52:67], v[240:243], v[220:223], v[52:67]
    v_pk_mul_f16 v216, v199, v146 op_sel_hi:[0,1]
    v_pk_mul_f16 v217, v199, v147 op_sel_hi:[0,1]
    v_pk_mul_f16 v218, v199, v148 op_sel_hi:[0,1]
    v_pk_mul_f16 v219, v199, v149 op_sel_hi:[0,1]
    v_mfma_f32_32x32x16_f16 v[4:19], v[228:231], v[224:227], v[4:19]
    ds_read_b128 v[240:243], v1 offset:29696
    v_pk_mul_f16 v220, v206, v160 op_sel_hi:[0,1]
    v_pk_mul_f16 v221, v206, v161 op_sel_hi:[0,1]
    v_pk_mul_f16 v222, v206, v162 op_sel_hi:[0,1]
    v_pk_mul_f16 v223, v206, v163 op_sel_hi:[0,1]
    v_mfma_f32_32x32x16_f16 v[20:35], v[228:231], v[216:219], v[20:35]
    v_pk_mul_f16 v224, v213, v174 op_sel_hi:[0,1]
    v_pk_mul_f16 v225, v213, v175 op_sel_hi:[0,1]
    v_pk_mul_f16 v226, v213, v176 op_sel_hi:[0,1]
    v_pk_mul_f16 v227, v213, v177 op_sel_hi:[0,1]
    v_mfma_f32_32x32x16_f16 v[36:51], v[228:231], v[220:223], v[36:51]
    v_pk_mul_f16 v216, v192, v136 op_sel_hi:[0,1]
    v_pk_mul_f16 v217, v192, v137 op_sel_hi:[0,1]
    v_pk_mul_f16 v218, v192, v138 op_sel_hi:[0,1]
    v_pk_mul_f16 v219, v192, v139 op_sel_hi:[0,1]
    v_mfma_f32_32x32x16_f16 v[52:67], v[228:231], v[224:227], v[52:67]
    v_pk_mul_f16 v220, v199, v150 op_sel_hi:[0,1]
    v_pk_mul_f16 v221, v199, v151 op_sel_hi:[0,1]
    v_pk_mul_f16 v222, v199, v152 op_sel_hi:[0,1]
    v_pk_mul_f16 v223, v199, v153 op_sel_hi:[0,1]
    v_mfma_f32_32x32x16_f16 v[4:19], v[232:235], v[216:219], v[4:19]
    ds_read_b128 v[228:231], v1 offset:30720
    v_pk_mul_f16 v224, v206, v164 op_sel_hi:[0,1]
    v_pk_mul_f16 v225, v206, v165 op_sel_hi:[0,1]
    v_pk_mul_f16 v226, v206, v166 op_sel_hi:[0,1]
    v_pk_mul_f16 v227, v206, v167 op_sel_hi:[0,1]
    v_mfma_f32_32x32x16_f16 v[20:35], v[232:235], v[220:223], v[20:35]
    v_pk_mul_f16 v216, v213, v178 op_sel_hi:[0,1]
    v_pk_mul_f16 v217, v213, v179 op_sel_hi:[0,1]
    v_pk_mul_f16 v218, v213, v180 op_sel_hi:[0,1]
    v_pk_mul_f16 v219, v213, v181 op_sel_hi:[0,1]
    v_mfma_f32_32x32x16_f16 v[36:51], v[232:235], v[224:227], v[36:51]
    v_pk_mul_f16 v220, v192, v140 op_sel_hi:[0,1]
    v_pk_mul_f16 v221, v192, v141 op_sel_hi:[0,1]
    v_pk_mul_f16 v222, v192, v142 op_sel_hi:[0,1]
    v_pk_mul_f16 v223, v192, v143 op_sel_hi:[0,1]
    v_mfma_f32_32x32x16_f16 v[52:67], v[232:235], v[216:219], v[52:67]
    v_pk_mul_f16 v224, v199, v154 op_sel_hi:[0,1]
    v_pk_mul_f16 v225, v199, v155 op_sel_hi:[0,1]
    v_pk_mul_f16 v226, v199, v156 op_sel_hi:[0,1]
    v_pk_mul_f16 v227, v199, v157 op_sel_hi:[0,1]
    s_waitcnt lgkmcnt(0)
    v_mfma_f32_32x32x16_f16 v[4:19], v[236:239], v[220:223], v[4:19]
    ds_read_b128 v[232:235], v1 offset:31744
    v_pk_mul_f16 v216, v206, v168 op_sel_hi:[0,1]
    v_pk_mul_f16 v217, v206, v169 op_sel_hi:[0,1]
    v_pk_mul_f16 v218, v206, v170 op_sel_hi:[0,1]
    v_pk_mul_f16 v219, v206, v171 op_sel_hi:[0,1]
    v_mfma_f32_32x32x16_f16 v[20:35], v[236:239], v[224:227], v[20:35]
    v_pk_mul_f16 v220, v213, v182 op_sel_hi:[0,1]
    v_pk_mul_f16 v221, v213, v183 op_sel_hi:[0,1]
    v_pk_mul_f16 v222, v213, v184 op_sel_hi:[0,1]
    v_pk_mul_f16 v223, v213, v185 op_sel_hi:[0,1]
    v_mfma_f32_32x32x16_f16 v[36:51], v[236:239], v[216:219], v[36:51]
    v_pk_mul_f16 v224, v192, v144 op_sel_hi:[0,1]
    v_pk_mul_f16 v225, v192, v132 op_sel:[1,0] op_sel_hi:[1,1]
    v_pk_mul_f16 v226, v192, v133 op_sel:[1,0] op_sel_hi:[1,1]
    v_pk_mul_f16 v227, v192, v134 op_sel:[1,0] op_sel_hi:[1,1]
    v_mfma_f32_32x32x16_f16 v[52:67], v[236:239], v[220:223], v[52:67]
    v_pk_mul_f16 v216, v199, v158 op_sel_hi:[0,1]
    v_pk_mul_f16 v217, v199, v146 op_sel:[1,0] op_sel_hi:[1,1]
    v_pk_mul_f16 v218, v199, v147 op_sel:[1,0] op_sel_hi:[1,1]
    v_pk_mul_f16 v219, v199, v148 op_sel:[1,0] op_sel_hi:[1,1]
    v_mfma_f32_32x32x16_f16 v[4:19], v[240:243], v[224:227], v[4:19]
    ds_read_b128 v[236:239], v1 offset:32768
    v_pk_mul_f16 v220, v206, v172 op_sel_hi:[0,1]
    v_pk_mul_f16 v221, v206, v160 op_sel:[1,0] op_sel_hi:[1,1]
    v_pk_mul_f16 v222, v206, v161 op_sel:[1,0] op_sel_hi:[1,1]
    v_pk_mul_f16 v223, v206, v162 op_sel:[1,0] op_sel_hi:[1,1]
    v_mfma_f32_32x32x16_f16 v[20:35], v[240:243], v[216:219], v[20:35]
    v_pk_mul_f16 v224, v213, v186 op_sel_hi:[0,1]
    v_pk_mul_f16 v225, v213, v174 op_sel:[1,0] op_sel_hi:[1,1]
    v_pk_mul_f16 v226, v213, v175 op_sel:[1,0] op_sel_hi:[1,1]
    v_pk_mul_f16 v227, v213, v176 op_sel:[1,0] op_sel_hi:[1,1]
    v_mfma_f32_32x32x16_f16 v[36:51], v[240:243], v[220:223], v[36:51]
    v_pk_mul_f16 v216, v192, v135 op_sel:[1,0] op_sel_hi:[1,1]
    v_pk_mul_f16 v217, v192, v136 op_sel:[1,0] op_sel_hi:[1,1]
    v_pk_mul_f16 v218, v192, v137 op_sel:[1,0] op_sel_hi:[1,1]
    v_pk_mul_f16 v219, v192, v138 op_sel:[1,0] op_sel_hi:[1,1]
    v_mfma_f32_32x32x16_f16 v[52:67], v[240:243], v[224:227], v[52:67]
    v_pk_mul_f16 v220, v199, v149 op_sel:[1,0] op_sel_hi:[1,1]
    v_pk_mul_f16 v221, v199, v150 op_sel:[1,0] op_sel_hi:[1,1]
    v_pk_mul_f16 v222, v199, v151 op_sel:[1,0] op_sel_hi:[1,1]
    v_pk_mul_f16 v223, v199, v152 op_sel:[1,0] op_sel_hi:[1,1]
    v_mfma_f32_32x32x16_f16 v[4:19], v[228:231], v[216:219], v[4:19]
    ds_read_b128 v[240:243], v1 offset:33792
    v_pk_mul_f16 v224, v206, v163 op_sel:[1,0] op_sel_hi:[1,1]
    v_pk_mul_f16 v225, v206, v164 op_sel:[1,0] op_sel_hi:[1,1]
    v_pk_mul_f16 v226, v206, v165 op_sel:[1,0] op_sel_hi:[1,1]
    v_pk_mul_f16 v227, v206, v166 op_sel:[1,0] op_sel_hi:[1,1]
    v_mfma_f32_32x32x16_f16 v[20:35], v[228:231], v[220:223], v[20:35]
    v_pk_mul_f16 v216, v213, v177 op_sel:[1,0] op_sel_hi:[1,1]
    v_pk_mul_f16 v217, v213, v178 op_sel:[1,0] op_sel_hi:[1,1]
    v_pk_mul_f16 v218, v213, v179 op_sel:[1,0] op_sel_hi:[1,1]
    v_pk_mul_f16 v219, v213, v180 op_sel:[1,0] op_sel_hi:[1,1]
    v_mfma_f32_32x32x16_f16 v[36:51], v[228:231], v[224:227], v[36:51]
    v_pk_mul_f16 v220, v192, v139 op_sel:[1,0] op_sel_hi:[1,1]
    v_pk_mul_f16 v221, v192, v140 op_sel:[1,0] op_sel_hi:[1,1]
    v_pk_mul_f16 v222, v192, v141 op_sel:[1,0] op_sel_hi:[1,1]
    v_pk_mul_f16 v223, v192, v142 op_sel:[1,0] op_sel_hi:[1,1]
    v_mfma_f32_32x32x16_f16 v[52:67], v[228:231], v[216:219], v[52:67]
    v_pk_mul_f16 v224, v199, v153 op_sel:[1,0] op_sel_hi:[1,1]
    v_pk_mul_f16 v225, v199, v154 op_sel:[1,0] op_sel_hi:[1,1]
    v_pk_mul_f16 v226, v199, v155 op_sel:[1,0] op_sel_hi:[1,1]
    v_pk_mul_f16 v227, v199, v156 op_sel:[1,0] op_sel_hi:[1,1]
    s_waitcnt lgkmcnt(0)
    v_mfma_f32_32x32x16_f16 v[4:19], v[232:235], v[220:223], v[4:19]
    ds_read_b128 v[228:231], v1 offset:34816
    v_pk_mul_f16 v216, v206, v167 op_sel:[1,0] op_sel_hi:[1,1]
    v_pk_mul_f16 v217, v206, v168 op_sel:[1,0] op_sel_hi:[1,1]
    v_pk_mul_f16 v218, v206, v169 op_sel:[1,0] op_sel_hi:[1,1]
    v_pk_mul_f16 v219, v206, v170 op_sel:[1,0] op_sel_hi:[1,1]
    v_mfma_f32_32x32x16_f16 v[20:35], v[232:235], v[224:227], v[20:35]
    v_pk_mul_f16 v220, v213, v181 op_sel:[1,0] op_sel_hi:[1,1]
    v_pk_mul_f16 v221, v213, v182 op_sel:[1,0] op_sel_hi:[1,1]
    v_pk_mul_f16 v222, v213, v183 op_sel:[1,0] op_sel_hi:[1,1]
    v_pk_mul_f16 v223, v213, v184 op_sel:[1,0] op_sel_hi:[1,1]
    v_mfma_f32_32x32x16_f16 v[36:51], v[232:235], v[216:219], v[36:51]
    v_pk_mul_f16 v224, v192, v143 op_sel:[1,0] op_sel_hi:[1,1]
    v_pk_mul_f16 v225, v192, v144 op_sel:[1,0] op_sel_hi:[1,1]
    v_pk_mul_f16 v226, v193, v132 op_sel_hi:[0,1]
    v_pk_mul_f16 v227, v193, v133 op_sel_hi:[0,1]
    v_mfma_f32_32x32x16_f16 v[52:67], v[232:235], v[220:223], v[52:67]
    v_pk_mul_f16 v216, v199, v157 op_sel:[1,0] op_sel_hi:[1,1]
    v_pk_mul_f16 v217, v199, v158 op_sel:[1,0] op_sel_hi:[1,1]
    v_pk_mul_f16 v218, v200, v146 op_sel_hi:[0,1]
    v_pk_mul_f16 v219, v200, v147 op_sel_hi:[0,1]
    v_mfma_f32_32x32x16_f16 v[4:19], v[236:239], v[224:227], v[4:19]
    ds_read_b128 v[232:235], v1 offset:35840
    v_pk_mul_f16 v220, v206, v171 op_sel:[1,0] op_sel_hi:[1,1]
    v_pk_mul_f16 v221, v206, v172 op_sel:[1,0] op_sel_hi:[1,1]
    v_pk_mul_f16 v222, v207, v160 op_sel_hi:[0,1]
    v_pk_mul_f16 v223, v207, v161 op_sel_hi:[0,1]
    v_mfma_f32_32x32x16_f16 v[20:35], v[236:239], v[216:219], v[20:35]
    v_pk_mul_f16 v224, v213, v185 op_sel:[1,0] op_sel_hi:[1,1]
    v_pk_mul_f16 v225, v213, v186 op_sel:[1,0] op_sel_hi:[1,1]
    v_pk_mul_f16 v226, v214, v174 op_sel_hi:[0,1]
    v_pk_mul_f16 v227, v214, v175 op_sel_hi:[0,1]
    v_mfma_f32_32x32x16_f16 v[36:51], v[236:239], v[220:223], v[36:51]
    v_pk_mul_f16 v216, v193, v134 op_sel_hi:[0,1]
    v_pk_mul_f16 v217, v193, v135 op_sel_hi:[0,1]
    v_pk_mul_f16 v218, v193, v136 op_sel_hi:[0,1]
    v_pk_mul_f16 v219, v193, v137 op_sel_hi:[0,1]
    v_mfma_f32_32x32x16_f16 v[52:67], v[236:239], v[224:227], v[52:67]
    v_pk_mul_f16 v220, v200, v148 op_sel_hi:[0,1]
    v_pk_mul_f16 v221, v200, v149 op_sel_hi:[0,1]
    v_pk_mul_f16 v222, v200, v150 op_sel_hi:[0,1]
    v_pk_mul_f16 v223, v200, v151 op_sel_hi:[0,1]
    v_mfma_f32_32x32x16_f16 v[4:19], v[240:243], v[216:219], v[4:19]
    ds_read_b128 v[236:239], v1 offset:36864
    v_pk_mul_f16 v224, v207, v162 op_sel_hi:[0,1]
    v_pk_mul_f16 v225, v207, v163 op_sel_hi:[0,1]
    v_pk_mul_f16 v226, v207, v164 op_sel_hi:[0,1]
    v_pk_mul_f16 v227, v207, v165 op_sel_hi:[0,1]
    v_mfma_f32_32x32x16_f16 v[20:35], v[240:243], v[220:223], v[20:35]
    v_pk_mul_f16 v216, v214, v176 op_sel_hi:[0,1]
    v_pk_mul_f16 v217, v214, v177 op_sel_hi:[0,1]
    v_pk_mul_f16 v218, v214, v178 op_sel_hi:[0,1]
    v_pk_mul_f16 v219, v214, v179 op_sel_hi:[0,1]
    v_mfma_f32_32x32x16_f16 v[36:51], v[240:243], v[224:227], v[36:51]
    v_pk_mul_f16 v220, v193, v138 op_sel_hi:[0,1]
    v_pk_mul_f16 v221, v193, v139 op_sel_hi:[0,1]
    v_pk_mul_f16 v222, v193, v140 op_sel_hi:[0,1]
    v_pk_mul_f16 v223, v193, v141 op_sel_hi:[0,1]
    v_mfma_f32_32x32x16_f16 v[52:67], v[240:243], v[216:219], v[52:67]
    v_pk_mul_f16 v224, v200, v152 op_sel_hi:[0,1]
    v_pk_mul_f16 v225, v200, v153 op_sel_hi:[0,1]
    v_pk_mul_f16 v226, v200, v154 op_sel_hi:[0,1]
    v_pk_mul_f16 v227, v200, v155 op_sel_hi:[0,1]
    s_waitcnt lgkmcnt(0)
    v_mfma_f32_32x32x16_f16 v[4:19], v[228:231], v[220:223], v[4:19]
    ds_read_b128 v[240:243], v1 offset:37888
    v_pk_mul_f16 v216, v207, v166 op_sel_hi:[0,1]
    v_pk_mul_f16 v217, v207, v167 op_sel_hi:[0,1]
    v_pk_mul_f16 v218, v207, v168 op_sel_hi:[0,1]
    v_pk_mul_f16 v219, v207, v169 op_sel_hi:[0,1]
    v_mfma_f32_32x32x16_f16 v[20:35], v[228:231], v[224:227], v[20:35]
    v_pk_mul_f16 v220, v214, v180 op_sel_hi:[0,1]
    v_pk_mul_f16 v221, v214, v181 op_sel_hi:[0,1]
    v_pk_mul_f16 v222, v214, v182 op_sel_hi:[0,1]
    v_pk_mul_f16 v223, v214, v183 op_sel_hi:[0,1]
    v_mfma_f32_32x32x16_f16 v[36:51], v[228:231], v[216:219], v[36:51]
    v_pk_mul_f16 v224, v193, v142 op_sel_hi:[0,1]
    v_pk_mul_f16 v225, v193, v143 op_sel_hi:[0,1]
    v_pk_mul_f16 v226, v193, v144 op_sel_hi:[0,1]
    v_pk_mul_f16 v227, v193, v132 op_sel:[1,0] op_sel_hi:[1,1]
    v_mfma_f32_32x32x16_f16 v[52:67], v[228:231], v[220:223], v[52:67]
    v_pk_mul_f16 v216, v200, v156 op_sel_hi:[0,1]
    v_pk_mul_f16 v217, v200, v157 op_sel_hi:[0,1]
    v_pk_mul_f16 v218, v200, v158 op_sel_hi:[0,1]
    v_pk_mul_f16 v219, v200, v146 op_sel:[1,0] op_sel_hi:[1,1]
    v_mfma_f32_32x32x16_f16 v[4:19], v[232:235], v[224:227], v[4:19]
    ds_read_b128 v[228:231], v1 offset:38912
    v_pk_mul_f16 v220, v207, v170 op_sel_hi:[0,1]
    v_pk_mul_f16 v221, v207, v171 op_sel_hi:[0,1]
    v_pk_mul_f16 v222, v207, v172 op_sel_hi:[0,1]
    v_pk_mul_f16 v223, v207, v160 op_sel:[1,0] op_sel_hi:[1,1]
    v_mfma_f32_32x32x16_f16 v[20:35], v[232:235], v[216:219], v[20:35]
    v_pk_mul_f16 v224, v214, v184 op_sel_hi:[0,1]
    v_pk_mul_f16 v225, v214, v185 op_sel_hi:[0,1]
    v_pk_mul_f16 v226, v214, v186 op_sel_hi:[0,1]
    v_pk_mul_f16 v227, v214, v174 op_sel:[1,0] op_sel_hi:[1,1]
    v_mfma_f32_32x32x16_f16 v[36:51], v[232:235], v[220:223], v[36:51]
    v_pk_mul_f16 v216, v193, v133 op_sel:[1,0] op_sel_hi:[1,1]
    v_pk_mul_f16 v217, v193, v134 op_sel:[1,0] op_sel_hi:[1,1]
    v_pk_mul_f16 v218, v193, v135 op_sel:[1,0] op_sel_hi:[1,1]
    v_pk_mul_f16 v219, v193, v136 op_sel:[1,0] op_sel_hi:[1,1]
    v_mfma_f32_32x32x16_f16 v[52:67], v[232:235], v[224:227], v[52:67]
    v_pk_mul_f16 v220, v200, v147 op_sel:[1,0] op_sel_hi:[1,1]
    v_pk_mul_f16 v221, v200, v148 op_sel:[1,0] op_sel_hi:[1,1]
    v_pk_mul_f16 v222, v200, v149 op_sel:[1,0] op_sel_hi:[1,1]
    v_pk_mul_f16 v223, v200, v150 op_sel:[1,0] op_sel_hi:[1,1]
    v_mfma_f32_32x32x16_f16 v[4:19], v[236:239], v[216:219], v[4:19]
    ds_read_b128 v[232:235], v1 offset:39936
    v_pk_mul_f16 v224, v207, v161 op_sel:[1,0] op_sel_hi:[1,1]
    v_pk_mul_f16 v225, v207, v162 op_sel:[1,0] op_sel_hi:[1,1]
    v_pk_mul_f16 v226, v207, v163 op_sel:[1,0] op_sel_hi:[1,1]
    v_pk_mul_f16 v227, v207, v164 op_sel:[1,0] op_sel_hi:[1,1]
    v_mov_b32 v3, 160024
    v_mfma_f32_32x32x16_f16 v[20:35], v[236:239], v[220:223], v[20:35]
    v_pk_mul_f16 v216, v214, v175 op_sel:[1,0] op_sel_hi:[1,1]
    v_pk_mul_f16 v217, v214, v176 op_sel:[1,0] op_sel_hi:[1,1]
    v_pk_mul_f16 v218, v214, v177 op_sel:[1,0] op_sel_hi:[1,1]
    v_pk_mul_f16 v219, v214, v178 op_sel:[1,0] op_sel_hi:[1,1]
    ds_read_b32 v2, v3
    v_mfma_f32_32x32x16_f16 v[36:51], v[236:239], v[224:227], v[36:51]
    v_pk_mul_f16 v220, v193, v137 op_sel:[1,0] op_sel_hi:[1,1]
    v_pk_mul_f16 v221, v193, v138 op_sel:[1,0] op_sel_hi:[1,1]
    v_pk_mul_f16 v222, v193, v139 op_sel:[1,0] op_sel_hi:[1,1]
    v_pk_mul_f16 v223, v193, v140 op_sel:[1,0] op_sel_hi:[1,1]
    v_mfma_f32_32x32x16_f16 v[52:67], v[236:239], v[216:219], v[52:67]
    v_pk_mul_f16 v224, v200, v151 op_sel:[1,0] op_sel_hi:[1,1]
    v_pk_mul_f16 v225, v200, v152 op_sel:[1,0] op_sel_hi:[1,1]
    v_pk_mul_f16 v226, v200, v153 op_sel:[1,0] op_sel_hi:[1,1]
    v_pk_mul_f16 v227, v200, v154 op_sel:[1,0] op_sel_hi:[1,1]
    s_waitcnt lgkmcnt(0)
    v_mfma_f32_32x32x16_f16 v[4:19], v[240:243], v[220:223], v[4:19]
    ds_read_b128 v[236:239], v1 offset:40960
    v_pk_mul_f16 v216, v207, v165 op_sel:[1,0] op_sel_hi:[1,1]
    v_pk_mul_f16 v217, v207, v166 op_sel:[1,0] op_sel_hi:[1,1]
    v_pk_mul_f16 v218, v207, v167 op_sel:[1,0] op_sel_hi:[1,1]
    v_pk_mul_f16 v219, v207, v168 op_sel:[1,0] op_sel_hi:[1,1]
    v_readfirstlane_b32 s74, v2
    v_mfma_f32_32x32x16_f16 v[20:35], v[240:243], v[224:227], v[20:35]
    v_pk_mul_f16 v220, v214, v179 op_sel:[1,0] op_sel_hi:[1,1]
    v_pk_mul_f16 v221, v214, v180 op_sel:[1,0] op_sel_hi:[1,1]
    v_pk_mul_f16 v222, v214, v181 op_sel:[1,0] op_sel_hi:[1,1]
    v_pk_mul_f16 v223, v214, v182 op_sel:[1,0] op_sel_hi:[1,1]
    s_cmp_lt_u32 s74, 4
    s_cbranch_scc1 L_cs_12
L_cb_13:
    v_mfma_f32_32x32x16_f16 v[36:51], v[240:243], v[216:219], v[36:51]
    v_pk_mul_f16 v224, v193, v141 op_sel:[1,0] op_sel_hi:[1,1]
    v_pk_mul_f16 v225, v193, v142 op_sel:[1,0] op_sel_hi:[1,1]
    v_pk_mul_f16 v226, v193, v143 op_sel:[1,0] op_sel_hi:[1,1]
    v_pk_mul_f16 v227, v193, v144 op_sel:[1,0] op_sel_hi:[1,1]
    v_mfma_f32_32x32x16_f16 v[52:67], v[240:243], v[220:223], v[52:67]
    v_pk_mul_f16 v216, v200, v155 op_sel:[1,0] op_sel_hi:[1,1]
    v_pk_mul_f16 v217, v200, v156 op_sel:[1,0] op_sel_hi:[1,1]
    v_pk_mul_f16 v218, v200, v157 op_sel:[1,0] op_sel_hi:[1,1]
    v_pk_mul_f16 v219, v200, v158 op_sel:[1,0] op_sel_hi:[1,1]
    v_mfma_f32_32x32x16_f16 v[4:19], v[228:231], v[224:227], v[4:19]
    ds_read_b128 v[240:243], v1 offset:41984
    v_pk_mul_f16 v220, v207, v169 op_sel:[1,0] op_sel_hi:[1,1]
    v_pk_mul_f16 v221, v207, v170 op_sel:[1,0] op_sel_hi:[1,1]
    v_pk_mul_f16 v222, v207, v171 op_sel:[1,0] op_sel_hi:[1,1]
    v_pk_mul_f16 v223, v207, v172 op_sel:[1,0] op_sel_hi:[1,1]
    v_mfma_f32_32x32x16_f16 v[20:35], v[228:231], v[216:219], v[20:35]
    v_pk_mul_f16 v224, v214, v183 op_sel:[1,0] op_sel_hi:[1,1]
    v_pk_mul_f16 v225, v214, v184 op_sel:[1,0] op_sel_hi:[1,1]
    v_pk_mul_f16 v226, v214, v185 op_sel:[1,0] op_sel_hi:[1,1]
    v_pk_mul_f16 v227, v214, v186 op_sel:[1,0] op_sel_hi:[1,1]
    v_mfma_f32_32x32x16_f16 v[36:51], v[228:231], v[220:223], v[36:51]
    v_pk_mul_f16 v216, v194, v132 op_sel_hi:[0,1]
    v_pk_mul_f16 v217, v194, v133 op_sel_hi:[0,1]
    v_pk_mul_f16 v218, v194, v134 op_sel_hi:[0,1]
    v_pk_mul_f16 v219, v194, v135 op_sel_hi:[0,1]
    v_mfma_f32_32x32x16_f16 v[52:67], v[228:231], v[224:227], v[52:67]
    v_pk_mul_f16 v220, v201, v146 op_sel_hi:[0,1]
    v_pk_mul_f16 v221, v201, v147 op_sel_hi:[0,1]
    v_pk_mul_f16 v222, v201, v148 op_sel_hi:[0,1]
    v_pk_mul_f16 v223, v201, v149 op_sel_hi:[0,1]
    v_mfma_f32_32x32x16_f16 v[4:19], v[232:235], v[216:219], v[4:19]
    ds_read_b128 v[228:231], v1 offset:43008
    v_pk_mul_f16 v224, v208, v160 op_sel_hi:[0,1]
    v_pk_mul_f16 v225, v208, v161 op_sel_hi:[0,1]
    v_pk_mul_f16 v226, v208, v162 op_sel_hi:[0,1]
    v_pk_mul_f16 v227, v208, v163 op_sel_hi:[0,1]
    v_mfma_f32_32x32x16_f16 v[20:35], v[232:235], v[220:223], v[20:35]
    v_pk_mul_f16 v216, v215, v174 op_sel_hi:[0,1]
    v_pk_mul_f16 v217, v215, v175 op_sel_hi:[0,1]
    v_pk_mul_f16 v218, v215, v176 op_sel_hi:[0,1]
    v_pk_mul_f16 v219, v215, v177 op_sel_hi:[0,1]
    v_mfma_f32_32x32x16_f16 v[36:51], v[232:235], v[224:227], v[36:51]
    v_pk_mul_f16 v220, v194, v136 op_sel_hi:[0,1]
    v_pk_mul_f16 v221, v194, v137 op_sel_hi:[0,1]
    v_pk_mul_f16 v222, v194, v138 op_sel_hi:[0,1]
    v_pk_mul_f16 v223, v194, v139 op_sel_hi:[0,1]
    v_mfma_f32_32x32x16_f16 v[52:67], v[232:235], v[216:219], v[52:67]
    v_pk_mul_f16 v224, v201, v150 op_sel_hi:[0,1]
    v_pk_mul_f16 v225, v201, v151 op_sel_hi:[0,1]
    v_pk_mul_f16 v226, v201, v152 op_sel_hi:[0,1]
    v_pk_mul_f16 v227, v201, v153 op_sel_hi:[0,1]
    s_waitcnt lgkmcnt(0)
    v_mfma_f32_32x32x16_f16 v[4:19], v[236:239], v[220:223], v[4:19]
    ds_read_b128 v[232:235], v1 offset:44032
    v_pk_mul_f16 v216, v208, v164 op_sel_hi:[0,1]
    v_pk_mul_f16 v217, v208, v165 op_sel_hi:[0,1]
    v_pk_mul_f16 v218, v208, v166 op_sel_hi:[0,1]
    v_pk_mul_f16 v219, v208, v167 op_sel_hi:[0,1]
    v_mfma_f32_32x32x16_f16 v[20:35], v[236:239], v[224:227], v[20:35]
    v_pk_mul_f16 v220, v215, v178 op_sel_hi:[0,1]
    v_pk_mul_f16 v221, v215, v179 op_sel_hi:[0,1]
    v_pk_mul_f16 v222, v215, v180 op_sel_hi:[0,1]
    v_pk_mul_f16 v223, v215, v181 op_sel_hi:[0,1]
    v_mfma_f32_32x32x16_f16 v[36:51], v[236:239], v[216:219], v[36:51]
    v_pk_mul_f16 v224, v194, v140 op_sel_hi:[0,1]
    v_pk_mul_f16 v225, v194, v141 op_sel_hi:[0,1]
    v_pk_mul_f16 v226, v194, v142 op_sel_hi:[0,1]
    v_pk_mul_f16 v227, v194, v143 op_sel_hi:[0,1]
    v_mfma_f32_32x32x16_f16 v[52:67], v[236:239], v[220:223], v[52:67]
    v_pk_mul_f16 v216, v201, v154 op_sel_hi:[0,1]
    v_pk_mul_f16 v217, v201, v155 op_sel_hi:[0,1]
    v_pk_mul_f16 v218, v201, v156 op_sel_hi:[0,1]
    v_pk_mul_f16 v219, v201, v157 op_sel_hi:[0,1]
    v_mfma_f32_32x32x16_f16 v[4:19], v[240:243], v[224:227], v[4:19]
    ds_read_b128 v[236:239], v1 offset:45056
    v_pk_mul_f16 v220, v208, v168 op_sel_hi:[0,1]
    v_pk_mul_f16 v221, v208, v169 op_sel_hi:[0,1]
    v_pk_mul_f16 v222, v208, v170 op_sel_hi:[0,1]
    v_pk_mul_f16 v223, v208, v171 op_sel_hi:[0,1]
    v_mfma_f32_32x32x16_f16 v[20:35], v[240:243], v[216:219], v[20:35]
    v_pk_mul_f16 v224, v215, v182 op_sel_hi:[0,1]
    v_pk_mul_f16 v225, v215, v183 op_sel_hi:[0,1]
    v_pk_mul_f16 v226, v215, v184 op_sel_hi:[0,1]
    v_pk_mul_f16 v227, v215, v185 op_sel_hi:[0,1]
    v_mfma_f32_32x32x16_f16 v[36:51], v[240:243], v[220:223], v[36:51]
    v_pk_mul_f16 v216, v194, v144 op_sel_hi:[0,1]
    v_mov_b32 v217, v188
    v_mov_b32 v218, v189
    v_mov_b32 v219, v190
    v_mfma_f32_32x32x16_f16 v[52:67], v[240:243], v[224:227], v[52:67]
    v_mov_b32 v220, v191
    v_mov_b32 v221, v192
    v_mov_b32 v222, v193
    v_mov_b32 v223, v194
    v_mfma_f32_32x32x16_f16 v[4:19], v[228:231], v[216:219], v[4:19]
    ds_read_b128 v[240:243], v1 offset:46080
    v_pk_mul_f16 v224, v201, v158 op_sel_hi:[0,1]
    v_mov_b32 v225, v195
    v_mov_b32 v226, v196
    v_mov_b32 v227, v197
    s_waitcnt lgkmcnt(1)
    v_mfma_f32_32x32x16_f16 v[4:19], v[232:235], v[220:223], v[4:19]
    v_mov_b32 v216, v198
    v_mov_b32 v217, v199
    v_mov_b32 v218, v200
    v_mov_b32 v219, v201
    v_mfma_f32_32x32x16_f16 v[20:35], v[228:231], v[224:227], v[20:35]
    v_pk_mul_f16 v220, v208, v172 op_sel_hi:[0,1]
    v_mov_b32 v221, v202
    v_mov_b32 v222, v203
    v_mov_b32 v223, v204
    v_mfma_f32_32x32x16_f16 v[20:35], v[232:235], v[216:219], v[20:35]
    s_nop 1
    v_max3_f32 v244, |v4|, |v5|, |v6|
    v_max3_f32 v252, |v7|, |v8|, |v9|
    v_max3_f32 v244, v244, |v10|, |v11|
    v_max3_f32 v252, v252, |v12|, |v13|
    v_max3_f32 v244, v244, |v14|, |v15|
    v_mov_b32 v224, v205
    v_mov_b32 v225, v206
    v_mov_b32 v226, v207
    v_mov_b32 v227, v208
    v_mfma_f32_32x32x16_f16 v[36:51], v[228:231], v[220:223], v[36:51]
    v_max3_f32 v244, v244, v252, |v16|
    v_mov_b32 v252, v244
    v_cvt_pk_f16_f32 v188, v4, v5
    v_cvt_pk_f16_f32 v189, v6, v7
    v_permlane32_swap_b32 v244, v252
    v_pk_mul_f16 v216, v215, v186 op_sel_hi:[0,1]
    v_mov_b32 v217, v209
    v_mov_b32 v218, v210
    v_mov_b32 v219, v211
    v_mfma_f32_32x32x16_f16 v[36:51], v[232:235], v[224:227], v[36:51]
    v_max3_f32 v244, v244, v252, s81
    v_lshrrev_b32 v252, 23, v244
    v_sub_u32 v244, s80, v252
    v_lshlrev_b32 v244, 10, v244
    v_pk_mul_f16 v188, v188, v244 op_sel_hi:[1,0]
    v_mov_b32 v220, v212
    v_mov_b32 v221, v213
    v_mov_b32 v222, v214
    v_mov_b32 v223, v215
    v_mfma_f32_32x32x16_f16 v[52:67], v[228:231], v[216:219], v[52:67]
    v_max3_f32 v245, |v20|, |v21|, |v22|
    v_max3_f32 v253, |v23|, |v24|, |v25|
    v_max3_f32 v245, v245, |v26|, |v27|
    v_max3_f32 v253, v253, |v28|, |v29|
    v_max3_f32 v245, v245, |v30|, |v31|
    v_pk_mul_f16 v224, v188, v132 op_sel_hi:[0,1]
    v_pk_mul_f16 v225, v188, v133 op_sel_hi:[0,1]
    v_pk_mul_f16 v226, v188, v134 op_sel_hi:[0,1]
    v_pk_mul_f16 v227, v188, v135 op_sel_hi:[0,1]
    v_mfma_f32_32x32x16_f16 v[52:67], v[232:235], v[220:223], v[52:67]
    ds_read_b128 v[228:231], v1 offset:47104
    v_max3_f32 v245, v245, v253, |v32|
    v_mov_b32 v253, v245
    v_cvt_pk_f16_f32 v195, v20, v21
    v_cvt_pk_f16_f32 v196, v22, v23
    v_permlane32_swap_b32 v245, v253
    v_pk_mul_f16 v216, v188, v136 op_sel_hi:[0,1]
    v_pk_mul_f16 v217, v188, v137 op_sel_hi:[0,1]
    v_pk_mul_f16 v218, v188, v138 op_sel_hi:[0,1]
    v_pk_mul_f16 v219, v188, v139 op_sel_hi:[0,1]
    v_mfma_f32_32x32x16_f16 v[68:83], v[236:239], v[224:227], 0
    ds_read_b128 v[232:235], v1 offset:48128
    v_max3_f32 v245, v245, v253, s81
    v_lshrrev_b32 v253, 23, v245
    v_sub_u32 v245, s80, v253
    v_lshlrev_b32 v245, 10, v245
    v_pk_mul_f16 v195, v195, v245 op_sel_hi:[1,0]
    v_pk_mul_f16 v220, v195, v146 op_sel_hi:[0,1]
    v_pk_mul_f16 v221, v195, v147 op_sel_hi:[0,1]
    v_pk_mul_f16 v222, v195, v148 op_sel_hi:[0,1]
    v_pk_mul_f16 v223, v195, v149 op_sel_hi:[0,1]
    s_waitcnt lgkmcnt(2)
    v_mfma_f32_32x32x16_f16 v[68:83], v[240:243], v[216:219], v[68:83]
    v_max3_f32 v246, |v36|, |v37|, |v38|
    v_max3_f32 v254, |v39|, |v40|, |v41|
    v_max3_f32 v246, v246, |v42|, |v43|
    v_max3_f32 v254, v254, |v44|, |v45|
    v_max3_f32 v246, v246, |v46|, |v47|
    v_pk_mul_f16 v224, v195, v150 op_sel_hi:[0,1]
    v_pk_mul_f16 v225, v195, v151 op_sel_hi:[0,1]
    v_pk_mul_f16 v226, v195, v152 op_sel_hi:[0,1]
    v_pk_mul_f16 v227, v195, v153 op_sel_hi:[0,1]
    v_mfma_f32_32x32x16_f16 v[84:99], v[236:239], v[220:223], 0
    v_max3_f32 v246, v246, v254, |v48|
    v_mov_b32 v254, v246
    v_cvt_pk_f16_f32 v202, v36, v37
    v_cvt_pk_f16_f32 v203, v38, v39
    v_permlane32_swap_b32 v246, v254
    v_max3_f32 v246, v246, v254, s81
    v_lshrrev_b32 v254, 23, v246
    v_sub_u32 v246, s80, v254
    v_lshlrev_b32 v246, 10, v246
    v_pk_mul_f16 v202, v202, v246 op_sel_hi:[1,0]
    v_pk_mul_f16 v216, v202, v160 op_sel_hi:[0,1]
    v_pk_mul_f16 v217, v202, v161 op_sel_hi:[0,1]
    v_pk_mul_f16 v218, v202, v162 op_sel_hi:[0,1]
    v_pk_mul_f16 v219, v202, v163 op_sel_hi:[0,1]
    v_mfma_f32_32x32x16_f16 v[84:99], v[240:243], v[224:227], v[84:99]
    v_max3_f32 v247, |v52|, |v53|, |v54|
    v_max3_f32 v255, |v55|, |v56|, |v57|
    v_max3_f32 v247, v247, |v58|, |v59|
    v_max3_f32 v255, v255, |v60|, |v61|
    v_max3_f32 v247, v247, |v62|, |v63|
    v_pk_mul_f16 v220, v202, v164 op_sel_hi:[0,1]
    v_pk_mul_f16 v221, v202, v165 op_sel_hi:[0,1]
    v_pk_mul_f16 v222, v202, v166 op_sel_hi:[0,1]
    v_pk_mul_f16 v223, v202, v167 op_sel_hi:[0,1]
    v_mfma_f32_32x32x16_f16 v[100:115], v[236:239], v[216:219], 0
    v_max3_f32 v247, v247, v255, |v64|
    v_mov_b32 v255, v247
    v_cvt_pk_f16_f32 v209, v52, v53
    v_cvt_pk_f16_f32 v210, v54, v55
    v_permlane32_swap_b32 v247, v255
    v_max3_f32 v247, v247, v255, s81
    v_lshrrev_b32 v255, 23, v247
    v_sub_u32 v247, s80, v255
    v_lshlrev_b32 v247, 10, v247
    v_pk_mul_f16 v209, v209, v247 op_sel_hi:[1,0]
    v_pk_mul_f16 v224, v209, v174 op_sel_hi:[0,1]
    v_pk_mul_f16 v225, v209, v175 op_sel_hi:[0,1]
    v_pk_mul_f16 v226, v209, v176 op_sel_hi:[0,1]
    v_pk_mul_f16 v227, v209, v177 op_sel_hi:[0,1]
    v_mfma_f32_32x32x16_f16 v[100:115], v[240:243], v[220:223], v[100:115]
    v_pk_mul_f16 v216, v209, v178 op_sel_hi:[0,1]
    v_pk_mul_f16 v217, v209, v179 op_sel_hi:[0,1]
    v_pk_mul_f16 v218, v209, v180 op_sel_hi:[0,1]
    v_pk_mul_f16 v219, v209, v181 op_sel_hi:[0,1]
    v_mfma_f32_32x32x16_f16 v[116:131], v[236:239], v[224:227], 0
    v_pk_mul_f16 v220, v188, v140 op_sel_hi:[0,1]
    v_pk_mul_f16 v221, v188, v141 op_sel_hi:[0,1]
    v_pk_mul_f16 v222, v188, v142 op_sel_hi:[0,1]
    v_pk_mul_f16 v223, v188, v143 op_sel_hi:[0,1]
    v_mfma_f32_32x32x16_f16 v[116:131], v[240:243], v[216:219], v[116:131]
    ds_read_b128 v[236:239], v1 offset:49152
    v_pk_mul_f16 v224, v195, v154 op_sel_hi:[0,1]
    v_pk_mul_f16 v225, v195, v155 op_sel_hi:[0,1]
    v_pk_mul_f16 v226, v195, v156 op_sel_hi:[0,1]
    v_pk_mul_f16 v227, v195, v157 op_sel_hi:[0,1]
    s_waitcnt lgkmcnt(1)
    v_mfma_f32_32x32x16_f16 v[68:83], v[228:231], v[220:223], v[68:83]
    ds_read_b128 v[240:243], v1 offset:50176
    v_pk_mul_f16 v216, v202, v168 op_sel_hi:[0,1]
    v_pk_mul_f16 v217, v202, v169 op_sel_hi:[0,1]
    v_pk_mul_f16 v218, v202, v170 op_sel_hi:[0,1]
    v_pk_mul_f16 v219, v202, v171 op_sel_hi:[0,1]
    v_pk_mul_f16 v189, v189, v244 op_sel_hi:[1,0]
    v_mfma_f32_32x32x16_f16 v[84:99], v[228:231], v[224:227], v[84:99]
    v_pk_mul_f16 v220, v209, v182 op_sel_hi:[0,1]
    v_pk_mul_f16 v221, v209, v183 op_sel_hi:[0,1]
    v_pk_mul_f16 v222, v209, v184 op_sel_hi:[0,1]
    v_pk_mul_f16 v223, v209, v185 op_sel_hi:[0,1]
    v_pk_mul_f16 v196, v196, v245 op_sel_hi:[1,0]
    v_mfma_f32_32x32x16_f16 v[100:115], v[228:231], v[216:219], v[100:115]
    v_pk_mul_f16 v224, v188, v144 op_sel_hi:[0,1]
    v_pk_mul_f16 v225, v188, v132 op_sel:[1,0] op_sel_hi:[1,1]
    v_pk_mul_f16 v226, v188, v133 op_sel:[1,0] op_sel_hi:[1,1]
    v_pk_mul_f16 v227, v188, v134 op_sel:[1,0] op_sel_hi:[1,1]
    v_pk_mul_f16 v203, v203, v246 op_sel_hi:[1,0]
    v_mfma_f32_32x32x16_f16 v[116:131], v[228:231], v[220:223], v[116:131]
    v_pk_mul_f16 v216, v195, v158 op_sel_hi:[0,1]
    v_pk_mul_f16 v217, v195, v146 op_sel:[1,0] op_sel_hi:[1,1]
    v_pk_mul_f16 v218, v195, v147 op_sel:[1,0] op_sel_hi:[1,1]
    v_pk_mul_f16 v219, v195, v148 op_sel:[1,0] op_sel_hi:[1,1]
    v_mfma_f32_32x32x16_f16 v[68:83], v[232:235], v[224:227], v[68:83]
    ds_read_b128 v[228:231], v1 offset:51200
    v_pk_mul_f16 v220, v202, v172 op_sel_hi:[0,1]
    v_pk_mul_f16 v221, v202, v160 op_sel:[1,0] op_sel_hi:[1,1]
    v_pk_mul_f16 v222, v202, v161 op_sel:[1,0] op_sel_hi:[1,1]
    v_pk_mul_f16 v223, v202, v162 op_sel:[1,0] op_sel_hi:[1,1]
    v_pk_mul_f16 v210, v210, v247 op_sel_hi:[1,0]
    v_mfma_f32_32x32x16_f16 v[84:99], v[232:235], v[216:219], v[84:99]
    v_pk_mul_f16 v224, v209, v186 op_sel_hi:[0,1]
    v_pk_mul_f16 v225, v209, v174 op_sel:[1,0] op_sel_hi:[1,1]
    v_pk_mul_f16 v226, v209, v175 op_sel:[1,0] op_sel_hi:[1,1]
    v_pk_mul_f16 v227, v209, v176 op_sel:[1,0] op_sel_hi:[1,1]
    v_mfma_f32_32x32x16_f16 v[100:115], v[232:235], v[220:223], v[100:115]
    v_pk_mul_f16 v216, v188, v135 op_sel:[1,0] op_sel_hi:[1,1]
    v_pk_mul_f16 v217, v188, v136 op_sel:[1,0] op_sel_hi:[1,1]
    v_pk_mul_f16 v218, v188, v137 op_sel:[1,0] op_sel_hi:[1,1]
    v_pk_mul_f16 v219, v188, v138 op_sel:[1,0] op_sel_hi:[1,1]
    v_cvt_pk_f16_f32 v190, v8, v9
    v_mfma_f32_32x32x16_f16 v[116:131], v[232:235], v[224:227], v[116:131]
    v_pk_mul_f16 v220, v195, v149 op_sel:[1,0] op_sel_hi:[1,1]
    v_pk_mul_f16 v221, v195, v150 op_sel:[1,0] op_sel_hi:[1,1]
    v_pk_mul_f16 v222, v195, v151 op_sel:[1,0] op_sel_hi:[1,1]
    v_pk_mul_f16 v223, v195, v152 op_sel:[1,0] op_sel_hi:[1,1]
    s_waitcnt lgkmcnt(0)
    v_mfma_f32_32x32x16_f16 v[68:83], v[236:239], v[216:219], v[68:83]
    ds_read_b128 v[232:235], v1 offset:52224
    v_pk_mul_f16 v224, v202, v163 op_sel:[1,0] op_sel_hi:[1,1]
    v_pk_mul_f16 v225, v202, v164 op_sel:[1,0] op_sel_hi:[1,1]
    v_pk_mul_f16 v226, v202, v165 op_sel:[1,0] op_sel_hi:[1,1]
    v_pk_mul_f16 v227, v202, v166 op_sel:[1,0] op_sel_hi:[1,1]
    v_cvt_pk_f16_f32 v197, v24, v25
    v_mfma_f32_32x32x16_f16 v[84:99], v[236:239], v[220:223], v[84:99]
    v_pk_mul_f16 v216, v209, v177 op_sel:[1,0] op_sel_hi:[1,1]
    v_pk_mul_f16 v217, v209, v178 op_sel:[1,0] op_sel_hi:[1,1]
    v_pk_mul_f16 v218, v209, v179 op_sel:[1,0] op_sel_hi:[1,1]
    v_pk_mul_f16 v219, v209, v180 op_sel:[1,0] op_sel_hi:[1,1]
    v_cvt_pk_f16_f32 v204, v40, v41
    v_mfma_f32_32x32x16_f16 v[100:115], v[236:239], v[224:227], v[100:115]
    v_pk_mul_f16 v220, v188, v139 op_sel:[1,0] op_sel_hi:[1,1]
    v_pk_mul_f16 v221, v188, v140 op_sel:[1,0] op_sel_hi:[1,1]
    v_pk_mul_f16 v222, v188, v141 op_sel:[1,0] op_sel_hi:[1,1]
    v_pk_mul_f16 v223, v188, v142 op_sel:[1,0] op_sel_hi:[1,1]
    v_mfma_f32_32x32x16_f16 v[116:131], v[236:239], v[216:219], v[116:131]
    v_pk_mul_f16 v224, v195, v153 op_sel:[1,0] op_sel_hi:[1,1]
    v_pk_mul_f16 v225, v195, v154 op_sel:[1,0] op_sel_hi:[1,1]
    v_pk_mul_f16 v226, v195, v155 op_sel:[1,0] op_sel_hi:[1,1]
    v_pk_mul_f16 v227, v195, v156 op_sel:[1,0] op_sel_hi:[1,1]
    v_cvt_pk_f16_f32 v211, v56, v57
    v_mfma_f32_32x32x16_f16 v[68:83], v[240:243], v[220:223], v[68:83]
    ds_read_b128 v[236:239], v1 offset:53248
    v_pk_mul_f16 v216, v202, v167 op_sel:[1,0] op_sel_hi:[1,1]
    v_pk_mul_f16 v217, v202, v168 op_sel:[1,0] op_sel_hi:[1,1]
    v_pk_mul_f16 v218, v202, v169 op_sel:[1,0] op_sel_hi:[1,1]
    v_pk_mul_f16 v219, v202, v170 op_sel:[1,0] op_sel_hi:[1,1]
    v_mfma_f32_32x32x16_f16 v[84:99], v[240:243], v[224:227], v[84:99]
    v_pk_mul_f16 v220, v209, v181 op_sel:[1,0] op_sel_hi:[1,1]
    v_pk_mul_f16 v221, v209, v182 op_sel:[1,0] op_sel_hi:[1,1]
    v_pk_mul_f16 v222, v209, v183 op_sel:[1,0] op_sel_hi:[1,1]
    v_pk_mul_f16 v223, v209, v184 op_sel:[1,0] op_sel_hi:[1,1]
    v_pk_mul_f16 v190, v190, v244 op_sel_hi:[1,0]
    v_mfma_f32_32x32x16_f16 v[100:115], v[240:243], v[216:219], v[100:115]
    v_pk_mul_f16 v224, v188, v143 op_sel:[1,0] op_sel_hi:[1,1]
    v_pk_mul_f16 v225, v188, v144 op_sel:[1,0] op_sel_hi:[1,1]
    v_pk_mul_f16 v226, v189, v132 op_sel_hi:[0,1]
    v_pk_mul_f16 v227, v189, v133 op_sel_hi:[0,1]
    v_mfma_f32_32x32x16_f16 v[116:131], v[240:243], v[220:223], v[116:131]
    v_pk_mul_f16 v216, v195, v157 op_sel:[1,0] op_sel_hi:[1,1]
    v_pk_mul_f16 v217, v195, v158 op_sel:[1,0] op_sel_hi:[1,1]
    v_pk_mul_f16 v218, v196, v146 op_sel_hi:[0,1]
    v_pk_mul_f16 v219, v196, v147 op_sel_hi:[0,1]
    v_pk_mul_f16 v197, v197, v245 op_sel_hi:[1,0]
    v_mfma_f32_32x32x16_f16 v[68:83], v[228:231], v[224:227], v[68:83]
    ds_read_b128 v[240:243], v1 offset:54272
    v_pk_mul_f16 v220, v202, v171 op_sel:[1,0] op_sel_hi:[1,1]
    v_pk_mul_f16 v221, v202, v172 op_sel:[1,0] op_sel_hi:[1,1]
    v_pk_mul_f16 v222, v203, v160 op_sel_hi:[0,1]
    v_pk_mul_f16 v223, v203, v161 op_sel_hi:[0,1]
    v_pk_mul_f16 v204, v204, v246 op_sel_hi:[1,0]
    v_mfma_f32_32x32x16_f16 v[84:99], v[228:231], v[216:219], v[84:99]
    v_pk_mul_f16 v224, v209, v185 op_sel:[1,0] op_sel_hi:[1,1]
    v_pk_mul_f16 v225, v209, v186 op_sel:[1,0] op_sel_hi:[1,1]
    v_pk_mul_f16 v226, v210, v174 op_sel_hi:[0,1]
    v_pk_mul_f16 v227, v210, v175 op_sel_hi:[0,1]
    v_mfma_f32_32x32x16_f16 v[100:115], v[228:231], v[220:223], v[100:115]
    v_pk_mul_f16 v216, v189, v134 op_sel_hi:[0,1]
    v_pk_mul_f16 v217, v189, v135 op_sel_hi:[0,1]
    v_pk_mul_f16 v218, v189, v136 op_sel_hi:[0,1]
    v_pk_mul_f16 v219, v189, v137 op_sel_hi:[0,1]
    v_pk_mul_f16 v211, v211, v247 op_sel_hi:[1,0]
    v_mfma_f32_32x32x16_f16 v[116:131], v[228:231], v[224:227], v[116:131]
    v_pk_mul_f16 v220, v196, v148 op_sel_hi:[0,1]
    v_pk_mul_f16 v221, v196, v149 op_sel_hi:[0,1]
    v_pk_mul_f16 v222, v196, v150 op_sel_hi:[0,1]
    v_pk_mul_f16 v223, v196, v151 op_sel_hi:[0,1]
    s_waitcnt lgkmcnt(0)
    v_mfma_f32_32x32x16_f16 v[68:83], v[232:235], v[216:219], v[68:83]
    ds_read_b128 v[228:231], v1 offset:55296
    v_pk_mul_f16 v224, v203, v162 op_sel_hi:[0,1]
    v_pk_mul_f16 v225, v203, v163 op_sel_hi:[0,1]
    v_pk_mul_f16 v226, v203, v164 op_sel_hi:[0,1]
    v_pk_mul_f16 v227, v203, v165 op_sel_hi:[0,1]
    v_cvt_pk_f16_f32 v191, v10, v11
    v_mfma_f32_32x32x16_f16 v[84:99], v[232:235], v[220:223], v[84:99]
    v_pk_mul_f16 v216, v210, v176 op_sel_hi:[0,1]
    v_pk_mul_f16 v217, v210, v177 op_sel_hi:[0,1]
    v_pk_mul_f16 v218, v210, v178 op_sel_hi:[0,1]
    v_pk_mul_f16 v219, v210, v179 op_sel_hi:[0,1]
    v_mfma_f32_32x32x16_f16 v[100:115], v[232:235], v[224:227], v[100:115]
    v_pk_mul_f16 v220, v189, v138 op_sel_hi:[0,1]
    v_pk_mul_f16 v221, v189, v139 op_sel_hi:[0,1]
    v_pk_mul_f16 v222, v189, v140 op_sel_hi:[0,1]
    v_pk_mul_f16 v223, v189, v141 op_sel_hi:[0,1]
    v_cvt_pk_f16_f32 v198, v26, v27
    v_mfma_f32_32x32x16_f16 v[116:131], v[232:235], v[216:219], v[116:131]
    v_pk_mul_f16 v224, v196, v152 op_sel_hi:[0,1]
    v_pk_mul_f16 v225, v196, v153 op_sel_hi:[0,1]
    v_pk_mul_f16 v226, v196, v154 op_sel_hi:[0,1]
    v_pk_mul_f16 v227, v196, v155 op_sel_hi:[0,1]
    v_mfma_f32_32x32x16_f16 v[68:83], v[236:239], v[220:223], v[68:83]
    ds_read_b128 v[232:235], v1 offset:56320
    v_pk_mul_f16 v216, v203, v166 op_sel_hi:[0,1]
    v_pk_mul_f16 v217, v203, v167 op_sel_hi:[0,1]
    v_pk_mul_f16 v218, v203, v168 op_sel_hi:[0,1]
    v_pk_mul_f16 v219, v203, v169 op_sel_hi:[0,1]
    v_cvt_pk_f16_f32 v205, v42, v43
    v_mfma_f32_32x32x16_f16 v[84:99], v[236:239], v[224:227], v[84:99]
    v_pk_mul_f16 v220, v210, v180 op_sel_hi:[0,1]
    v_pk_mul_f16 v221, v210, v181 op_sel_hi:[0,1]
    v_pk_mul_f16 v222, v210, v182 op_sel_hi:[0,1]
    v_pk_mul_f16 v223, v210, v183 op_sel_hi:[0,1]
    v_cvt_pk_f16_f32 v212, v58, v59
    v_mfma_f32_32x32x16_f16 v[100:115], v[236:239], v[216:219], v[100:115]
    v_pk_mul_f16 v224, v189, v142 op_sel_hi:[0,1]
    v_pk_mul_f16 v225, v189, v143 op_sel_hi:[0,1]
    v_pk_mul_f16 v226, v189, v144 op_sel_hi:[0,1]
    v_pk_mul_f16 v227, v189, v132 op_sel:[1,0] op_sel_hi:[1,1]
    v_mfma_f32_32x32x16_f16 v[116:131], v[236:239], v[220:223], v[116:131]
    v_pk_mul_f16 v216, v196, v156 op_sel_hi:[0,1]
    v_pk_mul_f16 v217, v196, v157 op_sel_hi:[0,1]
    v_pk_mul_f16 v218, v196, v158 op_sel_hi:[0,1]
    v_pk_mul_f16 v219, v196, v146 op_sel:[1,0] op_sel_hi:[1,1]
    v_pk_mul_f16 v191, v191, v244 op_sel_hi:[1,0]
    v_mfma_f32_32x32x16_f16 v[68:83], v[240:243], v[224:227], v[68:83]
    ds_read_b128 v[236:239], v1 offset:57344
    v_pk_mul_f16 v220, v203, v170 op_sel_hi:[0,1]
    v_pk_mul_f16 v221, v203, v171 op_sel_hi:[0,1]
    v_pk_mul_f16 v222, v203, v172 op_sel_hi:[0,1]
    v_pk_mul_f16 v223, v203, v160 op_sel:[1,0] op_sel_hi:[1,1]
    v_mfma_f32_32x32x16_f16 v[84:99], v[240:243], v[216:219], v[84:99]
    v_pk_mul_f16 v224, v210, v184 op_sel_hi:[0,1]
    v_pk_mul_f16 v225, v210, v185 op_sel_hi:[0,1]
    v_pk_mul_f16 v226, v210, v186 op_sel_hi:[0,1]
    v_pk_mul_f16 v227, v210, v174 op_sel:[1,0] op_sel_hi:[1,1]
    v_pk_mul_f16 v198, v198, v245 op_sel_hi:[1,0]
    v_mfma_f32_32x32x16_f16 v[100:115], v[240:243], v[220:223], v[100:115]
    v_pk_mul_f16 v216, v189, v133 op_sel:[1,0] op_sel_hi:[1,1]
    v_pk_mul_f16 v217, v189, v134 op_sel:[1,0] op_sel_hi:[1,1]
    v_pk_mul_f16 v218, v189, v135 op_sel:[1,0] op_sel_hi:[1,1]
    v_pk_mul_f16 v219, v189, v136 op_sel:[1,0] op_sel_hi:[1,1]
    v_mfma_f32_32x32x16_f16 v[116:131], v[240:243], v[224:227], v[116:131]
    v_pk_mul_f16 v220, v196, v147 op_sel:[1,0] op_sel_hi:[1,1]
    v_pk_mul_f16 v221, v196, v148 op_sel:[1,0] op_sel_hi:[1,1]
    v_pk_mul_f16 v222, v196, v149 op_sel:[1,0] op_sel_hi:[1,1]
    v_pk_mul_f16 v223, v196, v150 op_sel:[1,0] op_sel_hi:[1,1]
    v_pk_mul_f16 v205, v205, v246 op_sel_hi:[1,0]
    s_waitcnt lgkmcnt(0)
    v_mfma_f32_32x32x16_f16 v[68:83], v[228:231], v[216:219], v[68:83]
    ds_read_b128 v[240:243], v1 offset:58368
    v_pk_mul_f16 v224, v203, v161 op_sel:[1,0] op_sel_hi:[1,1]
    v_pk_mul_f16 v225, v203, v162 op_sel:[1,0] op_sel_hi:[1,1]
    v_pk_mul_f16 v226, v203, v163 op_sel:[1,0] op_sel_hi:[1,1]
    v_pk_mul_f16 v227, v203, v164 op_sel:[1,0] op_sel_hi:[1,1]
    v_pk_mul_f16 v212, v212, v247 op_sel_hi:[1,0]
    v_mfma_f32_32x32x16_f16 v[84:99], v[228:231], v[220:223], v[84:99]
    v_pk_mul_f16 v216, v210, v175 op_sel:[1,0] op_sel_hi:[1,1]
    v_pk_mul_f16 v217, v210, v176 op_sel:[1,0] op_sel_hi:[1,1]
    v_pk_mul_f16 v218, v210, v177 op_sel:[1,0] op_sel_hi:[1,1]
    v_pk_mul_f16 v219, v210, v178 op_sel:[1,0] op_sel_hi:[1,1]
    v_mfma_f32_32x32x16_f16 v[100:115], v[228:231], v[224:227], v[100:115]
    v_pk_mul_f16 v220, v189, v137 op_sel:[1,0] op_sel_hi:[1,1]
    v_pk_mul_f16 v221, v189, v138 op_sel:[1,0] op_sel_hi:[1,1]
    v_pk_mul_f16 v222, v189, v139 op_sel:[1,0] op_sel_hi:[1,1]
    v_pk_mul_f16 v223, v189, v140 op_sel:[1,0] op_sel_hi:[1,1]
    v_cvt_pk_f16_f32 v192, v12, v13
    v_mfma_f32_32x32x16_f16 v[116:131], v[228:231], v[216:219], v[116:131]
    v_pk_mul_f16 v224, v196, v151 op_sel:[1,0] op_sel_hi:[1,1]
    v_pk_mul_f16 v225, v196, v152 op_sel:[1,0] op_sel_hi:[1,1]
    v_pk_mul_f16 v226, v196, v153 op_sel:[1,0] op_sel_hi:[1,1]
    v_pk_mul_f16 v227, v196, v154 op_sel:[1,0] op_sel_hi:[1,1]
    v_mfma_f32_32x32x16_f16 v[68:83], v[232:235], v[220:223], v[68:83]
    ds_read_b128 v[228:231], v1 offset:59392
    v_pk_mul_f16 v216, v203, v165 op_sel:[1,0] op_sel_hi:[1,1]
    v_pk_mul_f16 v217, v203, v166 op_sel:[1,0] op_sel_hi:[1,1]
    v_pk_mul_f16 v218, v203, v167 op_sel:[1,0] op_sel_hi:[1,1]
    v_pk_mul_f16 v219, v203, v168 op_sel:[1,0] op_sel_hi:[1,1]
    v_cvt_pk_f16_f32 v199, v28, v29
    v_mfma_f32_32x32x16_f16 v[84:99], v[232:235], v[224:227], v[84:99]
    v_pk_mul_f16 v220, v210, v179 op_sel:[1,0] op_sel_hi:[1,1]
    v_pk_mul_f16 v221, v210, v180 op_sel:[1,0] op_sel_hi:[1,1]
    v_pk_mul_f16 v222, v210, v181 op_sel:[1,0] op_sel_hi:[1,1]
    v_pk_mul_f16 v223, v210, v182 op_sel:[1,0] op_sel_hi:[1,1]
    v_mfma_f32_32x32x16_f16 v[100:115], v[232:235], v[216:219], v[100:115]
    v_pk_mul_f16 v224, v189, v141 op_sel:[1,0] op_sel_hi:[1,1]
    v_pk_mul_f16 v225, v189, v142 op_sel:[1,0] op_sel_hi:[1,1]
    v_pk_mul_f16 v226, v189, v143 op_sel:[1,0] op_sel_hi:[1,1]
    v_pk_mul_f16 v227, v189, v144 op_sel:[1,0] op_sel_hi:[1,1]
    v_cvt_pk_f16_f32 v206, v44, v45
    v_mfma_f32_32x32x16_f16 v[116:131], v[232:235], v[220:223], v[116:131]
    v_pk_mul_f16 v216, v196, v155 op_sel:[1,0] op_sel_hi:[1,1]
    v_pk_mul_f16 v217, v196, v156 op_sel:[1,0] op_sel_hi:[1,1]
    v_pk_mul_f16 v218, v196, v157 op_sel:[1,0] op_sel_hi:[1,1]
    v_pk_mul_f16 v219, v196, v158 op_sel:[1,0] op_sel_hi:[1,1]
    v_mfma_f32_32x32x16_f16 v[68:83], v[236:239], v[224:227], v[68:83]
    ds_read_b128 v[232:235], v1 offset:60416
    v_pk_mul_f16 v220, v203, v169 op_sel:[1,0] op_sel_hi:[1,1]
    v_pk_mul_f16 v221, v203, v170 op_sel:[1,0] op_sel_hi:[1,1]
    v_pk_mul_f16 v222, v203, v171 op_sel:[1,0] op_sel_hi:[1,1]
    v_pk_mul_f16 v223, v203, v172 op_sel:[1,0] op_sel_hi:[1,1]
    v_mov_b32 v3, 45520
    v_mfma_f32_32x32x16_f16 v[84:99], v[236:239], v[216:219], v[84:99]
    v_pk_mul_f16 v224, v210, v183 op_sel:[1,0] op_sel_hi:[1,1]
    v_pk_mul_f16 v225, v210, v184 op_sel:[1,0] op_sel_hi:[1,1]
    v_pk_mul_f16 v226, v210, v185 op_sel:[1,0] op_sel_hi:[1,1]
    v_pk_mul_f16 v227, v210, v186 op_sel:[1,0] op_sel_hi:[1,1]
    ds_read_b64 v[2:3], v3
    v_mfma_f32_32x32x16_f16 v[100:115], v[236:239], v[220:223], v[100:115]
    v_pk_mul_f16 v216, v190, v132 op_sel_hi:[0,1]
    v_pk_mul_f16 v217, v190, v133 op_sel_hi:[0,1]
    v_pk_mul_f16 v218, v190, v134 op_sel_hi:[0,1]
    v_pk_mul_f16 v219, v190, v135 op_sel_hi:[0,1]
    v_mfma_f32_32x32x16_f16 v[116:131], v[236:239], v[224:227], v[116:131]
    v_pk_mul_f16 v220, v197, v146 op_sel_hi:[0,1]
    v_pk_mul_f16 v221, v197, v147 op_sel_hi:[0,1]
    v_pk_mul_f16 v222, v197, v148 op_sel_hi:[0,1]
    v_pk_mul_f16 v223, v197, v149 op_sel_hi:[0,1]
    v_cvt_pk_f16_f32 v213, v60, v61
    s_waitcnt lgkmcnt(0)
    v_mfma_f32_32x32x16_f16 v[68:83], v[240:243], v[216:219], v[68:83]
    ds_read_b128 v[236:239], v1 offset:61440
    v_pk_mul_f16 v224, v204, v160 op_sel_hi:[0,1]
    v_pk_mul_f16 v225, v204, v161 op_sel_hi:[0,1]
    v_pk_mul_f16 v226, v204, v162 op_sel_hi:[0,1]
    v_pk_mul_f16 v227, v204, v163 op_sel_hi:[0,1]
    v_readfirstlane_b32 s54, v2
    v_mfma_f32_32x32x16_f16 v[84:99], v[240:243], v[220:223], v[84:99]
    v_pk_mul_f16 v216, v211, v174 op_sel_hi:[0,1]
    v_pk_mul_f16 v217, v211, v175 op_sel_hi:[0,1]
    v_pk_mul_f16 v218, v211, v176 op_sel_hi:[0,1]
    v_pk_mul_f16 v219, v211, v177 op_sel_hi:[0,1]
    v_readfirstlane_b32 s55, v3
    v_mfma_f32_32x32x16_f16 v[100:115], v[240:243], v[224:227], v[100:115]
    v_pk_mul_f16 v220, v190, v136 op_sel_hi:[0,1]
    v_pk_mul_f16 v221, v190, v137 op_sel_hi:[0,1]
    v_pk_mul_f16 v222, v190, v138 op_sel_hi:[0,1]
    v_pk_mul_f16 v223, v190, v139 op_sel_hi:[0,1]
    s_sub_u32 s72, s52, s53
    v_mfma_f32_32x32x16_f16 v[116:131], v[240:243], v[216:219], v[116:131]
    v_pk_mul_f16 v224, v197, v150 op_sel_hi:[0,1]
    v_pk_mul_f16 v225, v197, v151 op_sel_hi:[0,1]
    v_pk_mul_f16 v226, v197, v152 op_sel_hi:[0,1]
    v_pk_mul_f16 v227, v197, v153 op_sel_hi:[0,1]
    s_add_u32 s72, s72, s55
    v_mfma_f32_32x32x16_f16 v[68:83], v[228:231], v[220:223], v[68:83]
    ds_read_b128 v[240:243], v1 offset:62464
    v_pk_mul_f16 v216, v204, v164 op_sel_hi:[0,1]
    v_pk_mul_f16 v217, v204, v165 op_sel_hi:[0,1]
    v_pk_mul_f16 v218, v204, v166 op_sel_hi:[0,1]
    v_pk_mul_f16 v219, v204, v167 op_sel_hi:[0,1]
    s_sub_u32 s72, s72, 260
    v_mfma_f32_32x32x16_f16 v[84:99], v[228:231], v[224:227], v[84:99]
    v_pk_mul_f16 v220, v211, v178 op_sel_hi:[0,1]
    v_pk_mul_f16 v221, v211, v179 op_sel_hi:[0,1]
    v_pk_mul_f16 v222, v211, v180 op_sel_hi:[0,1]
    v_pk_mul_f16 v223, v211, v181 op_sel_hi:[0,1]
    s_add_u32 s64, s72, s60
    v_mfma_f32_32x32x16_f16 v[100:115], v[228:231], v[216:219], v[100:115]
    v_pk_mul_f16 v224, v190, v140 op_sel_hi:[0,1]
    v_pk_mul_f16 v225, v190, v141 op_sel_hi:[0,1]
    v_pk_mul_f16 v226, v190, v142 op_sel_hi:[0,1]
    v_pk_mul_f16 v227, v190, v143 op_sel_hi:[0,1]
    s_add_u32 s65, s72, s61
    v_mfma_f32_32x32x16_f16 v[116:131], v[228:231], v[220:223], v[116:131]
    v_pk_mul_f16 v216, v197, v154 op_sel_hi:[0,1]
    v_pk_mul_f16 v217, v197, v155 op_sel_hi:[0,1]
    v_pk_mul_f16 v218, v197, v156 op_sel_hi:[0,1]
    v_pk_mul_f16 v219, v197, v157 op_sel_hi:[0,1]
    s_add_u32 s66, s72, s62
    v_mfma_f32_32x32x16_f16 v[68:83], v[232:235], v[224:227], v[68:83]
    ds_read_b128 v[228:231], v1 offset:63488
    v_pk_mul_f16 v220, v204, v168 op_sel_hi:[0,1]
    v_pk_mul_f16 v221, v204, v169 op_sel_hi:[0,1]
    v_pk_mul_f16 v222, v204, v170 op_sel_hi:[0,1]
    v_pk_mul_f16 v223, v204, v171 op_sel_hi:[0,1]
    s_add_u32 s67, s72, s63
    v_mfma_f32_32x32x16_f16 v[84:99], v[232:235], v[216:219], v[84:99]
    v_pk_mul_f16 v224, v211, v182 op_sel_hi:[0,1]
    v_pk_mul_f16 v225, v211, v183 op_sel_hi:[0,1]
    v_pk_mul_f16 v226, v211, v184 op_sel_hi:[0,1]
    v_pk_mul_f16 v227, v211, v185 op_sel_hi:[0,1]
    v_mfma_f32_32x32x16_f16 v[100:115], v[232:235], v[220:223], v[100:115]
    v_pk_mul_f16 v216, v190, v144 op_sel_hi:[0,1]
    v_pk_mul_f16 v217, v190, v132 op_sel:[1,0] op_sel_hi:[1,1]
    v_pk_mul_f16 v218, v190, v133 op_sel:[1,0] op_sel_hi:[1,1]
    v_pk_mul_f16 v219, v190, v134 op_sel:[1,0] op_sel_hi:[1,1]
    v_pk_mul_f16 v192, v192, v244 op_sel_hi:[1,0]
    v_mfma_f32_32x32x16_f16 v[116:131], v[232:235], v[224:227], v[116:131]
    v_pk_mul_f16 v220, v197, v158 op_sel_hi:[0,1]
    v_pk_mul_f16 v221, v197, v146 op_sel:[1,0] op_sel_hi:[1,1]
    v_pk_mul_f16 v222, v197, v147 op_sel:[1,0] op_sel_hi:[1,1]
    v_pk_mul_f16 v223, v197, v148 op_sel:[1,0] op_sel_hi:[1,1]
    s_waitcnt lgkmcnt(0)
    v_mfma_f32_32x32x16_f16 v[68:83], v[236:239], v[216:219], v[68:83]
    ds_read_b128 v[232:235], v1 offset:64512
    v_pk_mul_f16 v224, v204, v172 op_sel_hi:[0,1]
    v_pk_mul_f16 v225, v204, v160 op_sel:[1,0] op_sel_hi:[1,1]
    v_pk_mul_f16 v226, v204, v161 op_sel:[1,0] op_sel_hi:[1,1]
    v_pk_mul_f16 v227, v204, v162 op_sel:[1,0] op_sel_hi:[1,1]
    v_pk_mul_f16 v199, v199, v245 op_sel_hi:[1,0]
    v_mfma_f32_32x32x16_f16 v[84:99], v[236:239], v[220:223], v[84:99]
    v_pk_mul_f16 v216, v211, v186 op_sel_hi:[0,1]
    v_pk_mul_f16 v217, v211, v174 op_sel:[1,0] op_sel_hi:[1,1]
    v_pk_mul_f16 v218, v211, v175 op_sel:[1,0] op_sel_hi:[1,1]
    v_pk_mul_f16 v219, v211, v176 op_sel:[1,0] op_sel_hi:[1,1]
    v_pk_mul_f16 v206, v206, v246 op_sel_hi:[1,0]
    v_mfma_f32_32x32x16_f16 v[100:115], v[236:239], v[224:227], v[100:115]
    v_pk_mul_f16 v220, v190, v135 op_sel:[1,0] op_sel_hi:[1,1]
    v_pk_mul_f16 v221, v190, v136 op_sel:[1,0] op_sel_hi:[1,1]
    v_pk_mul_f16 v222, v190, v137 op_sel:[1,0] op_sel_hi:[1,1]
    v_pk_mul_f16 v223, v190, v138 op_sel:[1,0] op_sel_hi:[1,1]
    v_mfma_f32_32x32x16_f16 v[116:131], v[236:239], v[216:219], v[116:131]
    v_pk_mul_f16 v224, v197, v149 op_sel:[1,0] op_sel_hi:[1,1]
    v_pk_mul_f16 v225, v197, v150 op_sel:[1,0] op_sel_hi:[1,1]
    v_pk_mul_f16 v226, v197, v151 op_sel:[1,0] op_sel_hi:[1,1]
    v_pk_mul_f16 v227, v197, v152 op_sel:[1,0] op_sel_hi:[1,1]
    v_pk_mul_f16 v213, v213, v247 op_sel_hi:[1,0]
    v_mfma_f32_32x32x16_f16 v[68:83], v[240:243], v[220:223], v[68:83]
    v_add_u32 v1, 65536, v1
    ds_read_b128 v[236:239], v1 offset:0
    v_pk_mul_f16 v216, v204, v163 op_sel:[1,0] op_sel_hi:[1,1]
    v_pk_mul_f16 v217, v204, v164 op_sel:[1,0] op_sel_hi:[1,1]
    v_pk_mul_f16 v218, v204, v165 op_sel:[1,0] op_sel_hi:[1,1]
    v_pk_mul_f16 v219, v204, v166 op_sel:[1,0] op_sel_hi:[1,1]
    v_mfma_f32_32x32x16_f16 v[84:99], v[240:243], v[224:227], v[84:99]
    v_pk_mul_f16 v220, v211, v177 op_sel:[1,0] op_sel_hi:[1,1]
    v_pk_mul_f16 v221, v211, v178 op_sel:[1,0] op_sel_hi:[1,1]
    v_pk_mul_f16 v222, v211, v179 op_sel:[1,0] op_sel_hi:[1,1]
    v_pk_mul_f16 v223, v211, v180 op_sel:[1,0] op_sel_hi:[1,1]
    v_cvt_pk_f16_f32 v193, v14, v15
    v_mfma_f32_32x32x16_f16 v[100:115], v[240:243], v[216:219], v[100:115]
    v_pk_mul_f16 v224, v190, v139 op_sel:[1,0] op_sel_hi:[1,1]
    v_pk_mul_f16 v225, v190, v140 op_sel:[1,0] op_sel_hi:[1,1]
    v_pk_mul_f16 v226, v190, v141 op_sel:[1,0] op_sel_hi:[1,1]
    v_pk_mul_f16 v227, v190, v142 op_sel:[1,0] op_sel_hi:[1,1]
    v_mfma_f32_32x32x16_f16 v[116:131], v[240:243], v[220:223], v[116:131]
    v_pk_mul_f16 v216, v197, v153 op_sel:[1,0] op_sel_hi:[1,1]
    v_pk_mul_f16 v217, v197, v154 op_sel:[1,0] op_sel_hi:[1,1]
    v_pk_mul_f16 v218, v197, v155 op_sel:[1,0] op_sel_hi:[1,1]
    v_pk_mul_f16 v219, v197, v156 op_sel:[1,0] op_sel_hi:[1,1]
    v_cvt_pk_f16_f32 v200, v30, v31
    v_mfma_f32_32x32x16_f16 v[68:83], v[228:231], v[224:227], v[68:83]
    ds_read_b128 v[240:243], v1 offset:1024
    v_pk_mul_f16 v220, v204, v167 op_sel:[1,0] op_sel_hi:[1,1]
    v_pk_mul_f16 v221, v204, v168 op_sel:[1,0] op_sel_hi:[1,1]
    v_pk_mul_f16 v222, v204, v169 op_sel:[1,0] op_sel_hi:[1,1]
    v_pk_mul_f16 v223, v204, v170 op_sel:[1,0] op_sel_hi:[1,1]
    v_cvt_pk_f16_f32 v207, v46, v47
    v_mfma_f32_32x32x16_f16 v[84:99], v[228:231], v[216:219], v[84:99]
    v_pk_mul_f16 v224, v211, v181 op_sel:[1,0] op_sel_hi:[1,1]
    v_pk_mul_f16 v225, v211, v182 op_sel:[1,0] op_sel_hi:[1,1]
    v_pk_mul_f16 v226, v211, v183 op_sel:[1,0] op_sel_hi:[1,1]
    v_pk_mul_f16 v227, v211, v184 op_sel:[1,0] op_sel_hi:[1,1]
    v_mfma_f32_32x32x16_f16 v[100:115], v[228:231], v[220:223], v[100:115]
    v_pk_mul_f16 v216, v190, v143 op_sel:[1,0] op_sel_hi:[1,1]
    v_pk_mul_f16 v217, v190, v144 op_sel:[1,0] op_sel_hi:[1,1]
    v_pk_mul_f16 v218, v191, v132 op_sel_hi:[0,1]
    v_pk_mul_f16 v219, v191, v133 op_sel_hi:[0,1]
    v_cvt_pk_f16_f32 v214, v62, v63
    v_mfma_f32_32x32x16_f16 v[116:131], v[228:231], v[224:227], v[116:131]
    v_pk_mul_f16 v220, v197, v157 op_sel:[1,0] op_sel_hi:[1,1]
    v_pk_mul_f16 v221, v197, v158 op_sel:[1,0] op_sel_hi:[1,1]
    v_pk_mul_f16 v222, v198, v146 op_sel_hi:[0,1]
    v_pk_mul_f16 v223, v198, v147 op_sel_hi:[0,1]
    s_waitcnt lgkmcnt(0)
    v_mfma_f32_32x32x16_f16 v[68:83], v[232:235], v[216:219], v[68:83]
    ds_read_b128 v[228:231], v1 offset:2048
    v_pk_mul_f16 v224, v204, v171 op_sel:[1,0] op_sel_hi:[1,1]
    v_pk_mul_f16 v225, v204, v172 op_sel:[1,0] op_sel_hi:[1,1]
    v_pk_mul_f16 v226, v205, v160 op_sel_hi:[0,1]
    v_pk_mul_f16 v227, v205, v161 op_sel_hi:[0,1]
    v_pk_mul_f16 v193, v193, v244 op_sel_hi:[1,0]
    v_mfma_f32_32x32x16_f16 v[84:99], v[232:235], v[220:223], v[84:99]
    v_pk_mul_f16 v216, v211, v185 op_sel:[1,0] op_sel_hi:[1,1]
    v_pk_mul_f16 v217, v211, v186 op_sel:[1,0] op_sel_hi:[1,1]
    v_pk_mul_f16 v218, v212, v174 op_sel_hi:[0,1]
    v_pk_mul_f16 v219, v212, v175 op_sel_hi:[0,1]
    v_mfma_f32_32x32x16_f16 v[100:115], v[232:235], v[224:227], v[100:115]
    v_pk_mul_f16 v220, v191, v134 op_sel_hi:[0,1]
    v_pk_mul_f16 v221, v191, v135 op_sel_hi:[0,1]
    v_pk_mul_f16 v222, v191, v136 op_sel_hi:[0,1]
    v_pk_mul_f16 v223, v191, v137 op_sel_hi:[0,1]
    v_pk_mul_f16 v200, v200, v245 op_sel_hi:[1,0]
    v_mfma_f32_32x32x16_f16 v[116:131], v[232:235], v[216:219], v[116:131]
    v_pk_mul_f16 v224, v198, v148 op_sel_hi:[0,1]
    v_pk_mul_f16 v225, v198, v149 op_sel_hi:[0,1]
    v_pk_mul_f16 v226, v198, v150 op_sel_hi:[0,1]
    v_pk_mul_f16 v227, v198, v151 op_sel_hi:[0,1]
    v_mfma_f32_32x32x16_f16 v[68:83], v[236:239], v[220:223], v[68:83]
    ds_read_b128 v[232:235], v1 offset:3072
    v_pk_mul_f16 v216, v205, v162 op_sel_hi:[0,1]
    v_pk_mul_f16 v217, v205, v163 op_sel_hi:[0,1]
    v_pk_mul_f16 v218, v205, v164 op_sel_hi:[0,1]
    v_pk_mul_f16 v219, v205, v165 op_sel_hi:[0,1]
    v_pk_mul_f16 v207, v207, v246 op_sel_hi:[1,0]
    v_mfma_f32_32x32x16_f16 v[84:99], v[236:239], v[224:227], v[84:99]
    v_pk_mul_f16 v220, v212, v176 op_sel_hi:[0,1]
    v_pk_mul_f16 v221, v212, v177 op_sel_hi:[0,1]
    v_pk_mul_f16 v222, v212, v178 op_sel_hi:[0,1]
    v_pk_mul_f16 v223, v212, v179 op_sel_hi:[0,1]
    v_pk_mul_f16 v214, v214, v247 op_sel_hi:[1,0]
    v_mfma_f32_32x32x16_f16 v[100:115], v[236:239], v[216:219], v[100:115]
    v_pk_mul_f16 v224, v191, v138 op_sel_hi:[0,1]
    v_pk_mul_f16 v225, v191, v139 op_sel_hi:[0,1]
    v_pk_mul_f16 v226, v191, v140 op_sel_hi:[0,1]
    v_pk_mul_f16 v227, v191, v141 op_sel_hi:[0,1]
    v_mfma_f32_32x32x16_f16 v[116:131], v[236:239], v[220:223], v[116:131]
    v_pk_mul_f16 v216, v198, v152 op_sel_hi:[0,1]
    v_pk_mul_f16 v217, v198, v153 op_sel_hi:[0,1]
    v_pk_mul_f16 v218, v198, v154 op_sel_hi:[0,1]
    v_pk_mul_f16 v219, v198, v155 op_sel_hi:[0,1]
    v_cvt_pk_f16_f32 v194, v16, 0
    v_mfma_f32_32x32x16_f16 v[68:83], v[240:243], v[224:227], v[68:83]
    ds_read_b128 v[236:239], v1 offset:4096
    v_pk_mul_f16 v220, v205, v166 op_sel_hi:[0,1]
    v_pk_mul_f16 v221, v205, v167 op_sel_hi:[0,1]
    v_pk_mul_f16 v222, v205, v168 op_sel_hi:[0,1]
    v_pk_mul_f16 v223, v205, v169 op_sel_hi:[0,1]
    v_mfma_f32_32x32x16_f16 v[84:99], v[240:243], v[216:219], v[84:99]
    v_pk_mul_f16 v224, v212, v180 op_sel_hi:[0,1]
    v_pk_mul_f16 v225, v212, v181 op_sel_hi:[0,1]
    v_pk_mul_f16 v226, v212, v182 op_sel_hi:[0,1]
    v_pk_mul_f16 v227, v212, v183 op_sel_hi:[0,1]
    v_cvt_pk_f16_f32 v201, v32, 0
    v_mfma_f32_32x32x16_f16 v[100:115], v[240:243], v[220:223], v[100:115]
    v_pk_mul_f16 v216, v191, v142 op_sel_hi:[0,1]
    v_pk_mul_f16 v217, v191, v143 op_sel_hi:[0,1]
    v_pk_mul_f16 v218, v191, v144 op_sel_hi:[0,1]
    v_pk_mul_f16 v219, v191, v132 op_sel:[1,0] op_sel_hi:[1,1]
    v_mfma_f32_32x32x16_f16 v[116:131], v[240:243], v[224:227], v[116:131]
    v_pk_mul_f16 v220, v198, v156 op_sel_hi:[0,1]
    v_pk_mul_f16 v221, v198, v157 op_sel_hi:[0,1]
    v_pk_mul_f16 v222, v198, v158 op_sel_hi:[0,1]
    v_pk_mul_f16 v223, v198, v146 op_sel:[1,0] op_sel_hi:[1,1]
    v_cvt_pk_f16_f32 v208, v48, 0
    s_waitcnt lgkmcnt(0)
    v_mfma_f32_32x32x16_f16 v[68:83], v[228:231], v[216:219], v[68:83]
    ds_read_b128 v[240:243], v1 offset:5120
    v_pk_mul_f16 v224, v205, v170 op_sel_hi:[0,1]
    v_pk_mul_f16 v225, v205, v171 op_sel_hi:[0,1]
    v_pk_mul_f16 v226, v205, v172 op_sel_hi:[0,1]
    v_pk_mul_f16 v227, v205, v160 op_sel:[1,0] op_sel_hi:[1,1]
    v_cvt_pk_f16_f32 v215, v64, 0
    v_mfma_f32_32x32x16_f16 v[84:99], v[228:231], v[220:223], v[84:99]
    v_pk_mul_f16 v216, v212, v184 op_sel_hi:[0,1]
    v_pk_mul_f16 v217, v212, v185 op_sel_hi:[0,1]
    v_pk_mul_f16 v218, v212, v186 op_sel_hi:[0,1]
    v_pk_mul_f16 v219, v212, v174 op_sel:[1,0] op_sel_hi:[1,1]
    v_mfma_f32_32x32x16_f16 v[100:115], v[228:231], v[224:227], v[100:115]
    v_pk_mul_f16 v220, v191, v133 op_sel:[1,0] op_sel_hi:[1,1]
    v_pk_mul_f16 v221, v191, v134 op_sel:[1,0] op_sel_hi:[1,1]
    v_pk_mul_f16 v222, v191, v135 op_sel:[1,0] op_sel_hi:[1,1]
    v_pk_mul_f16 v223, v191, v136 op_sel:[1,0] op_sel_hi:[1,1]
    v_pk_mul_f16 v194, v194, v244 op_sel_hi:[1,0]
    v_mfma_f32_32x32x16_f16 v[116:131], v[228:231], v[216:219], v[116:131]
    v_pk_mul_f16 v224, v198, v147 op_sel:[1,0] op_sel_hi:[1,1]
    v_pk_mul_f16 v225, v198, v148 op_sel:[1,0] op_sel_hi:[1,1]
    v_pk_mul_f16 v226, v198, v149 op_sel:[1,0] op_sel_hi:[1,1]
    v_pk_mul_f16 v227, v198, v150 op_sel:[1,0] op_sel_hi:[1,1]
    v_mfma_f32_32x32x16_f16 v[68:83], v[232:235], v[220:223], v[68:83]
    ds_read_b128 v[228:231], v1 offset:6144
    v_pk_mul_f16 v216, v205, v161 op_sel:[1,0] op_sel_hi:[1,1]
    v_pk_mul_f16 v217, v205, v162 op_sel:[1,0] op_sel_hi:[1,1]
    v_pk_mul_f16 v218, v205, v163 op_sel:[1,0] op_sel_hi:[1,1]
    v_pk_mul_f16 v219, v205, v164 op_sel:[1,0] op_sel_hi:[1,1]
    v_pk_mul_f16 v201, v201, v245 op_sel_hi:[1,0]
    v_mfma_f32_32x32x16_f16 v[84:99], v[232:235], v[224:227], v[84:99]
    v_pk_mul_f16 v220, v212, v175 op_sel:[1,0] op_sel_hi:[1,1]
    v_pk_mul_f16 v221, v212, v176 op_sel:[1,0] op_sel_hi:[1,1]
    v_pk_mul_f16 v222, v212, v177 op_sel:[1,0] op_sel_hi:[1,1]
    v_pk_mul_f16 v223, v212, v178 op_sel:[1,0] op_sel_hi:[1,1]
    v_mfma_f32_32x32x16_f16 v[100:115], v[232:235], v[216:219], v[100:115]
    v_pk_mul_f16 v224, v191, v137 op_sel:[1,0] op_sel_hi:[1,1]
    v_pk_mul_f16 v225, v191, v138 op_sel:[1,0] op_sel_hi:[1,1]
    v_pk_mul_f16 v226, v191, v139 op_sel:[1,0] op_sel_hi:[1,1]
    v_pk_mul_f16 v227, v191, v140 op_sel:[1,0] op_sel_hi:[1,1]
    v_pk_mul_f16 v208, v208, v246 op_sel_hi:[1,0]
    v_mfma_f32_32x32x16_f16 v[116:131], v[232:235], v[220:223], v[116:131]
    v_pk_mul_f16 v216, v198, v151 op_sel:[1,0] op_sel_hi:[1,1]
    v_pk_mul_f16 v217, v198, v152 op_sel:[1,0] op_sel_hi:[1,1]
    v_pk_mul_f16 v218, v198, v153 op_sel:[1,0] op_sel_hi:[1,1]
    v_pk_mul_f16 v219, v198, v154 op_sel:[1,0] op_sel_hi:[1,1]
    v_mfma_f32_32x32x16_f16 v[68:83], v[236:239], v[224:227], v[68:83]
    ds_read_b128 v[232:235], v1 offset:7168
    v_pk_mul_f16 v220, v205, v165 op_sel:[1,0] op_sel_hi:[1,1]
    v_pk_mul_f16 v221, v205, v166 op_sel:[1,0] op_sel_hi:[1,1]
    v_pk_mul_f16 v222, v205, v167 op_sel:[1,0] op_sel_hi:[1,1]
    v_pk_mul_f16 v223, v205, v168 op_sel:[1,0] op_sel_hi:[1,1]
    v_pk_mul_f16 v215, v215, v247 op_sel_hi:[1,0]
    v_mfma_f32_32x32x16_f16 v[84:99], v[236:239], v[216:219], v[84:99]
    v_pk_mul_f16 v224, v212, v179 op_sel:[1,0] op_sel_hi:[1,1]
    v_pk_mul_f16 v225, v212, v180 op_sel:[1,0] op_sel_hi:[1,1]
    v_pk_mul_f16 v226, v212, v181 op_sel:[1,0] op_sel_hi:[1,1]
    v_pk_mul_f16 v227, v212, v182 op_sel:[1,0] op_sel_hi:[1,1]
    v_ldexp_f32 v19, v19, v145
    v_mfma_f32_32x32x16_f16 v[100:115], v[236:239], v[220:223], v[100:115]
    v_pk_mul_f16 v216, v191, v141 op_sel:[1,0] op_sel_hi:[1,1]
    v_pk_mul_f16 v217, v191, v142 op_sel:[1,0] op_sel_hi:[1,1]
    v_pk_mul_f16 v218, v191, v143 op_sel:[1,0] op_sel_hi:[1,1]
    v_pk_mul_f16 v219, v191, v144 op_sel:[1,0] op_sel_hi:[1,1]
    v_mfma_f32_32x32x16_f16 v[116:131], v[236:239], v[224:227], v[116:131]
    v_pk_mul_f16 v220, v198, v155 op_sel:[1,0] op_sel_hi:[1,1]
    v_pk_mul_f16 v221, v198, v156 op_sel:[1,0] op_sel_hi:[1,1]
    v_pk_mul_f16 v222, v198, v157 op_sel:[1,0] op_sel_hi:[1,1]
    v_pk_mul_f16 v223, v198, v158 op_sel:[1,0] op_sel_hi:[1,1]
    v_ldexp_f32 v35, v35, v159
    s_waitcnt lgkmcnt(0)
    v_mfma_f32_32x32x16_f16 v[68:83], v[240:243], v[216:219], v[68:83]
    ds_read_b128 v[236:239], v1 offset:8192
    v_pk_mul_f16 v224, v205, v169 op_sel:[1,0] op_sel_hi:[1,1]
    v_pk_mul_f16 v225, v205, v170 op_sel:[1,0] op_sel_hi:[1,1]
    v_pk_mul_f16 v226, v205, v171 op_sel:[1,0] op_sel_hi:[1,1]
    v_pk_mul_f16 v227, v205, v172 op_sel:[1,0] op_sel_hi:[1,1]
    v_mfma_f32_32x32x16_f16 v[84:99], v[240:243], v[220:223], v[84:99]
    v_pk_mul_f16 v216, v212, v183 op_sel:[1,0] op_sel_hi:[1,1]
    v_pk_mul_f16 v217, v212, v184 op_sel:[1,0] op_sel_hi:[1,1]
    v_pk_mul_f16 v218, v212, v185 op_sel:[1,0] op_sel_hi:[1,1]
    v_pk_mul_f16 v219, v212, v186 op_sel:[1,0] op_sel_hi:[1,1]
    v_ldexp_f32 v51, v51, v173
    v_mfma_f32_32x32x16_f16 v[100:115], v[240:243], v[224:227], v[100:115]
    v_pk_mul_f16 v220, v192, v132 op_sel_hi:[0,1]
    v_pk_mul_f16 v221, v192, v133 op_sel_hi:[0,1]
    v_pk_mul_f16 v222, v192, v134 op_sel_hi:[0,1]
    v_pk_mul_f16 v223, v192, v135 op_sel_hi:[0,1]
    v_mfma_f32_32x32x16_f16 v[116:131], v[240:243], v[216:219], v[116:131]
    v_pk_mul_f16 v224, v199, v146 op_sel_hi:[0,1]
    v_pk_mul_f16 v225, v199, v147 op_sel_hi:[0,1]
    v_pk_mul_f16 v226, v199, v148 op_sel_hi:[0,1]
    v_pk_mul_f16 v227, v199, v149 op_sel_hi:[0,1]
    v_ldexp_f32 v67, v67, v187
    v_mfma_f32_32x32x16_f16 v[68:83], v[228:231], v[220:223], v[68:83]
    ds_read_b128 v[240:243], v1 offset:9216
    v_pk_mul_f16 v216, v206, v160 op_sel_hi:[0,1]
    v_pk_mul_f16 v217, v206, v161 op_sel_hi:[0,1]
    v_pk_mul_f16 v218, v206, v162 op_sel_hi:[0,1]
    v_pk_mul_f16 v219, v206, v163 op_sel_hi:[0,1]
    v_add_u32 v17, s4, v145
    v_mfma_f32_32x32x16_f16 v[84:99], v[228:231], v[224:227], v[84:99]
    v_pk_mul_f16 v220, v213, v174 op_sel_hi:[0,1]
    v_pk_mul_f16 v221, v213, v175 op_sel_hi:[0,1]
    v_pk_mul_f16 v222, v213, v176 op_sel_hi:[0,1]
    v_pk_mul_f16 v223, v213, v177 op_sel_hi:[0,1]
    v_add_u32 v33, s5, v159
    v_add_u32 v49, s6, v173
    v_mfma_f32_32x32x16_f16 v[100:115], v[228:231], v[216:219], v[100:115]
    v_pk_mul_f16 v224, v192, v136 op_sel_hi:[0,1]
    v_pk_mul_f16 v225, v192, v137 op_sel_hi:[0,1]
    v_pk_mul_f16 v226, v192, v138 op_sel_hi:[0,1]
    v_pk_mul_f16 v227, v192, v139 op_sel_hi:[0,1]
    v_add_u32 v65, s7, v187
    v_mfma_f32_32x32x16_f16 v[116:131], v[228:231], v[220:223], v[116:131]
    v_pk_mul_f16 v216, v199, v150 op_sel_hi:[0,1]
    v_pk_mul_f16 v217, v199, v151 op_sel_hi:[0,1]
    v_pk_mul_f16 v218, v199, v152 op_sel_hi:[0,1]
    v_pk_mul_f16 v219, v199, v153 op_sel_hi:[0,1]
    v_mfma_f32_32x32x16_f16 v[68:83], v[232:235], v[224:227], v[68:83]
    ds_read_b128 v[228:231], v1 offset:10240
    v_pk_mul_f16 v220, v206, v164 op_sel_hi:[0,1]
    v_pk_mul_f16 v221, v206, v165 op_sel_hi:[0,1]
    v_pk_mul_f16 v222, v206, v166 op_sel_hi:[0,1]
    v_pk_mul_f16 v223, v206, v167 op_sel_hi:[0,1]
    v_ldexp_f32 v18, v18, v17
    v_mfma_f32_32x32x16_f16 v[84:99], v[232:235], v[216:219], v[84:99]
    v_pk_mul_f16 v224, v213, v178 op_sel_hi:[0,1]
    v_pk_mul_f16 v225, v213, v179 op_sel_hi:[0,1]
    v_pk_mul_f16 v226, v213, v180 op_sel_hi:[0,1]
    v_pk_mul_f16 v227, v213, v181 op_sel_hi:[0,1]
    v_mfma_f32_32x32x16_f16 v[100:115], v[232:235], v[220:223], v[100:115]
    v_pk_mul_f16 v216, v192, v140 op_sel_hi:[0,1]
    v_pk_mul_f16 v217, v192, v141 op_sel_hi:[0,1]
    v_pk_mul_f16 v218, v192, v142 op_sel_hi:[0,1]
    v_pk_mul_f16 v219, v192, v143 op_sel_hi:[0,1]
    v_ldexp_f32 v34, v34, v33
    v_mfma_f32_32x32x16_f16 v[116:131], v[232:235], v[224:227], v[116:131]
    v_pk_mul_f16 v220, v199, v154 op_sel_hi:[0,1]
    v_pk_mul_f16 v221, v199, v155 op_sel_hi:[0,1]
    v_pk_mul_f16 v222, v199, v156 op_sel_hi:[0,1]
    v_pk_mul_f16 v223, v199, v157 op_sel_hi:[0,1]
    s_waitcnt lgkmcnt(0)
    v_mfma_f32_32x32x16_f16 v[68:83], v[236:239], v[216:219], v[68:83]
    ds_read_b128 v[232:235], v1 offset:11264
    v_pk_mul_f16 v224, v206, v168 op_sel_hi:[0,1]
    v_pk_mul_f16 v225, v206, v169 op_sel_hi:[0,1]
    v_pk_mul_f16 v226, v206, v170 op_sel_hi:[0,1]
    v_pk_mul_f16 v227, v206, v171 op_sel_hi:[0,1]
    v_ldexp_f32 v50, v50, v49
    v_mfma_f32_32x32x16_f16 v[84:99], v[236:239], v[220:223], v[84:99]
    v_pk_mul_f16 v216, v213, v182 op_sel_hi:[0,1]
    v_pk_mul_f16 v217, v213, v183 op_sel_hi:[0,1]
    v_pk_mul_f16 v218, v213, v184 op_sel_hi:[0,1]
    v_pk_mul_f16 v219, v213, v185 op_sel_hi:[0,1]
    v_ldexp_f32 v66, v66, v65
    v_mfma_f32_32x32x16_f16 v[100:115], v[236:239], v[224:227], v[100:115]
    v_pk_mul_f16 v220, v192, v144 op_sel_hi:[0,1]
    v_pk_mul_f16 v221, v192, v132 op_sel:[1,0] op_sel_hi:[1,1]
    v_pk_mul_f16 v222, v192, v133 op_sel:[1,0] op_sel_hi:[1,1]
    v_pk_mul_f16 v223, v192, v134 op_sel:[1,0] op_sel_hi:[1,1]
    v_add_f32 v248, v18, v19
    v_mfma_f32_32x32x16_f16 v[116:131], v[236:239], v[216:219], v[116:131]
    v_pk_mul_f16 v224, v199, v158 op_sel_hi:[0,1]
    v_pk_mul_f16 v225, v199, v146 op_sel:[1,0] op_sel_hi:[1,1]
    v_pk_mul_f16 v226, v199, v147 op_sel:[1,0] op_sel_hi:[1,1]
    v_pk_mul_f16 v227, v199, v148 op_sel:[1,0] op_sel_hi:[1,1]
    v_add_f32 v249, v34, v35
    v_mfma_f32_32x32x16_f16 v[68:83], v[240:243], v[220:223], v[68:83]
    ds_read_b128 v[236:239], v1 offset:12288
    v_pk_mul_f16 v216, v206, v172 op_sel_hi:[0,1]
    v_pk_mul_f16 v217, v206, v160 op_sel:[1,0] op_sel_hi:[1,1]
    v_pk_mul_f16 v218, v206, v161 op_sel:[1,0] op_sel_hi:[1,1]
    v_pk_mul_f16 v219, v206, v162 op_sel:[1,0] op_sel_hi:[1,1]
    v_add_f32 v250, v50, v51
    v_mfma_f32_32x32x16_f16 v[84:99], v[240:243], v[224:227], v[84:99]
    v_pk_mul_f16 v220, v213, v186 op_sel_hi:[0,1]
    v_pk_mul_f16 v221, v213, v174 op_sel:[1,0] op_sel_hi:[1,1]
    v_pk_mul_f16 v222, v213, v175 op_sel:[1,0] op_sel_hi:[1,1]
    v_pk_mul_f16 v223, v213, v176 op_sel:[1,0] op_sel_hi:[1,1]
    v_add_f32 v251, v66, v67
    v_mfma_f32_32x32x16_f16 v[100:115], v[240:243], v[216:219], v[100:115]
    v_pk_mul_f16 v224, v192, v135 op_sel:[1,0] op_sel_hi:[1,1]
    v_pk_mul_f16 v225, v192, v136 op_sel:[1,0] op_sel_hi:[1,1]
    v_pk_mul_f16 v226, v192, v137 op_sel:[1,0] op_sel_hi:[1,1]
    v_pk_mul_f16 v227, v192, v138 op_sel:[1,0] op_sel_hi:[1,1]
    v_mfma_f32_32x32x16_f16 v[116:131], v[240:243], v[220:223], v[116:131]
    v_pk_mul_f16 v216, v199, v149 op_sel:[1,0] op_sel_hi:[1,1]
    v_pk_mul_f16 v217, v199, v150 op_sel:[1,0] op_sel_hi:[1,1]
    v_pk_mul_f16 v218, v199, v151 op_sel:[1,0] op_sel_hi:[1,1]
    v_pk_mul_f16 v219, v199, v152 op_sel:[1,0] op_sel_hi:[1,1]
    v_add3_u32 v145, v145, v252, s64
    v_mfma_f32_32x32x16_f16 v[68:83], v[228:231], v[224:227], v[68:83]
    ds_read_b128 v[240:243], v1 offset:13312
    v_pk_mul_f16 v220, v206, v163 op_sel:[1,0] op_sel_hi:[1,1]
    v_pk_mul_f16 v221, v206, v164 op_sel:[1,0] op_sel_hi:[1,1]
    v_pk_mul_f16 v222, v206, v165 op_sel:[1,0] op_sel_hi:[1,1]
    v_pk_mul_f16 v223, v206, v166 op_sel:[1,0] op_sel_hi:[1,1]
    v_add3_u32 v159, v159, v253, s65
    v_mfma_f32_32x32x16_f16 v[84:99], v[228:231], v[216:219], v[84:99]
    v_pk_mul_f16 v224, v213, v177 op_sel:[1,0] op_sel_hi:[1,1]
    v_pk_mul_f16 v225, v213, v178 op_sel:[1,0] op_sel_hi:[1,1]
    v_pk_mul_f16 v226, v213, v179 op_sel:[1,0] op_sel_hi:[1,1]
    v_pk_mul_f16 v227, v213, v180 op_sel:[1,0] op_sel_hi:[1,1]
    v_mfma_f32_32x32x16_f16 v[100:115], v[228:231], v[220:223], v[100:115]
    v_pk_mul_f16 v216, v192, v139 op_sel:[1,0] op_sel_hi:[1,1]
    v_pk_mul_f16 v217, v192, v140 op_sel:[1,0] op_sel_hi:[1,1]
    v_pk_mul_f16 v218, v192, v141 op_sel:[1,0] op_sel_hi:[1,1]
    v_pk_mul_f16 v219, v192, v142 op_sel:[1,0] op_sel_hi:[1,1]
    v_add3_u32 v173, v173, v254, s66
    v_mfma_f32_32x32x16_f16 v[116:131], v[228:231], v[224:227], v[116:131]
    v_pk_mul_f16 v220, v199, v153 op_sel:[1,0] op_sel_hi:[1,1]
    v_pk_mul_f16 v221, v199, v154 op_sel:[1,0] op_sel_hi:[1,1]
    v_pk_mul_f16 v222, v199, v155 op_sel:[1,0] op_sel_hi:[1,1]
    v_pk_mul_f16 v223, v199, v156 op_sel:[1,0] op_sel_hi:[1,1]
    s_waitcnt lgkmcnt(0)
    v_mfma_f32_32x32x16_f16 v[68:83], v[232:235], v[216:219], v[68:83]
    ds_read_b128 v[228:231], v1 offset:14336
    v_pk_mul_f16 v224, v206, v167 op_sel:[1,0] op_sel_hi:[1,1]
    v_pk_mul_f16 v225, v206, v168 op_sel:[1,0] op_sel_hi:[1,1]
    v_pk_mul_f16 v226, v206, v169 op_sel:[1,0] op_sel_hi:[1,1]
    v_pk_mul_f16 v227, v206, v170 op_sel:[1,0] op_sel_hi:[1,1]
    v_add3_u32 v187, v187, v255, s67
    v_mfma_f32_32x32x16_f16 v[84:99], v[232:235], v[220:223], v[84:99]
    v_pk_mul_f16 v216, v213, v181 op_sel:[1,0] op_sel_hi:[1,1]
    v_pk_mul_f16 v217, v213, v182 op_sel:[1,0] op_sel_hi:[1,1]
    v_pk_mul_f16 v218, v213, v183 op_sel:[1,0] op_sel_hi:[1,1]
    v_pk_mul_f16 v219, v213, v184 op_sel:[1,0] op_sel_hi:[1,1]
    v_mfma_f32_32x32x16_f16 v[100:115], v[232:235], v[224:227], v[100:115]
    v_pk_mul_f16 v220, v192, v143 op_sel:[1,0] op_sel_hi:[1,1]
    v_pk_mul_f16 v221, v192, v144 op_sel:[1,0] op_sel_hi:[1,1]
    v_pk_mul_f16 v222, v193, v132 op_sel_hi:[0,1]
    v_pk_mul_f16 v223, v193, v133 op_sel_hi:[0,1]
    v_mfma_f32_32x32x16_f16 v[116:131], v[232:235], v[216:219], v[116:131]
    v_pk_mul_f16 v224, v199, v157 op_sel:[1,0] op_sel_hi:[1,1]
    v_pk_mul_f16 v225, v199, v158 op_sel:[1,0] op_sel_hi:[1,1]
    v_pk_mul_f16 v226, v200, v146 op_sel_hi:[0,1]
    v_pk_mul_f16 v227, v200, v147 op_sel_hi:[0,1]
    v_mfma_f32_32x32x16_f16 v[68:83], v[236:239], v[220:223], v[68:83]
    ds_read_b128 v[232:235], v1 offset:15360
    v_pk_mul_f16 v216, v206, v171 op_sel:[1,0] op_sel_hi:[1,1]
    v_pk_mul_f16 v217, v206, v172 op_sel:[1,0] op_sel_hi:[1,1]
    v_pk_mul_f16 v218, v207, v160 op_sel_hi:[0,1]
    v_pk_mul_f16 v219, v207, v161 op_sel_hi:[0,1]
    v_mfma_f32_32x32x16_f16 v[84:99], v[236:239], v[224:227], v[84:99]
    v_pk_mul_f16 v220, v213, v185 op_sel:[1,0] op_sel_hi:[1,1]
    v_pk_mul_f16 v221, v213, v186 op_sel:[1,0] op_sel_hi:[1,1]
    v_pk_mul_f16 v222, v214, v174 op_sel_hi:[0,1]
    v_pk_mul_f16 v223, v214, v175 op_sel_hi:[0,1]
    v_mfma_f32_32x32x16_f16 v[100:115], v[236:239], v[216:219], v[100:115]
    v_pk_mul_f16 v224, v193, v134 op_sel_hi:[0,1]
    v_pk_mul_f16 v225, v193, v135 op_sel_hi:[0,1]
    v_pk_mul_f16 v226, v193, v136 op_sel_hi:[0,1]
    v_pk_mul_f16 v227, v193, v137 op_sel_hi:[0,1]
    v_mfma_f32_32x32x16_f16 v[116:131], v[236:239], v[220:223], v[116:131]
    v_pk_mul_f16 v216, v200, v148 op_sel_hi:[0,1]
    v_pk_mul_f16 v217, v200, v149 op_sel_hi:[0,1]
    v_pk_mul_f16 v218, v200, v150 op_sel_hi:[0,1]
    v_pk_mul_f16 v219, v200, v151 op_sel_hi:[0,1]
    v_mfma_f32_32x32x16_f16 v[68:83], v[240:243], v[224:227], v[68:83]
    ds_read_b128 v[236:239], v1 offset:16384
    v_pk_mul_f16 v220, v207, v162 op_sel_hi:[0,1]
    v_pk_mul_f16 v221, v207, v163 op_sel_hi:[0,1]
    v_pk_mul_f16 v222, v207, v164 op_sel_hi:[0,1]
    v_pk_mul_f16 v223, v207, v165 op_sel_hi:[0,1]
    v_mfma_f32_32x32x16_f16 v[84:99], v[240:243], v[216:219], v[84:99]
    v_pk_mul_f16 v224, v214, v176 op_sel_hi:[0,1]
    v_pk_mul_f16 v225, v214, v177 op_sel_hi:[0,1]
    v_pk_mul_f16 v226, v214, v178 op_sel_hi:[0,1]
    v_pk_mul_f16 v227, v214, v179 op_sel_hi:[0,1]
    v_mfma_f32_32x32x16_f16 v[100:115], v[240:243], v[220:223], v[100:115]
    v_pk_mul_f16 v216, v193, v138 op_sel_hi:[0,1]
    v_pk_mul_f16 v217, v193, v139 op_sel_hi:[0,1]
    v_pk_mul_f16 v218, v193, v140 op_sel_hi:[0,1]
    v_pk_mul_f16 v219, v193, v141 op_sel_hi:[0,1]
    v_mfma_f32_32x32x16_f16 v[116:131], v[240:243], v[224:227], v[116:131]
    v_pk_mul_f16 v220, v200, v152 op_sel_hi:[0,1]
    v_pk_mul_f16 v221, v200, v153 op_sel_hi:[0,1]
    v_pk_mul_f16 v222, v200, v154 op_sel_hi:[0,1]
    v_pk_mul_f16 v223, v200, v155 op_sel_hi:[0,1]
    s_waitcnt lgkmcnt(0)
    v_mfma_f32_32x32x16_f16 v[68:83], v[228:231], v[216:219], v[68:83]
    ds_read_b128 v[240:243], v1 offset:17408
    v_pk_mul_f16 v224, v207, v166 op_sel_hi:[0,1]
    v_pk_mul_f16 v225, v207, v167 op_sel_hi:[0,1]
    v_pk_mul_f16 v226, v207, v168 op_sel_hi:[0,1]
    v_pk_mul_f16 v227, v207, v169 op_sel_hi:[0,1]
    v_mfma_f32_32x32x16_f16 v[84:99], v[228:231], v[220:223], v[84:99]
    v_pk_mul_f16 v216, v214, v180 op_sel_hi:[0,1]
    v_pk_mul_f16 v217, v214, v181 op_sel_hi:[0,1]
    v_pk_mul_f16 v218, v214, v182 op_sel_hi:[0,1]
    v_pk_mul_f16 v219, v214, v183 op_sel_hi:[0,1]
    v_mfma_f32_32x32x16_f16 v[100:115], v[228:231], v[224:227], v[100:115]
    v_pk_mul_f16 v220, v193, v142 op_sel_hi:[0,1]
    v_pk_mul_f16 v221, v193, v143 op_sel_hi:[0,1]
    v_pk_mul_f16 v222, v193, v144 op_sel_hi:[0,1]
    v_pk_mul_f16 v223, v193, v132 op_sel:[1,0] op_sel_hi:[1,1]
    v_mfma_f32_32x32x16_f16 v[116:131], v[228:231], v[216:219], v[116:131]
    v_pk_mul_f16 v224, v200, v156 op_sel_hi:[0,1]
    v_pk_mul_f16 v225, v200, v157 op_sel_hi:[0,1]
    v_pk_mul_f16 v226, v200, v158 op_sel_hi:[0,1]
    v_pk_mul_f16 v227, v200, v146 op_sel:[1,0] op_sel_hi:[1,1]
    v_mfma_f32_32x32x16_f16 v[68:83], v[232:235], v[220:223], v[68:83]
    ds_read_b128 v[228:231], v1 offset:18432
    v_pk_mul_f16 v216, v207, v170 op_sel_hi:[0,1]
    v_pk_mul_f16 v217, v207, v171 op_sel_hi:[0,1]
    v_pk_mul_f16 v218, v207, v172 op_sel_hi:[0,1]
    v_pk_mul_f16 v219, v207, v160 op_sel:[1,0] op_sel_hi:[1,1]
    v_mov_b32 v3, 160028
    v_mfma_f32_32x32x16_f16 v[84:99], v[232:235], v[224:227], v[84:99]
    v_pk_mul_f16 v220, v214, v184 op_sel_hi:[0,1]
    v_pk_mul_f16 v221, v214, v185 op_sel_hi:[0,1]
    v_pk_mul_f16 v222, v214, v186 op_sel_hi:[0,1]
    v_pk_mul_f16 v223, v214, v174 op_sel:[1,0] op_sel_hi:[1,1]
    ds_read_b32 v2, v3
    v_mfma_f32_32x32x16_f16 v[100:115], v[232:235], v[216:219], v[100:115]
    v_pk_mul_f16 v224, v193, v133 op_sel:[1,0] op_sel_hi:[1,1]
    v_pk_mul_f16 v225, v193, v134 op_sel:[1,0] op_sel_hi:[1,1]
    v_pk_mul_f16 v226, v193, v135 op_sel:[1,0] op_sel_hi:[1,1]
    v_pk_mul_f16 v227, v193, v136 op_sel:[1,0] op_sel_hi:[1,1]
    v_mfma_f32_32x32x16_f16 v[116:131], v[232:235], v[220:223], v[116:131]
    v_pk_mul_f16 v216, v200, v147 op_sel:[1,0] op_sel_hi:[1,1]
    v_pk_mul_f16 v217, v200, v148 op_sel:[1,0] op_sel_hi:[1,1]
    v_pk_mul_f16 v218, v200, v149 op_sel:[1,0] op_sel_hi:[1,1]
    v_pk_mul_f16 v219, v200, v150 op_sel:[1,0] op_sel_hi:[1,1]
    v_mfma_f32_32x32x16_f16 v[68:83], v[236:239], v[224:227], v[68:83]
    ds_read_b128 v[232:235], v1 offset:19456
    v_pk_mul_f16 v220, v207, v161 op_sel:[1,0] op_sel_hi:[1,1]
    v_pk_mul_f16 v221, v207, v162 op_sel:[1,0] op_sel_hi:[1,1]
    v_pk_mul_f16 v222, v207, v163 op_sel:[1,0] op_sel_hi:[1,1]
    v_pk_mul_f16 v223, v207, v164 op_sel:[1,0] op_sel_hi:[1,1]
    v_mfma_f32_32x32x16_f16 v[84:99], v[236:239], v[216:219], v[84:99]
    v_pk_mul_f16 v224, v214, v175 op_sel:[1,0] op_sel_hi:[1,1]
    v_pk_mul_f16 v225, v214, v176 op_sel:[1,0] op_sel_hi:[1,1]
    v_pk_mul_f16 v226, v214, v177 op_sel:[1,0] op_sel_hi:[1,1]
    v_pk_mul_f16 v227, v214, v178 op_sel:[1,0] op_sel_hi:[1,1]
    v_mfma_f32_32x32x16_f16 v[100:115], v[236:239], v[220:223], v[100:115]
    v_pk_mul_f16 v216, v193, v137 op_sel:[1,0] op_sel_hi:[1,1]
    v_pk_mul_f16 v217, v193, v138 op_sel:[1,0] op_sel_hi:[1,1]
    v_pk_mul_f16 v218, v193, v139 op_sel:[1,0] op_sel_hi:[1,1]
    v_pk_mul_f16 v219, v193, v140 op_sel:[1,0] op_sel_hi:[1,1]
    v_mfma_f32_32x32x16_f16 v[116:131], v[236:239], v[224:227], v[116:131]
    v_pk_mul_f16 v220, v200, v151 op_sel:[1,0] op_sel_hi:[1,1]
    v_pk_mul_f16 v221, v200, v152 op_sel:[1,0] op_sel_hi:[1,1]
    v_pk_mul_f16 v222, v200, v153 op_sel:[1,0] op_sel_hi:[1,1]
    v_pk_mul_f16 v223, v200, v154 op_sel:[1,0] op_sel_hi:[1,1]
    s_waitcnt lgkmcnt(0)
    v_mfma_f32_32x32x16_f16 v[68:83], v[240:243], v[216:219], v[68:83]
    ds_read_b128 v[236:239], v1 offset:20480
    v_pk_mul_f16 v224, v207, v165 op_sel:[1,0] op_sel_hi:[1,1]
    v_pk_mul_f16 v225, v207, v166 op_sel:[1,0] op_sel_hi:[1,1]
    v_pk_mul_f16 v226, v207, v167 op_sel:[1,0] op_sel_hi:[1,1]
    v_pk_mul_f16 v227, v207, v168 op_sel:[1,0] op_sel_hi:[1,1]
    v_readfirstlane_b32 s74, v2
    v_mfma_f32_32x32x16_f16 v[84:99], v[240:243], v[220:223], v[84:99]
    v_pk_mul_f16 v216, v214, v179 op_sel:[1,0] op_sel_hi:[1,1]
    v_pk_mul_f16 v217, v214, v180 op_sel:[1,0] op_sel_hi:[1,1]
    v_pk_mul_f16 v218, v214, v181 op_sel:[1,0] op_sel_hi:[1,1]
    v_pk_mul_f16 v219, v214, v182 op_sel:[1,0] op_sel_hi:[1,1]
    s_cmp_lt_u32 s74, 4
    s_cbranch_scc1 L_cs_15
L_cb_16:
    v_mfma_f32_32x32x16_f16 v[100:115], v[240:243], v[224:227], v[100:115]
    v_pk_mul_f16 v220, v193, v141 op_sel:[1,0] op_sel_hi:[1,1]
    v_pk_mul_f16 v221, v193, v142 op_sel:[1,0] op_sel_hi:[1,1]
    v_pk_mul_f16 v222, v193, v143 op_sel:[1,0] op_sel_hi:[1,1]
    v_pk_mul_f16 v223, v193, v144 op_sel:[1,0] op_sel_hi:[1,1]
    v_mov_b32 v3, 154624
    v_mfma_f32_32x32x16_f16 v[116:131], v[240:243], v[216:219], v[116:131]
    v_pk_mul_f16 v224, v200, v155 op_sel:[1,0] op_sel_hi:[1,1]
    v_pk_mul_f16 v225, v200, v156 op_sel:[1,0] op_sel_hi:[1,1]
    v_pk_mul_f16 v226, v200, v157 op_sel:[1,0] op_sel_hi:[1,1]
    v_pk_mul_f16 v227, v200, v158 op_sel:[1,0] op_sel_hi:[1,1]
    ds_read_b64 v[2:3], v3
    v_mfma_f32_32x32x16_f16 v[68:83], v[228:231], v[220:223], v[68:83]
    ds_read_b128 v[240:243], v1 offset:21504
    v_pk_mul_f16 v216, v207, v169 op_sel:[1,0] op_sel_hi:[1,1]
    v_pk_mul_f16 v217, v207, v170 op_sel:[1,0] op_sel_hi:[1,1]
    v_pk_mul_f16 v218, v207, v171 op_sel:[1,0] op_sel_hi:[1,1]
    v_pk_mul_f16 v219, v207, v172 op_sel:[1,0] op_sel_hi:[1,1]
    v_mfma_f32_32x32x16_f16 v[84:99], v[228:231], v[224:227], v[84:99]
    v_pk_mul_f16 v220, v214, v183 op_sel:[1,0] op_sel_hi:[1,1]
    v_pk_mul_f16 v221, v214, v184 op_sel:[1,0] op_sel_hi:[1,1]
    v_pk_mul_f16 v222, v214, v185 op_sel:[1,0] op_sel_hi:[1,1]
    v_pk_mul_f16 v223, v214, v186 op_sel:[1,0] op_sel_hi:[1,1]
    v_mfma_f32_32x32x16_f16 v[100:115], v[228:231], v[216:219], v[100:115]
    v_pk_mul_f16 v224, v194, v132 op_sel_hi:[0,1]
    v_pk_mul_f16 v225, v194, v133 op_sel_hi:[0,1]
    v_pk_mul_f16 v226, v194, v134 op_sel_hi:[0,1]
    v_pk_mul_f16 v227, v194, v135 op_sel_hi:[0,1]
    v_mfma_f32_32x32x16_f16 v[116:131], v[228:231], v[220:223], v[116:131]
    v_pk_mul_f16 v216, v201, v146 op_sel_hi:[0,1]
    v_pk_mul_f16 v217, v201, v147 op_sel_hi:[0,1]
    v_pk_mul_f16 v218, v201, v148 op_sel_hi:[0,1]
    v_pk_mul_f16 v219, v201, v149 op_sel_hi:[0,1]
    v_mfma_f32_32x32x16_f16 v[68:83], v[232:235], v[224:227], v[68:83]
    ds_read_b128 v[228:231], v1 offset:22528
    v_pk_mul_f16 v220, v208, v160 op_sel_hi:[0,1]
    v_pk_mul_f16 v221, v208, v161 op_sel_hi:[0,1]
    v_pk_mul_f16 v222, v208, v162 op_sel_hi:[0,1]
    v_pk_mul_f16 v223, v208, v163 op_sel_hi:[0,1]
    v_mfma_f32_32x32x16_f16 v[84:99], v[232:235], v[216:219], v[84:99]
    v_pk_mul_f16 v224, v215, v174 op_sel_hi:[0,1]
    v_pk_mul_f16 v225, v215, v175 op_sel_hi:[0,1]
    v_pk_mul_f16 v226, v215, v176 op_sel_hi:[0,1]
    v_pk_mul_f16 v227, v215, v177 op_sel_hi:[0,1]
    v_mfma_f32_32x32x16_f16 v[100:115], v[232:235], v[220:223], v[100:115]
    v_pk_mul_f16 v216, v194, v136 op_sel_hi:[0,1]
    v_pk_mul_f16 v217, v194, v137 op_sel_hi:[0,1]
    v_pk_mul_f16 v218, v194, v138 op_sel_hi:[0,1]
    v_pk_mul_f16 v219, v194, v139 op_sel_hi:[0,1]
    v_mfma_f32_32x32x16_f16 v[116:131], v[232:235], v[224:227], v[116:131]
    v_pk_mul_f16 v220, v201, v150 op_sel_hi:[0,1]
    v_pk_mul_f16 v221, v201, v151 op_sel_hi:[0,1]
    v_pk_mul_f16 v222, v201, v152 op_sel_hi:[0,1]
    v_pk_mul_f16 v223, v201, v153 op_sel_hi:[0,1]
    s_waitcnt lgkmcnt(0)
    v_mfma_f32_32x32x16_f16 v[68:83], v[236:239], v[216:219], v[68:83]
    v_add_u32 v1, 65536, v1
    ds_read_b128 v[232:235], v1 offset:0
    v_pk_mul_f16 v224, v208, v164 op_sel_hi:[0,1]
    v_pk_mul_f16 v225, v208, v165 op_sel_hi:[0,1]
    v_pk_mul_f16 v226, v208, v166 op_sel_hi:[0,1]
    v_pk_mul_f16 v227, v208, v167 op_sel_hi:[0,1]
    v_mfma_f32_32x32x16_f16 v[84:99], v[236:239], v[220:223], v[84:99]
    v_pk_mul_f16 v216, v215, v178 op_sel_hi:[0,1]
    v_pk_mul_f16 v217, v215, v179 op_sel_hi:[0,1]
    v_pk_mul_f16 v218, v215, v180 op_sel_hi:[0,1]
    v_pk_mul_f16 v219, v215, v181 op_sel_hi:[0,1]
    v_readfirstlane_b32 s56, v2
    v_readfirstlane_b32 s57, v3
    v_mfma_f32_32x32x16_f16 v[100:115], v[236:239], v[224:227], v[100:115]
    v_pk_mul_f16 v220, v194, v140 op_sel_hi:[0,1]
    v_pk_mul_f16 v221, v194, v141 op_sel_hi:[0,1]
    v_pk_mul_f16 v222, v194, v142 op_sel_hi:[0,1]
    v_pk_mul_f16 v223, v194, v143 op_sel_hi:[0,1]
    v_mov_b32 v3, 154632
    v_mfma_f32_32x32x16_f16 v[116:131], v[236:239], v[216:219], v[116:131]
    v_pk_mul_f16 v224, v201, v154 op_sel_hi:[0,1]
    v_pk_mul_f16 v225, v201, v155 op_sel_hi:[0,1]
    v_pk_mul_f16 v226, v201, v156 op_sel_hi:[0,1]
    v_pk_mul_f16 v227, v201, v157 op_sel_hi:[0,1]
    ds_read_b64 v[2:3], v3
    v_mfma_f32_32x32x16_f16 v[68:83], v[240:243], v[220:223], v[68:83]
    ds_read_b128 v[236:239], v1 offset:1024
    v_pk_mul_f16 v216, v208, v168 op_sel_hi:[0,1]
    v_pk_mul_f16 v217, v208, v169 op_sel_hi:[0,1]
    v_pk_mul_f16 v218, v208, v170 op_sel_hi:[0,1]
    v_pk_mul_f16 v219, v208, v171 op_sel_hi:[0,1]
    v_mfma_f32_32x32x16_f16 v[84:99], v[240:243], v[224:227], v[84:99]
    v_pk_mul_f16 v220, v215, v182 op_sel_hi:[0,1]
    v_pk_mul_f16 v221, v215, v183 op_sel_hi:[0,1]
    v_pk_mul_f16 v222, v215, v184 op_sel_hi:[0,1]
    v_pk_mul_f16 v223, v215, v185 op_sel_hi:[0,1]
    v_mfma_f32_32x32x16_f16 v[100:115], v[240:243], v[216:219], v[100:115]
    v_pk_mul_f16 v224, v194, v144 op_sel_hi:[0,1]
    v_mfma_f32_32x32x16_f16 v[116:131], v[240:243], v[220:223], v[116:131]
    v_pk_mul_f16 v216, v201, v158 op_sel_hi:[0,1]
    v_mfma_f32_32x32x16_f16 v[68:83], v[228:231], v[224:227], v[68:83]
    ds_read_b128 v[240:243], v1 offset:2048
    v_pk_mul_f16 v220, v208, v172 op_sel_hi:[0,1]
    v_mfma_f32_32x32x16_f16 v[84:99], v[228:231], v[216:219], v[84:99]
    v_pk_mul_f16 v224, v215, v186 op_sel_hi:[0,1]
    v_mfma_f32_32x32x16_f16 v[100:115], v[228:231], v[220:223], v[100:115]
    v_pk_mul_f16 v216, v132, v132 op_sel_hi:[0,1]
    v_pk_mul_f16 v217, v132, v133 op_sel_hi:[0,1]
    v_pk_mul_f16 v218, v132, v134 op_sel_hi:[0,1]
    v_pk_mul_f16 v219, v132, v135 op_sel_hi:[0,1]
    v_mfma_f32_32x32x16_f16 v[116:131], v[228:231], v[224:227], v[116:131]
    v_pk_mul_f16 v220, v146, v146 op_sel_hi:[0,1]
    v_pk_mul_f16 v221, v146, v147 op_sel_hi:[0,1]
    v_pk_mul_f16 v222, v146, v148 op_sel_hi:[0,1]
    v_pk_mul_f16 v223, v146, v149 op_sel_hi:[0,1]
    s_waitcnt lgkmcnt(0)
    v_mfma_f32_32x32x16_f16 v[4:19], v[232:235], v[216:219], 0
    ds_read_b128 v[228:231], v1 offset:3072
    v_pk_mul_f16 v224, v160, v160 op_sel_hi:[0,1]
    v_pk_mul_f16 v225, v160, v161 op_sel_hi:[0,1]
    v_pk_mul_f16 v226, v160, v162 op_sel_hi:[0,1]
    v_pk_mul_f16 v227, v160, v163 op_sel_hi:[0,1]
    v_readfirstlane_b32 s49, v2
    v_mfma_f32_32x32x16_f16 v[20:35], v[232:235], v[220:223], 0
    v_pk_mul_f16 v216, v174, v174 op_sel_hi:[0,1]
    v_pk_mul_f16 v217, v174, v175 op_sel_hi:[0,1]
    v_pk_mul_f16 v218, v174, v176 op_sel_hi:[0,1]
    v_pk_mul_f16 v219, v174, v177 op_sel_hi:[0,1]
    ds_read_b128 v[204:207], v1 offset:24576
    ds_read_b128 v[208:211], v1 offset:25600
    v_mfma_f32_32x32x16_f16 v[36:51], v[232:235], v[224:227], 0
    v_pk_mul_f16 v220, v132, v136 op_sel_hi:[0,1]
    v_pk_mul_f16 v221, v132, v137 op_sel_hi:[0,1]
    v_pk_mul_f16 v222, v132, v138 op_sel_hi:[0,1]
    v_pk_mul_f16 v223, v132, v139 op_sel_hi:[0,1]
    v_mfma_f32_32x32x16_f16 v[52:67], v[232:235], v[216:219], 0
    v_pk_mul_f16 v224, v146, v150 op_sel_hi:[0,1]
    v_pk_mul_f16 v225, v146, v151 op_sel_hi:[0,1]
    v_pk_mul_f16 v226, v146, v152 op_sel_hi:[0,1]
    v_pk_mul_f16 v227, v146, v153 op_sel_hi:[0,1]
    v_mfma_f32_32x32x16_f16 v[4:19], v[236:239], v[220:223], v[4:19]
    v_pk_mul_f16 v216, v160, v164 op_sel_hi:[0,1]
    v_pk_mul_f16 v217, v160, v165 op_sel_hi:[0,1]
    v_pk_mul_f16 v218, v160, v166 op_sel_hi:[0,1]
    v_pk_mul_f16 v219, v160, v167 op_sel_hi:[0,1]
    v_ldexp_f32 v83, v83, v145
    v_ldexp_f32 v99, v99, v159
    v_mfma_f32_32x32x16_f16 v[20:35], v[236:239], v[224:227], v[20:35]
    v_pk_mul_f16 v220, v174, v178 op_sel_hi:[0,1]
    v_pk_mul_f16 v221, v174, v179 op_sel_hi:[0,1]
    v_pk_mul_f16 v222, v174, v180 op_sel_hi:[0,1]
    v_pk_mul_f16 v223, v174, v181 op_sel_hi:[0,1]
    v_mfma_f32_32x32x16_f16 v[36:51], v[236:239], v[216:219], v[36:51]
    ds_read_b128 v[232:235], v1 offset:4096
    v_pk_mul_f16 v224, v132, v140 op_sel_hi:[0,1]
    v_pk_mul_f16 v225, v132, v141 op_sel_hi:[0,1]
    v_pk_mul_f16 v226, v132, v142 op_sel_hi:[0,1]
    v_pk_mul_f16 v227, v132, v143 op_sel_hi:[0,1]
    v_ldexp_f32 v115, v115, v173
    v_mfma_f32_32x32x16_f16 v[52:67], v[236:239], v[220:223], v[52:67]
    v_pk_mul_f16 v216, v146, v154 op_sel_hi:[0,1]
    v_pk_mul_f16 v217, v146, v155 op_sel_hi:[0,1]
    v_pk_mul_f16 v218, v146, v156 op_sel_hi:[0,1]
    v_pk_mul_f16 v219, v146, v157 op_sel_hi:[0,1]
    v_ldexp_f32 v131, v131, v187
    v_mfma_f32_32x32x16_f16 v[4:19], v[240:243], v[224:227], v[4:19]
    v_pk_mul_f16 v220, v160, v168 op_sel_hi:[0,1]
    v_pk_mul_f16 v221, v160, v169 op_sel_hi:[0,1]
    v_pk_mul_f16 v222, v160, v170 op_sel_hi:[0,1]
    v_pk_mul_f16 v223, v160, v171 op_sel_hi:[0,1]
    v_add_f32 v248, v248, v83
    v_add_f32 v249, v249, v99
    v_mfma_f32_32x32x16_f16 v[20:35], v[240:243], v[216:219], v[20:35]
    v_pk_mul_f16 v224, v174, v182 op_sel_hi:[0,1]
    v_pk_mul_f16 v225, v174, v183 op_sel_hi:[0,1]
    v_pk_mul_f16 v226, v174, v184 op_sel_hi:[0,1]
    v_pk_mul_f16 v227, v174, v185 op_sel_hi:[0,1]
    v_add_f32 v250, v250, v115
    v_mfma_f32_32x32x16_f16 v[36:51], v[240:243], v[220:223], v[36:51]
    ds_read_b128 v[236:239], v1 offset:5120
    v_pk_mul_f16 v216, v132, v144 op_sel_hi:[0,1]
    v_pk_mul_f16 v217, v133, v133 op_sel_hi:[0,1]
    v_pk_mul_f16 v218, v133, v134 op_sel_hi:[0,1]
    v_pk_mul_f16 v219, v133, v135 op_sel_hi:[0,1]
    v_add_f32 v251, v251, v131
    v_mfma_f32_32x32x16_f16 v[52:67], v[240:243], v[224:227], v[52:67]
    v_pk_mul_f16 v220, v146, v158 op_sel_hi:[0,1]
    v_pk_mul_f16 v221, v147, v147 op_sel_hi:[0,1]
    v_pk_mul_f16 v222, v147, v148 op_sel_hi:[0,1]
    v_pk_mul_f16 v223, v147, v149 op_sel_hi:[0,1]
    s_waitcnt lgkmcnt(1)
    v_mfma_f32_32x32x16_f16 v[4:19], v[228:231], v[216:219], v[4:19]
    v_pk_mul_f16 v224, v160, v172 op_sel_hi:[0,1]
    v_pk_mul_f16 v225, v161, v161 op_sel_hi:[0,1]
    v_pk_mul_f16 v226, v161, v162 op_sel_hi:[0,1]
    v_pk_mul_f16 v227, v161, v163 op_sel_hi:[0,1]
    s_sub_u32 s72, s54, s55
    s_sub_u32 s72, s72, 130
    v_mfma_f32_32x32x16_f16 v[20:35], v[228:231], v[220:223], v[20:35]
    v_pk_mul_f16 v216, v174, v186 op_sel_hi:[0,1]
    v_pk_mul_f16 v217, v175, v175 op_sel_hi:[0,1]
    v_pk_mul_f16 v218, v175, v176 op_sel_hi:[0,1]
    v_pk_mul_f16 v219, v175, v177 op_sel_hi:[0,1]
    s_add_u32 s57, s57, s72
    s_add_u32 s56, s56, s72
    v_mfma_f32_32x32x16_f16 v[36:51], v[228:231], v[224:227], v[36:51]
    ds_read_b128 v[240:243], v1 offset:6144
    v_pack_b32_f16 v220, v132, v133
    v_pack_b32_f16 v221, v134, v135
    v_pack_b32_f16 v222, v136, v137
    v_pack_b32_f16 v223, v138, v139
    s_sub_u32 s56, s56, 130
    v_mfma_f32_32x32x16_f16 v[52:67], v[228:231], v[216:219], v[52:67]
    v_pack_b32_f16 v224, v140, v141
    v_pack_b32_f16 v225, v142, v143
    v_pack_b32_f16 v226, v144, v144
    s_sub_u32 s49, s49, 260
    s_add_u32 s4, s57, s60
    v_mfma_f32_32x32x16_f16 v[188:203], v[204:207], v[220:223], 0
    v_pk_mul_f16 v216, v133, v136 op_sel_hi:[0,1]
    v_pk_mul_f16 v217, v133, v137 op_sel_hi:[0,1]
    v_pk_mul_f16 v218, v133, v138 op_sel_hi:[0,1]
    v_pk_mul_f16 v219, v133, v139 op_sel_hi:[0,1]
    s_lshl1_add_u32 s64, s60, s56
    s_lshl1_add_u32 s76, s60, s49
    v_mfma_f32_32x32x16_f16 v[188:203], v[208:211], v[224:227], v[188:203]
    v_pk_mul_f16 v220, v147, v150 op_sel_hi:[0,1]
    v_pk_mul_f16 v221, v147, v151 op_sel_hi:[0,1]
    v_pk_mul_f16 v222, v147, v152 op_sel_hi:[0,1]
    v_pk_mul_f16 v223, v147, v153 op_sel_hi:[0,1]
    s_add_u32 s5, s57, s61
    v_mfma_f32_32x32x16_f16 v[4:19], v[232:235], v[216:219], v[4:19]
    ds_read_b128 v[228:231], v1 offset:7168
    v_pk_mul_f16 v224, v161, v164 op_sel_hi:[0,1]
    v_pk_mul_f16 v225, v161, v165 op_sel_hi:[0,1]
    v_pk_mul_f16 v226, v161, v166 op_sel_hi:[0,1]
    v_pk_mul_f16 v227, v161, v167 op_sel_hi:[0,1]
    s_lshl1_add_u32 s65, s61, s56
    v_mfma_f32_32x32x16_f16 v[20:35], v[232:235], v[220:223], v[20:35]
    v_pk_mul_f16 v216, v175, v178 op_sel_hi:[0,1]
    v_pk_mul_f16 v217, v175, v179 op_sel_hi:[0,1]
    v_pk_mul_f16 v218, v175, v180 op_sel_hi:[0,1]
    v_pk_mul_f16 v219, v175, v181 op_sel_hi:[0,1]
    s_lshl1_add_u32 s77, s61, s49
    s_add_u32 s6, s57, s62
    v_mfma_f32_32x32x16_f16 v[36:51], v[232:235], v[224:227], v[36:51]
    v_pk_mul_f16 v220, v133, v140 op_sel_hi:[0,1]
    v_pk_mul_f16 v221, v133, v141 op_sel_hi:[0,1]
    v_pk_mul_f16 v222, v133, v142 op_sel_hi:[0,1]
    v_pk_mul_f16 v223, v133, v143 op_sel_hi:[0,1]
    s_lshl1_add_u32 s66, s62, s56
    s_lshl1_add_u32 s78, s62, s49
    v_mfma_f32_32x32x16_f16 v[52:67], v[232:235], v[216:219], v[52:67]
    v_pk_mul_f16 v224, v147, v154 op_sel_hi:[0,1]
    v_pk_mul_f16 v225, v147, v155 op_sel_hi:[0,1]
    v_pk_mul_f16 v226, v147, v156 op_sel_hi:[0,1]
    v_pk_mul_f16 v227, v147, v157 op_sel_hi:[0,1]
    s_add_u32 s7, s57, s63
    s_waitcnt lgkmcnt(0)
    v_mfma_f32_32x32x16_f16 v[4:19], v[236:239], v[220:223], v[4:19]
    ds_read_b128 v[232:235], v1 offset:8192
    v_pk_mul_f16 v216, v161, v168 op_sel_hi:[0,1]
    v_pk_mul_f16 v217, v161, v169 op_sel_hi:[0,1]
    v_pk_mul_f16 v218, v161, v170 op_sel_hi:[0,1]
    v_pk_mul_f16 v219, v161, v171 op_sel_hi:[0,1]
    s_lshl1_add_u32 s67, s63, s56
    v_mfma_f32_32x32x16_f16 v[20:35], v[236:239], v[224:227], v[20:35]
    v_pk_mul_f16 v220, v175, v182 op_sel_hi:[0,1]
    v_pk_mul_f16 v221, v175, v183 op_sel_hi:[0,1]
    v_pk_mul_f16 v222, v175, v184 op_sel_hi:[0,1]
    v_pk_mul_f16 v223, v175, v185 op_sel_hi:[0,1]
    s_lshl1_add_u32 s79, s63, s49
    v_mul_f32 v244, v188, v68
    v_mfma_f32_32x32x16_f16 v[36:51], v[236:239], v[216:219], v[36:51]
    v_pk_mul_f16 v224, v133, v144 op_sel_hi:[0,1]
    v_pk_mul_f16 v225, v134, v134 op_sel_hi:[0,1]
    v_pk_mul_f16 v226, v134, v135 op_sel_hi:[0,1]
    v_pk_mul_f16 v227, v134, v136 op_sel_hi:[0,1]
    v_fmac_f32 v244, v189, v69
    v_fmac_f32 v244, v190, v70
    v_mfma_f32_32x32x16_f16 v[52:67], v[236:239], v[220:223], v[52:67]
    v_pk_mul_f16 v216, v147, v158 op_sel_hi:[0,1]
    v_pk_mul_f16 v217, v148, v148 op_sel_hi:[0,1]
    v_pk_mul_f16 v218, v148, v149 op_sel_hi:[0,1]
    v_pk_mul_f16 v219, v148, v150 op_sel_hi:[0,1]
    v_fmac_f32 v244, v191, v71
    v_mfma_f32_32x32x16_f16 v[4:19], v[240:243], v[224:227], v[4:19]
    v_pk_mul_f16 v220, v161, v172 op_sel_hi:[0,1]
    v_pk_mul_f16 v221, v162, v162 op_sel_hi:[0,1]
    v_pk_mul_f16 v222, v162, v163 op_sel_hi:[0,1]
    v_pk_mul_f16 v223, v162, v164 op_sel_hi:[0,1]
    s_setprio 0
    v_fmac_f32 v244, v192, v72
    v_mfma_f32_32x32x16_f16 v[20:35], v[240:243], v[216:219], v[20:35]
    v_pk_mul_f16 v224, v175, v186 op_sel_hi:[0,1]
    v_pk_mul_f16 v225, v176, v176 op_sel_hi:[0,1]
    v_pk_mul_f16 v226, v176, v177 op_sel_hi:[0,1]
    v_pk_mul_f16 v227, v176, v178 op_sel_hi:[0,1]
    v_fmac_f32 v244, v193, v73
    v_mfma_f32_32x32x16_f16 v[36:51], v[240:243], v[220:223], v[36:51]
    ds_read_b128 v[236:239], v1 offset:9216
    v_pk_mul_f16 v216, v134, v137 op_sel_hi:[0,1]
    v_pk_mul_f16 v217, v134, v138 op_sel_hi:[0,1]
    v_pk_mul_f16 v218, v134, v139 op_sel_hi:[0,1]
    v_pk_mul_f16 v219, v134, v140 op_sel_hi:[0,1]
    v_fmac_f32 v244, v194, v74
    v_mfma_f32_32x32x16_f16 v[52:67], v[240:243], v[224:227], v[52:67]
    v_pk_mul_f16 v220, v148, v151 op_sel_hi:[0,1]
    v_pk_mul_f16 v221, v148, v152 op_sel_hi:[0,1]
    v_pk_mul_f16 v222, v148, v153 op_sel_hi:[0,1]
    v_pk_mul_f16 v223, v148, v154 op_sel_hi:[0,1]
    v_fmac_f32 v244, v195, v75
    v_fmac_f32 v244, v196, v76
    v_mfma_f32_32x32x16_f16 v[4:19], v[228:231], v[216:219], v[4:19]
    v_pk_mul_f16 v224, v162, v165 op_sel_hi:[0,1]
    v_pk_mul_f16 v225, v162, v166 op_sel_hi:[0,1]
    v_pk_mul_f16 v226, v162, v167 op_sel_hi:[0,1]
    v_pk_mul_f16 v227, v162, v168 op_sel_hi:[0,1]
    v_fmac_f32 v244, v197, v77
    v_fmac_f32 v244, v198, v78
    v_mfma_f32_32x32x16_f16 v[20:35], v[228:231], v[220:223], v[20:35]
    v_pk_mul_f16 v216, v176, v179 op_sel_hi:[0,1]
    v_pk_mul_f16 v217, v176, v180 op_sel_hi:[0,1]
    v_pk_mul_f16 v218, v176, v181 op_sel_hi:[0,1]
    v_pk_mul_f16 v219, v176, v182 op_sel_hi:[0,1]
    v_fmac_f32 v244, v199, v79
    v_mfma_f32_32x32x16_f16 v[36:51], v[228:231], v[224:227], v[36:51]
    ds_read_b128 v[240:243], v1 offset:10240
    v_pk_mul_f16 v220, v134, v141 op_sel_hi:[0,1]
    v_pk_mul_f16 v221, v134, v142 op_sel_hi:[0,1]
    v_pk_mul_f16 v222, v134, v143 op_sel_hi:[0,1]
    v_pk_mul_f16 v223, v134, v144 op_sel_hi:[0,1]
    v_fmac_f32 v244, v200, v80
    v_mfma_f32_32x32x16_f16 v[52:67], v[228:231], v[216:219], v[52:67]
    v_pk_mul_f16 v224, v148, v155 op_sel_hi:[0,1]
    v_pk_mul_f16 v225, v148, v156 op_sel_hi:[0,1]
    v_pk_mul_f16 v226, v148, v157 op_sel_hi:[0,1]
    v_pk_mul_f16 v227, v148, v158 op_sel_hi:[0,1]
    v_add_u32 v252, s4, v145
    s_waitcnt lgkmcnt(1)
    v_mfma_f32_32x32x16_f16 v[4:19], v[232:235], v[220:223], v[4:19]
    v_pk_mul_f16 v216, v162, v169 op_sel_hi:[0,1]
    v_pk_mul_f16 v217, v162, v170 op_sel_hi:[0,1]
    v_pk_mul_f16 v218, v162, v171 op_sel_hi:[0,1]
    v_pk_mul_f16 v219, v162, v172 op_sel_hi:[0,1]
    v_ldexp_f32 v244, v244, v252
    v_add_u32 v252, s64, v145
    v_mfma_f32_32x32x16_f16 v[20:35], v[232:235], v[224:227], v[20:35]
    v_pk_mul_f16 v220, v176, v183 op_sel_hi:[0,1]
    v_pk_mul_f16 v221, v176, v184 op_sel_hi:[0,1]
    v_pk_mul_f16 v222, v176, v185 op_sel_hi:[0,1]
    v_pk_mul_f16 v223, v176, v186 op_sel_hi:[0,1]
    v_add_f32 v248, v248, v244
    v_mfma_f32_32x32x16_f16 v[36:51], v[232:235], v[216:219], v[36:51]
    ds_read_b128 v[228:231], v1 offset:11264
    v_pack_b32_f16 v224, v146, v147
    v_pack_b32_f16 v225, v148, v149
    v_pack_b32_f16 v226, v150, v151
    v_pack_b32_f16 v227, v152, v153
    v_mfma_f32_32x32x16_f16 v[52:67], v[232:235], v[220:223], v[52:67]
    v_pack_b32_f16 v216, v154, v155
    v_pack_b32_f16 v217, v156, v157
    v_pack_b32_f16 v218, v158, v158
    v_mfma_f32_32x32x16_f16 v[188:203], v[204:207], v[224:227], 0
    v_pk_mul_f16 v220, v135, v135 op_sel_hi:[0,1]
    v_pk_mul_f16 v221, v135, v136 op_sel_hi:[0,1]
    v_pk_mul_f16 v222, v135, v137 op_sel_hi:[0,1]
    v_pk_mul_f16 v223, v135, v138 op_sel_hi:[0,1]
    v_mfma_f32_32x32x16_f16 v[188:203], v[208:211], v[216:219], v[188:203]
    v_pk_mul_f16 v224, v149, v149 op_sel_hi:[0,1]
    v_pk_mul_f16 v225, v149, v150 op_sel_hi:[0,1]
    v_pk_mul_f16 v226, v149, v151 op_sel_hi:[0,1]
    v_pk_mul_f16 v227, v149, v152 op_sel_hi:[0,1]
    v_mfma_f32_32x32x16_f16 v[4:19], v[236:239], v[220:223], v[4:19]
    ds_read_b128 v[232:235], v1 offset:12288
    v_pk_mul_f16 v216, v163, v163 op_sel_hi:[0,1]
    v_pk_mul_f16 v217, v163, v164 op_sel_hi:[0,1]
    v_pk_mul_f16 v218, v163, v165 op_sel_hi:[0,1]
    v_pk_mul_f16 v219, v163, v166 op_sel_hi:[0,1]
    v_bfe_u32 v2, v0, 4, 1
    v_mfma_f32_32x32x16_f16 v[20:35], v[236:239], v[224:227], v[20:35]
    v_pk_mul_f16 v220, v177, v177 op_sel_hi:[0,1]
    v_pk_mul_f16 v221, v177, v178 op_sel_hi:[0,1]
    v_pk_mul_f16 v222, v177, v179 op_sel_hi:[0,1]
    v_pk_mul_f16 v223, v177, v180 op_sel_hi:[0,1]
    v_lshrrev_b32 v3, 5, v0
    v_lshl_add_u32 v2, v2, 1, v3
    v_mfma_f32_32x32x16_f16 v[36:51], v[236:239], v[216:219], v[36:51]
    v_pk_mul_f16 v224, v135, v139 op_sel_hi:[0,1]
    v_pk_mul_f16 v225, v135, v140 op_sel_hi:[0,1]
    v_pk_mul_f16 v226, v135, v141 op_sel_hi:[0,1]
    v_pk_mul_f16 v227, v135, v142 op_sel_hi:[0,1]
    v_and_b32 v3, 15, v0
    v_cmp_lt_u32 vcc, 14, v3
    v_mfma_f32_32x32x16_f16 v[52:67], v[236:239], v[220:223], v[52:67]
    v_pk_mul_f16 v216, v149, v153 op_sel_hi:[0,1]
    v_pk_mul_f16 v217, v149, v154 op_sel_hi:[0,1]
    v_pk_mul_f16 v218, v149, v155 op_sel_hi:[0,1]
    v_pk_mul_f16 v219, v149, v156 op_sel_hi:[0,1]
    v_lshlrev_b32 v3, 10, v3
    s_waitcnt lgkmcnt(0)
    v_mfma_f32_32x32x16_f16 v[4:19], v[240:243], v[224:227], v[4:19]
    ds_read_b128 v[236:239], v1 offset:13312
    v_pk_mul_f16 v220, v163, v167 op_sel_hi:[0,1]
    v_pk_mul_f16 v221, v163, v168 op_sel_hi:[0,1]
    v_pk_mul_f16 v222, v163, v169 op_sel_hi:[0,1]
    v_pk_mul_f16 v223, v163, v170 op_sel_hi:[0,1]
    v_lshl_add_u32 v3, v2, 2, v3
    v_mfma_f32_32x32x16_f16 v[20:35], v[240:243], v[216:219], v[20:35]
    v_pk_mul_f16 v224, v177, v181 op_sel_hi:[0,1]
    v_pk_mul_f16 v225, v177, v182 op_sel_hi:[0,1]
    v_pk_mul_f16 v226, v177, v183 op_sel_hi:[0,1]
    v_pk_mul_f16 v227, v177, v184 op_sel_hi:[0,1]
    v_mul_f32 v245, v188, v84
    v_mfma_f32_32x32x16_f16 v[36:51], v[240:243], v[220:223], v[36:51]
    v_pk_mul_f16 v216, v135, v143 op_sel_hi:[0,1]
    v_pk_mul_f16 v217, v135, v144 op_sel_hi:[0,1]
    v_pk_mul_f16 v218, v136, v136 op_sel_hi:[0,1]
    v_pk_mul_f16 v219, v136, v137 op_sel_hi:[0,1]
    v_fmac_f32 v245, v189, v85
    v_fmac_f32 v245, v190, v86
    v_mfma_f32_32x32x16_f16 v[52:67], v[240:243], v[224:227], v[52:67]
    v_pk_mul_f16 v220, v149, v157 op_sel_hi:[0,1]
    v_pk_mul_f16 v221, v149, v158 op_sel_hi:[0,1]
    v_pk_mul_f16 v222, v150, v150 op_sel_hi:[0,1]
    v_pk_mul_f16 v223, v150, v151 op_sel_hi:[0,1]
    v_fmac_f32 v245, v191, v87
    v_mfma_f32_32x32x16_f16 v[4:19], v[228:231], v[216:219], v[4:19]
    v_pk_mul_f16 v224, v163, v171 op_sel_hi:[0,1]
    v_pk_mul_f16 v225, v163, v172 op_sel_hi:[0,1]
    v_pk_mul_f16 v226, v164, v164 op_sel_hi:[0,1]
    v_pk_mul_f16 v227, v164, v165 op_sel_hi:[0,1]
    v_fmac_f32 v245, v192, v88
    v_fmac_f32 v245, v193, v89
    v_mfma_f32_32x32x16_f16 v[20:35], v[228:231], v[220:223], v[20:35]
    v_pk_mul_f16 v216, v177, v185 op_sel_hi:[0,1]
    v_pk_mul_f16 v217, v177, v186 op_sel_hi:[0,1]
    v_pk_mul_f16 v218, v178, v178 op_sel_hi:[0,1]
    v_pk_mul_f16 v219, v178, v179 op_sel_hi:[0,1]
    v_fmac_f32 v245, v194, v90
    v_mfma_f32_32x32x16_f16 v[36:51], v[228:231], v[224:227], v[36:51]
    ds_read_b128 v[240:243], v1 offset:14336
    v_pk_mul_f16 v220, v136, v138 op_sel_hi:[0,1]
    v_pk_mul_f16 v221, v136, v139 op_sel_hi:[0,1]
    v_pk_mul_f16 v222, v136, v140 op_sel_hi:[0,1]
    v_pk_mul_f16 v223, v136, v141 op_sel_hi:[0,1]
    v_fmac_f32 v245, v195, v91
    v_mfma_f32_32x32x16_f16 v[52:67], v[228:231], v[216:219], v[52:67]
    v_pk_mul_f16 v224, v150, v152 op_sel_hi:[0,1]
    v_pk_mul_f16 v225, v150, v153 op_sel_hi:[0,1]
    v_pk_mul_f16 v226, v150, v154 op_sel_hi:[0,1]
    v_pk_mul_f16 v227, v150, v155 op_sel_hi:[0,1]
    v_fmac_f32 v245, v196, v92
    v_fmac_f32 v245, v197, v93
    v_mfma_f32_32x32x16_f16 v[4:19], v[232:235], v[220:223], v[4:19]
    v_pk_mul_f16 v216, v164, v166 op_sel_hi:[0,1]
    v_pk_mul_f16 v217, v164, v167 op_sel_hi:[0,1]
    v_pk_mul_f16 v218, v164, v168 op_sel_hi:[0,1]
    v_pk_mul_f16 v219, v164, v169 op_sel_hi:[0,1]
    v_fmac_f32 v245, v198, v94
    v_fmac_f32 v245, v199, v95
    v_mfma_f32_32x32x16_f16 v[20:35], v[232:235], v[224:227], v[20:35]
    v_pk_mul_f16 v220, v178, v180 op_sel_hi:[0,1]
    v_pk_mul_f16 v221, v178, v181 op_sel_hi:[0,1]
    v_pk_mul_f16 v222, v178, v182 op_sel_hi:[0,1]
    v_pk_mul_f16 v223, v178, v183 op_sel_hi:[0,1]
    v_fmac_f32 v245, v200, v96
    v_mfma_f32_32x32x16_f16 v[36:51], v[232:235], v[216:219], v[36:51]
    ds_read_b128 v[228:231], v1 offset:15360
    v_pk_mul_f16 v224, v136, v142 op_sel_hi:[0,1]
    v_pk_mul_f16 v225, v136, v143 op_sel_hi:[0,1]
    v_pk_mul_f16 v226, v136, v144 op_sel_hi:[0,1]
    v_pk_mul_f16 v227, v137, v137 op_sel_hi:[0,1]
    v_add_u32 v253, s5, v159
    v_mfma_f32_32x32x16_f16 v[52:67], v[232:235], v[220:223], v[52:67]
    v_pk_mul_f16 v216, v150, v156 op_sel_hi:[0,1]
    v_pk_mul_f16 v217, v150, v157 op_sel_hi:[0,1]
    v_pk_mul_f16 v218, v150, v158 op_sel_hi:[0,1]
    v_pk_mul_f16 v219, v151, v151 op_sel_hi:[0,1]
    v_ldexp_f32 v245, v245, v253
    s_waitcnt lgkmcnt(1)
    v_mfma_f32_32x32x16_f16 v[4:19], v[236:239], v[224:227], v[4:19]
    v_pk_mul_f16 v220, v164, v170 op_sel_hi:[0,1]
    v_pk_mul_f16 v221, v164, v171 op_sel_hi:[0,1]
    v_pk_mul_f16 v222, v164, v172 op_sel_hi:[0,1]
    v_pk_mul_f16 v223, v165, v165 op_sel_hi:[0,1]
    v_add_u32 v253, s65, v159
    v_add_f32 v249, v249, v245
    v_mfma_f32_32x32x16_f16 v[20:35], v[236:239], v[216:219], v[20:35]
    v_pk_mul_f16 v224, v178, v184 op_sel_hi:[0,1]
    v_pk_mul_f16 v225, v178, v185 op_sel_hi:[0,1]
    v_pk_mul_f16 v226, v178, v186 op_sel_hi:[0,1]
    v_pk_mul_f16 v227, v179, v179 op_sel_hi:[0,1]
    v_mfma_f32_32x32x16_f16 v[36:51], v[236:239], v[220:223], v[36:51]
    ds_read_b128 v[232:235], v1 offset:16384
    v_pack_b32_f16 v216, v160, v161
    v_pack_b32_f16 v217, v162, v163
    v_pack_b32_f16 v218, v164, v165
    v_pack_b32_f16 v219, v166, v167
    v_mfma_f32_32x32x16_f16 v[52:67], v[236:239], v[224:227], v[52:67]
    v_pack_b32_f16 v220, v168, v169
    v_pack_b32_f16 v221, v170, v171
    v_pack_b32_f16 v222, v172, v172
    v_mfma_f32_32x32x16_f16 v[188:203], v[204:207], v[216:219], 0
    v_pk_mul_f16 v224, v137, v138 op_sel_hi:[0,1]
    v_pk_mul_f16 v225, v137, v139 op_sel_hi:[0,1]
    v_pk_mul_f16 v226, v137, v140 op_sel_hi:[0,1]
    v_pk_mul_f16 v227, v137, v141 op_sel_hi:[0,1]
    v_mfma_f32_32x32x16_f16 v[188:203], v[208:211], v[220:223], v[188:203]
    v_pk_mul_f16 v216, v151, v152 op_sel_hi:[0,1]
    v_pk_mul_f16 v217, v151, v153 op_sel_hi:[0,1]
    v_pk_mul_f16 v218, v151, v154 op_sel_hi:[0,1]
    v_pk_mul_f16 v219, v151, v155 op_sel_hi:[0,1]
    v_mfma_f32_32x32x16_f16 v[4:19], v[240:243], v[224:227], v[4:19]
    ds_read_b128 v[236:239], v1 offset:17408
    v_pk_mul_f16 v220, v165, v166 op_sel_hi:[0,1]
    v_pk_mul_f16 v221, v165, v167 op_sel_hi:[0,1]
    v_pk_mul_f16 v222, v165, v168 op_sel_hi:[0,1]
    v_pk_mul_f16 v223, v165, v169 op_sel_hi:[0,1]
    v_mov_b32 v2, 1073741824
    v_mfma_f32_32x32x16_f16 v[20:35], v[240:243], v[216:219], v[20:35]
    v_pk_mul_f16 v224, v179, v180 op_sel_hi:[0,1]
    v_pk_mul_f16 v225, v179, v181 op_sel_hi:[0,1]
    v_pk_mul_f16 v226, v179, v182 op_sel_hi:[0,1]
    v_pk_mul_f16 v227, v179, v183 op_sel_hi:[0,1]
    v_cndmask_b32 v3, v3, v2, vcc
    s_mul_i32 s75, s70, 15360
    v_mfma_f32_32x32x16_f16 v[36:51], v[240:243], v[220:223], v[36:51]
    v_pk_mul_f16 v216, v137, v142 op_sel_hi:[0,1]
    v_pk_mul_f16 v217, v137, v143 op_sel_hi:[0,1]
    v_pk_mul_f16 v218, v137, v144 op_sel_hi:[0,1]
    v_pk_mul_f16 v219, v138, v138 op_sel_hi:[0,1]
    s_and_b32 s72, s82, 255
    v_mfma_f32_32x32x16_f16 v[52:67], v[240:243], v[224:227], v[52:67]
    v_pk_mul_f16 v220, v151, v156 op_sel_hi:[0,1]
    v_pk_mul_f16 v221, v151, v157 op_sel_hi:[0,1]
    v_pk_mul_f16 v222, v151, v158 op_sel_hi:[0,1]
    v_pk_mul_f16 v223, v152, v152 op_sel_hi:[0,1]
    s_lshl_b32 s72, s72, 2
    s_waitcnt lgkmcnt(0)
    v_mfma_f32_32x32x16_f16 v[4:19], v[228:231], v[216:219], v[4:19]
    ds_read_b128 v[240:243], v1 offset:18432
    v_pk_mul_f16 v224, v165, v170 op_sel_hi:[0,1]
    v_pk_mul_f16 v225, v165, v171 op_sel_hi:[0,1]
    v_pk_mul_f16 v226, v165, v172 op_sel_hi:[0,1]
    v_pk_mul_f16 v227, v166, v166 op_sel_hi:[0,1]
    s_add_u32 s75, s75, s72
    v_mfma_f32_32x32x16_f16 v[20:35], v[228:231], v[220:223], v[20:35]
    v_pk_mul_f16 v216, v179, v184 op_sel_hi:[0,1]
    v_pk_mul_f16 v217, v179, v185 op_sel_hi:[0,1]
    v_pk_mul_f16 v218, v179, v186 op_sel_hi:[0,1]
    v_pk_mul_f16 v219, v180, v180 op_sel_hi:[0,1]
    s_add_u32 s75, s75, 118784
    v_mfma_f32_32x32x16_f16 v[36:51], v[228:231], v[224:227], v[36:51]
    v_pk_mul_f16 v220, v138, v139 op_sel_hi:[0,1]
    v_pk_mul_f16 v221, v138, v140 op_sel_hi:[0,1]
    v_pk_mul_f16 v222, v138, v141 op_sel_hi:[0,1]
    v_pk_mul_f16 v223, v138, v142 op_sel_hi:[0,1]
    v_mul_f32 v246, v188, v100
    v_fmac_f32 v246, v189, v101
    v_mfma_f32_32x32x16_f16 v[52:67], v[228:231], v[216:219], v[52:67]
    v_pk_mul_f16 v224, v152, v153 op_sel_hi:[0,1]
    v_pk_mul_f16 v225, v152, v154 op_sel_hi:[0,1]
    v_pk_mul_f16 v226, v152, v155 op_sel_hi:[0,1]
    v_pk_mul_f16 v227, v152, v156 op_sel_hi:[0,1]
    v_fmac_f32 v246, v190, v102
    v_mfma_f32_32x32x16_f16 v[4:19], v[232:235], v[220:223], v[4:19]
    v_pk_mul_f16 v216, v166, v167 op_sel_hi:[0,1]
    v_pk_mul_f16 v217, v166, v168 op_sel_hi:[0,1]
    v_pk_mul_f16 v218, v166, v169 op_sel_hi:[0,1]
    v_pk_mul_f16 v219, v166, v170 op_sel_hi:[0,1]
    v_fmac_f32 v246, v191, v103
    v_fmac_f32 v246, v192, v104
    v_mfma_f32_32x32x16_f16 v[20:35], v[232:235], v[224:227], v[20:35]
    v_pk_mul_f16 v220, v180, v181 op_sel_hi:[0,1]
    v_pk_mul_f16 v221, v180, v182 op_sel_hi:[0,1]
    v_pk_mul_f16 v222, v180, v183 op_sel_hi:[0,1]
    v_pk_mul_f16 v223, v180, v184 op_sel_hi:[0,1]
    v_fmac_f32 v246, v193, v105
    v_mfma_f32_32x32x16_f16 v[36:51], v[232:235], v[216:219], v[36:51]
    ds_read_b128 v[228:231], v1 offset:19456
    v_pk_mul_f16 v224, v138, v143 op_sel_hi:[0,1]
    v_pk_mul_f16 v225, v138, v144 op_sel_hi:[0,1]
    v_pk_mul_f16 v226, v139, v139 op_sel_hi:[0,1]
    v_pk_mul_f16 v227, v139, v140 op_sel_hi:[0,1]
    v_fmac_f32 v246, v194, v106
    v_mfma_f32_32x32x16_f16 v[52:67], v[232:235], v[220:223], v[52:67]
    v_pk_mul_f16 v216, v152, v157 op_sel_hi:[0,1]
    v_pk_mul_f16 v217, v152, v158 op_sel_hi:[0,1]
    v_pk_mul_f16 v218, v153, v153 op_sel_hi:[0,1]
    v_pk_mul_f16 v219, v153, v154 op_sel_hi:[0,1]
    v_fmac_f32 v246, v195, v107
    v_fmac_f32 v246, v196, v108
    v_mfma_f32_32x32x16_f16 v[4:19], v[236:239], v[224:227], v[4:19]
    v_pk_mul_f16 v220, v166, v171 op_sel_hi:[0,1]
    v_pk_mul_f16 v221, v166, v172 op_sel_hi:[0,1]
    v_pk_mul_f16 v222, v167, v167 op_sel_hi:[0,1]
    v_pk_mul_f16 v223, v167, v168 op_sel_hi:[0,1]
    buffer_load_dword v2, v3, s[12:15], s75 offen sc1
    v_mfma_f32_32x32x16_f16 v[20:35], v[236:239], v[216:219], v[20:35]
    v_pk_mul_f16 v224, v180, v185 op_sel_hi:[0,1]
    v_pk_mul_f16 v225, v180, v186 op_sel_hi:[0,1]
    v_pk_mul_f16 v226, v181, v181 op_sel_hi:[0,1]
    v_pk_mul_f16 v227, v181, v182 op_sel_hi:[0,1]
    v_fmac_f32 v246, v197, v109
    v_mfma_f32_32x32x16_f16 v[36:51], v[236:239], v[220:223], v[36:51]
    ds_read_b128 v[232:235], v1 offset:20480
    v_pk_mul_f16 v216, v139, v141 op_sel_hi:[0,1]
    v_pk_mul_f16 v217, v139, v142 op_sel_hi:[0,1]
    v_pk_mul_f16 v218, v139, v143 op_sel_hi:[0,1]
    v_pk_mul_f16 v219, v139, v144 op_sel_hi:[0,1]
    v_fmac_f32 v246, v198, v110
    v_mfma_f32_32x32x16_f16 v[52:67], v[236:239], v[224:227], v[52:67]
    v_pk_mul_f16 v220, v153, v155 op_sel_hi:[0,1]
    v_pk_mul_f16 v221, v153, v156 op_sel_hi:[0,1]
    v_pk_mul_f16 v222, v153, v157 op_sel_hi:[0,1]
    v_pk_mul_f16 v223, v153, v158 op_sel_hi:[0,1]
    v_fmac_f32 v246, v199, v111
    v_fmac_f32 v246, v200, v112
    s_waitcnt lgkmcnt(1)
    v_mfma_f32_32x32x16_f16 v[4:19], v[240:243], v[216:219], v[4:19]
    v_pk_mul_f16 v224, v167, v169 op_sel_hi:[0,1]
    v_pk_mul_f16 v225, v167, v170 op_sel_hi:[0,1]
    v_pk_mul_f16 v226, v167, v171 op_sel_hi:[0,1]
    v_pk_mul_f16 v227, v167, v172 op_sel_hi:[0,1]
    v_add_u32 v254, s6, v173
    v_mfma_f32_32x32x16_f16 v[20:35], v[240:243], v[220:223], v[20:35]
    v_pk_mul_f16 v216, v181, v183 op_sel_hi:[0,1]
    v_pk_mul_f16 v217, v181, v184 op_sel_hi:[0,1]
    v_pk_mul_f16 v218, v181, v185 op_sel_hi:[0,1]
    v_pk_mul_f16 v219, v181, v186 op_sel_hi:[0,1]
    v_ldexp_f32 v246, v246, v254
    v_mfma_f32_32x32x16_f16 v[36:51], v[240:243], v[224:227], v[36:51]
    ds_read_b128 v[236:239], v1 offset:21504
    v_pack_b32_f16 v220, v174, v175
    v_pack_b32_f16 v221, v176, v177
    v_pack_b32_f16 v222, v178, v179
    v_pack_b32_f16 v223, v180, v181
    v_add_u32 v254, s66, v173
    v_mfma_f32_32x32x16_f16 v[52:67], v[240:243], v[216:219], v[52:67]
    v_pack_b32_f16 v224, v182, v183
    v_pack_b32_f16 v225, v184, v185
    v_pack_b32_f16 v226, v186, v186
    v_add_f32 v250, v250, v246
    v_mfma_f32_32x32x16_f16 v[188:203], v[204:207], v[220:223], 0
    ds_read_b128 v[240:243], v1 offset:22528
    v_pk_mul_f16 v216, v140, v140 op_sel_hi:[0,1]
    v_pk_mul_f16 v217, v140, v141 op_sel_hi:[0,1]
    v_pk_mul_f16 v218, v140, v142 op_sel_hi:[0,1]
    v_pk_mul_f16 v219, v140, v143 op_sel_hi:[0,1]
    v_mfma_f32_32x32x16_f16 v[188:203], v[208:211], v[224:227], v[188:203]
    v_pk_mul_f16 v220, v154, v154 op_sel_hi:[0,1]
    v_pk_mul_f16 v221, v154, v155 op_sel_hi:[0,1]
    v_pk_mul_f16 v222, v154, v156 op_sel_hi:[0,1]
    v_pk_mul_f16 v223, v154, v157 op_sel_hi:[0,1]
    v_mfma_f32_32x32x16_f16 v[4:19], v[228:231], v[216:219], v[4:19]
    v_pk_mul_f16 v224, v168, v168 op_sel_hi:[0,1]
    v_pk_mul_f16 v225, v168, v169 op_sel_hi:[0,1]
    v_pk_mul_f16 v226, v168, v170 op_sel_hi:[0,1]
    v_pk_mul_f16 v227, v168, v171 op_sel_hi:[0,1]
    v_mfma_f32_32x32x16_f16 v[20:35], v[228:231], v[220:223], v[20:35]
    v_pk_mul_f16 v216, v182, v182 op_sel_hi:[0,1]
    v_pk_mul_f16 v217, v182, v183 op_sel_hi:[0,1]
    v_pk_mul_f16 v218, v182, v184 op_sel_hi:[0,1]
    v_pk_mul_f16 v219, v182, v185 op_sel_hi:[0,1]
    v_mfma_f32_32x32x16_f16 v[36:51], v[228:231], v[224:227], v[36:51]
    v_pk_mul_f16 v220, v140, v144 op_sel_hi:[0,1]
    v_pk_mul_f16 v221, v141, v141 op_sel_hi:[0,1]
    v_pk_mul_f16 v222, v141, v142 op_sel_hi:[0,1]
    v_pk_mul_f16 v223, v141, v143 op_sel_hi:[0,1]
    v_mfma_f32_32x32x16_f16 v[52:67], v[228:231], v[216:219], v[52:67]
    v_pk_mul_f16 v224, v154, v158 op_sel_hi:[0,1]
    v_pk_mul_f16 v225, v155, v155 op_sel_hi:[0,1]
    v_pk_mul_f16 v226, v155, v156 op_sel_hi:[0,1]
    v_pk_mul_f16 v227, v155, v157 op_sel_hi:[0,1]
    s_waitcnt lgkmcnt(0)
    v_mfma_f32_32x32x16_f16 v[4:19], v[232:235], v[220:223], v[4:19]
    v_pk_mul_f16 v216, v168, v172 op_sel_hi:[0,1]
    v_pk_mul_f16 v217, v169, v169 op_sel_hi:[0,1]
    v_pk_mul_f16 v218, v169, v170 op_sel_hi:[0,1]
    v_pk_mul_f16 v219, v169, v171 op_sel_hi:[0,1]
    v_mul_f32 v247, v188, v116
    v_fmac_f32 v247, v189, v117
    v_mfma_f32_32x32x16_f16 v[20:35], v[232:235], v[224:227], v[20:35]
    v_pk_mul_f16 v220, v182, v186 op_sel_hi:[0,1]
    v_pk_mul_f16 v221, v183, v183 op_sel_hi:[0,1]
    v_pk_mul_f16 v222, v183, v184 op_sel_hi:[0,1]
    v_pk_mul_f16 v223, v183, v185 op_sel_hi:[0,1]
    v_fmac_f32 v247, v190, v118
    v_fmac_f32 v247, v191, v119
    v_mfma_f32_32x32x16_f16 v[36:51], v[232:235], v[216:219], v[36:51]
    v_pk_mul_f16 v224, v141, v144 op_sel_hi:[0,1]
    v_pk_mul_f16 v225, v142, v142 op_sel_hi:[0,1]
    v_pk_mul_f16 v226, v142, v143 op_sel_hi:[0,1]
    v_pk_mul_f16 v227, v142, v144 op_sel_hi:[0,1]
    v_fmac_f32 v247, v192, v120
    v_fmac_f32 v247, v193, v121
    v_mfma_f32_32x32x16_f16 v[52:67], v[232:235], v[220:223], v[52:67]
    v_pk_mul_f16 v216, v143, v143 op_sel_hi:[0,1]
    v_pk_mul_f16 v217, v143, v144 op_sel_hi:[0,1]
    v_pk_mul_f16 v218, v144, v144 op_sel_hi:[0,1]
    v_fmac_f32 v247, v194, v122
    v_fmac_f32 v247, v195, v123
    v_fmac_f32 v247, v196, v124
    v_mfma_f32_32x32x16_f16 v[4:19], v[236:239], v[224:227], v[4:19]
    v_pk_mul_f16 v220, v155, v158 op_sel_hi:[0,1]
    v_pk_mul_f16 v221, v156, v156 op_sel_hi:[0,1]
    v_pk_mul_f16 v222, v156, v157 op_sel_hi:[0,1]
    v_pk_mul_f16 v223, v156, v158 op_sel_hi:[0,1]
    v_fmac_f32 v247, v197, v125
    v_fmac_f32 v247, v198, v126
    v_mfma_f32_32x32x16_f16 v[4:19], v[240:243], v[216:219], v[4:19]
    v_pk_mul_f16 v224, v157, v157 op_sel_hi:[0,1]
    v_pk_mul_f16 v225, v157, v158 op_sel_hi:[0,1]
    v_pk_mul_f16 v226, v158, v158 op_sel_hi:[0,1]
    v_fmac_f32 v247, v199, v127
    v_fmac_f32 v247, v200, v128
    v_add_u32 v255, s7, v187
    v_mfma_f32_32x32x16_f16 v[20:35], v[236:239], v[220:223], v[20:35]
    v_pk_mul_f16 v216, v169, v172 op_sel_hi:[0,1]
    v_pk_mul_f16 v217, v170, v170 op_sel_hi:[0,1]
    v_pk_mul_f16 v218, v170, v171 op_sel_hi:[0,1]
    v_pk_mul_f16 v219, v170, v172 op_sel_hi:[0,1]
    v_ldexp_f32 v247, v247, v255
    v_mfma_f32_32x32x16_f16 v[20:35], v[240:243], v[224:227], v[20:35]
    v_mul_f32 v244, v4, v68
    v_ldexp_f32 v19, v19, s76
    v_fmac_f32 v244, v5, v69
    v_fmac_f32 v244, v6, v70
    v_fmac_f32 v244, v7, v71
    v_pk_mul_f16 v220, v171, v171 op_sel_hi:[0,1]
    v_pk_mul_f16 v221, v171, v172 op_sel_hi:[0,1]
    v_pk_mul_f16 v222, v172, v172 op_sel_hi:[0,1]
    v_mfma_f32_32x32x16_f16 v[36:51], v[236:239], v[216:219], v[36:51]
    v_fmac_f32 v244, v8, v72
    v_fmac_f32 v244, v9, v73
    v_fmac_f32 v244, v10, v74
    v_fmac_f32 v244, v11, v75
    v_fmac_f32 v244, v12, v76
    v_pk_mul_f16 v224, v183, v186 op_sel_hi:[0,1]
    v_pk_mul_f16 v225, v184, v184 op_sel_hi:[0,1]
    v_pk_mul_f16 v226, v184, v185 op_sel_hi:[0,1]
    v_pk_mul_f16 v227, v184, v186 op_sel_hi:[0,1]
    v_mfma_f32_32x32x16_f16 v[36:51], v[240:243], v[220:223], v[36:51]
    v_fmac_f32 v244, v13, v77
    v_fmac_f32 v244, v14, v78
    v_fmac_f32 v244, v15, v79
    v_fmac_f32 v244, v16, v80
    v_add_f32 v248, v248, v19
    v_pk_mul_f16 v216, v185, v185 op_sel_hi:[0,1]
    v_pk_mul_f16 v217, v185, v186 op_sel_hi:[0,1]
    v_pk_mul_f16 v218, v186, v186 op_sel_hi:[0,1]
    v_mfma_f32_32x32x16_f16 v[52:67], v[236:239], v[224:227], v[52:67]
    v_ldexp_f32 v244, v244, v252
    v_add_f32 v248, v248, v244
    v_mul_f32 v245, v20, v84
    v_ldexp_f32 v35, v35, s77
    v_fmac_f32 v245, v21, v85
    v_add_u32 v255, s67, v187
    v_mfma_f32_32x32x16_f16 v[52:67], v[240:243], v[216:219], v[52:67]
    v_fmac_f32 v245, v22, v86
    v_fmac_f32 v245, v23, v87
    v_fmac_f32 v245, v24, v88
    v_fmac_f32 v245, v25, v89
    v_fmac_f32 v245, v26, v90
    v_add_f32 v251, v251, v247
    v_fmac_f32 v245, v27, v91
    v_fmac_f32 v245, v28, v92
    v_fmac_f32 v245, v29, v93
    v_fmac_f32 v245, v30, v94
    v_fmac_f32 v245, v31, v95
    v_fmac_f32 v245, v32, v96
    v_add_f32 v249, v249, v35
    v_ldexp_f32 v245, v245, v253
    v_add_f32 v249, v249, v245
    v_mul_f32 v246, v36, v100
    v_ldexp_f32 v51, v51, s78
    v_fmac_f32 v246, v37, v101
    v_fmac_f32 v246, v38, v102
    v_fmac_f32 v246, v39, v103
    v_fmac_f32 v246, v40, v104
    v_fmac_f32 v246, v41, v105
    v_fmac_f32 v246, v42, v106
    v_fmac_f32 v246, v43, v107
    v_fmac_f32 v246, v44, v108
    v_fmac_f32 v246, v45, v109
    v_fmac_f32 v246, v46, v110
    v_fmac_f32 v246, v47, v111
    v_fmac_f32 v246, v48, v112
    v_add_f32 v250, v250, v51
    v_ldexp_f32 v246, v246, v254
    v_add_f32 v250, v250, v246
    v_mul_f32 v247, v52, v116
    v_ldexp_f32 v67, v67, s79
    v_fmac_f32 v247, v53, v117
    v_fmac_f32 v247, v54, v118
    v_fmac_f32 v247, v55, v119
    v_fmac_f32 v247, v56, v120
    v_fmac_f32 v247, v57, v121
    v_fmac_f32 v247, v58, v122
    v_fmac_f32 v247, v59, v123
    v_fmac_f32 v247, v60, v124
    v_fmac_f32 v247, v61, v125
    v_fmac_f32 v247, v62, v126
    v_fmac_f32 v247, v63, v127
    v_fmac_f32 v247, v64, v128
    v_add_f32 v251, v251, v67
    v_ldexp_f32 v247, v247, v255
    v_add_f32 v251, v251, v247
    v_permlane32_swap_b32 v248, v249
    s_nop 0
    v_permlane32_swap_b32 v250, v251
    v_add_f32 v248, v248, v249
    v_add_f32 v250, v250, v251
    s_nop 1
    v_permlane16_swap_b32 v248, v250
    v_add_f32 v248, v248, v250
    s_mov_b32 s72, 200000
L_pcheck:
    s_waitcnt vmcnt(0)
    v_cmp_eq_u32 vcc, -1, v2
    s_nop 1
    s_cbranch_vccz L_pok
    s_sleep 4
    buffer_load_dword v2, v3, s[12:15], s75 offen sc1
    s_sub_u32 s72, s72, 1
    s_cbranch_scc0 L_pcheck
    s_waitcnt vmcnt(0)
L_pok:
    v_add_f32 v248, v248, v2
    s_nop 1
    v_add_f32_dpp v248, v248, v248 row_ror:8 row_mask:0xf bank_mask:0xf
    s_nop 1
    v_add_f32_dpp v248, v248, v248 row_ror:4 row_mask:0xf bank_mask:0xf
    s_nop 1
    v_add_f32_dpp v248, v248, v248 row_ror:2 row_mask:0xf bank_mask:0xf
    s_nop 1
    v_add_f32_dpp v248, v248, v248 row_ror:1 row_mask:0xf bank_mask:0xf
    v_add_f32 v248, s36, v248
    v_cvt_pk_bf16_f32 v248, v248, v248
    v_lshrrev_b32 v3, 1, v3
    v_cmp_lt_u32 vcc, 7, v3
    v_mov_b32 v2, 1073741824
    s_nop 0
    v_cndmask_b32 v3, v3, v2, vcc
    s_lshl_b32 s72, s82, 1
    buffer_store_short v248, v3, s[28:31], s72 offen
    s_endpgm
L_helper2:
    s_barrier
    v_mov_b32 v61, 1073741824
    v_add_u32 v60, s3, v0
    v_cmp_eq_u32 vcc, 0, v60
    s_nop 1
    v_cndmask_b32 v253, v61, 0, vcc
    s_lshr_b32 s82, s71, 1
    s_mul_i32 s82, s82, 224
    s_and_b32 s69, s71, 1
    s_mul_i32 s69, s69, 96
    s_add_u32 s82, s82, s69
    v_lshrrev_b32 v27, 1, v2
    v_and_b32 v28, 1, v2
    v_lshlrev_b32 v19, 4, v28
    v_sub_u32 v29, 25, v27
    v_mul_u32_u24 v29, v29, v27
    v_lshrrev_b32 v29, 1, v29
    s_lshl_b32 s72, s3, 4
    v_lshl_add_u32 v28, v28, 9, s72
    v_lshl_add_u32 v30, v0, 2, s72
    v_add_u32 v30, 24960, v30
    v_mov_b32 v33, 0.5
    v_lshl_add_u32 v31, v3, 1, 0
    v_add_u32 v32, v29, v31
    v_lshrrev_b32 v12, 2, v32
    v_mul_u32_u24 v12, 1040, v12
    v_and_b32 v32, 3, v32
    v_lshl_add_u32 v32, v32, 2, v28
    v_add_u32 v12, v12, v32
    v_cmp_lt_u32 vcc, v31, v27
    s_nop 1
    v_cndmask_b32 v12, v12, v30, vcc
    v_cmp_eq_u32 vcc, v31, v27
    s_nop 1
    v_cndmask_b32 v20, 1.0, v33, vcc
    v_lshl_add_u32 v31, v3, 1, 1
    v_add_u32 v32, v29, v31
    v_lshrrev_b32 v13, 2, v32
    v_mul_u32_u24 v13, 1040, v13
    v_and_b32 v32, 3, v32
    v_lshl_add_u32 v32, v32, 2, v28
    v_add_u32 v13, v13, v32
    v_cmp_lt_u32 vcc, v31, v27
    s_nop 1
    v_cndmask_b32 v13, v13, v30, vcc
    v_cmp_eq_u32 vcc, v31, v27
    s_nop 1
    v_cndmask_b32 v21, 1.0, v33, vcc
    v_lshl_add_u32 v31, v3, 1, 4
    v_add_u32 v32, v29, v31
    v_lshrrev_b32 v14, 2, v32
    v_mul_u32_u24 v14, 1040, v14
    v_and_b32 v32, 3, v32
    v_lshl_add_u32 v32, v32, 2, v28
    v_add_u32 v14, v14, v32
    v_cmp_lt_u32 vcc, v31, v27
    s_nop 1
    v_cndmask_b32 v14, v14, v30, vcc
    v_cmp_eq_u32 vcc, v31, v27
    s_nop 1
    v_cndmask_b32 v22, 1.0, v33, vcc
    v_lshl_add_u32 v31, v3, 1, 5
    v_add_u32 v32, v29, v31
    v_lshrrev_b32 v15, 2, v32
    v_mul_u32_u24 v15, 1040, v15
    v_and_b32 v32, 3, v32
    v_lshl_add_u32 v32, v32, 2, v28
    v_add_u32 v15, v15, v32
    v_cmp_lt_u32 vcc, v31, v27
    s_nop 1
    v_cndmask_b32 v15, v15, v30, vcc
    v_cmp_eq_u32 vcc, v31, v27
    s_nop 1
    v_cndmask_b32 v23, 1.0, v33, vcc
    v_lshl_add_u32 v31, v3, 1, 8
    v_add_u32 v32, v29, v31
    v_lshrrev_b32 v16, 2, v32
    v_mul_u32_u24 v16, 1040, v16
    v_and_b32 v32, 3, v32
    v_lshl_add_u32 v32, v32, 2, v28
    v_add_u32 v16, v16, v32
    v_cmp_lt_u32 vcc, v31, v27
    s_nop 1
    v_cndmask_b32 v16, v16, v30, vcc
    v_cmp_eq_u32 vcc, v31, v27
    s_nop 1
    v_cndmask_b32 v24, 1.0, v33, vcc
    v_lshl_add_u32 v31, v3, 1, 9
    v_add_u32 v32, v29, v31
    v_lshrrev_b32 v17, 2, v32
    v_mul_u32_u24 v17, 1040, v17
    v_and_b32 v32, 3, v32
    v_lshl_add_u32 v32, v32, 2, v28
    v_add_u32 v17, v17, v32
    v_cmp_lt_u32 vcc, v31, v27
    s_nop 1
    v_cndmask_b32 v17, v17, v30, vcc
    v_cmp_eq_u32 vcc, v31, v27
    s_nop 1
    v_cndmask_b32 v25, 1.0, v33, vcc
    v_lshl_add_u32 v31, v3, 1, 12
    v_add_u32 v32, v29, v31
    v_lshrrev_b32 v18, 2, v32
    v_mul_u32_u24 v18, 1040, v18
    v_and_b32 v32, 3, v32
    v_lshl_add_u32 v32, v32, 2, v28
    v_add_u32 v18, v18, v32
    v_cmp_lt_u32 vcc, v31, v27
    v_cmp_lt_u32 s[72:73], 12, v31
    s_nop 0
    s_or_b64 vcc, vcc, s[72:73]
    v_cndmask_b32 v18, v18, v30, vcc
    v_cmp_eq_u32 vcc, v31, v27
    s_nop 1
    v_cndmask_b32 v26, 1.0, v33, vcc
    v_lshlrev_b32 v31, 3, v3
    v_sub_u32 v31, v2, v31
    v_mov_b32 v32, 0x3f80
    v_lshlrev_b32 v32, v19, v32
    v_lshrrev_b32 v31, 1, v31
    v_cmp_eq_u32 vcc, 0, v31
    s_nop 1
    v_cndmask_b32 v4, 0, v32, vcc
    v_cmp_eq_u32 vcc, 1, v31
    s_nop 1
    v_cndmask_b32 v5, 0, v32, vcc
    v_cmp_eq_u32 vcc, 2, v31
    s_nop 1
    v_cndmask_b32 v6, 0, v32, vcc
    v_cmp_eq_u32 vcc, 3, v31
    s_nop 1
    v_cndmask_b32 v7, 0, v32, vcc
    v_cmp_eq_u32 vcc, 8, v31
    s_nop 1
    v_cndmask_b32 v8, 0, v32, vcc
    v_cmp_eq_u32 vcc, 9, v31
    s_nop 1
    v_cndmask_b32 v9, 0, v32, vcc
    v_cmp_eq_u32 vcc, 10, v31
    s_nop 1
    v_cndmask_b32 v10, 0, v32, vcc
    v_cmp_eq_u32 vcc, 11, v31
    s_nop 1
    v_cndmask_b32 v11, 0, v32, vcc
    s_mul_i32 s54, s70, 15
    s_add_u32 s54, s54, s71
    s_lshl_b32 s54, s54, 2
    s_add_u32 s54, s54, s3
    s_lshl_b32 s54, s54, 8
    s_add_u32 s54, s54, 118784
    v_and_b32 v60, 15, v0
    v_mul_u32_u24 v245, 1680, v60
    v_and_b32 v60, 48, v0
    s_lshl_b32 s72, s3, 6
    s_add_u32 s72, s72, 90112
    v_add3_u32 v245, v245, v60, s72
    v_lshlrev_b32 v246, 4, v0
    s_lshl_b32 s61, s70, 2
    s_lshr_b32 s72, s71, 2
    s_add_u32 s61, s61, s72
    s_mul_i32 s61, s61, 106624
    s_and_b32 s72, s71, 3
    s_lshl_b32 s72, s72, 10
    s_add_u32 s61, s61, s72
    s_lshl_b32 s72, s3, 12
    s_add_u32 s61, s61, s72
    s_add_u32 s61, s61, 655488
    s_cmp_lt_u32 s71, 15
    s_cbranch_scc1 L_nordy
    s_waitcnt vmcnt(0)
    v_mov_b32 v35, 1
    s_lshl_b32 s60, s70, 2
    buffer_store_dword v35, v253, s[32:35], s60 offen offset:0 sc1
L_nordy:
    s_cmp_lt_u32 s48, 11
    s_cbranch_scc0 L_nc_19
    s_call_b64 s[66:67], L_pe2
L_nc_19:
    s_waitcnt vmcnt(12)
    v_mfma_f32_32x32x16_bf16 v[68:83], v[180:183], v[4:7], 0
    v_mfma_f32_32x32x16_bf16 v[68:83], v[184:187], v[8:11], v[68:83]
    v_mfma_f32_32x32x16_bf16 v[68:83], v[4:7], v[180:183], v[68:83]
    v_mfma_f32_32x32x16_bf16 v[68:83], v[8:11], v[184:187], v[68:83]
    s_waitcnt vmcnt(10)
    v_mfma_f32_32x32x16_bf16 v[84:99], v[188:191], v[4:7], 0
    v_mfma_f32_32x32x16_bf16 v[84:99], v[192:195], v[8:11], v[84:99]
    v_mfma_f32_32x32x16_bf16 v[84:99], v[4:7], v[188:191], v[84:99]
    v_mfma_f32_32x32x16_bf16 v[84:99], v[8:11], v[192:195], v[84:99]
    s_nop 6
    v_max_f32 v1, |v68|, |v69|
    v_max3_f32 v1, v1, |v70|, |v71|
    v_max3_f32 v1, v1, |v72|, |v73|
    v_max3_f32 v1, v1, |v74|, |v75|
    v_max3_f32 v1, v1, |v76|, |v77|
    v_max3_f32 v1, v1, |v78|, |v79|
    v_max3_f32 v1, v1, |v80|, |v81|
    s_waitcnt vmcnt(8)
    v_mfma_f32_32x32x16_bf16 v[100:115], v[196:199], v[4:7], 0
    v_mfma_f32_32x32x16_bf16 v[100:115], v[200:203], v[8:11], v[100:115]
    v_mfma_f32_32x32x16_bf16 v[100:115], v[4:7], v[196:199], v[100:115]
    v_mfma_f32_32x32x16_bf16 v[100:115], v[8:11], v[200:203], v[100:115]
    v_max3_f32 v1, v1, |v84|, |v85|
    v_max3_f32 v1, v1, |v86|, |v87|
    v_max3_f32 v1, v1, |v88|, |v89|
    v_max3_f32 v1, v1, |v90|, |v91|
    v_max3_f32 v1, v1, |v92|, |v93|
    v_max3_f32 v1, v1, |v94|, |v95|
    v_max3_f32 v1, v1, |v96|, |v97|
    s_waitcnt vmcnt(6)
    v_mfma_f32_32x32x16_bf16 v[116:131], v[204:207], v[4:7], 0
    v_mfma_f32_32x32x16_bf16 v[116:131], v[208:211], v[8:11], v[116:131]
    v_mfma_f32_32x32x16_bf16 v[116:131], v[4:7], v[204:207], v[116:131]
    v_mfma_f32_32x32x16_bf16 v[116:131], v[8:11], v[208:211], v[116:131]
    v_max3_f32 v1, v1, |v100|, |v101|
    v_max3_f32 v1, v1, |v102|, |v103|
    v_max3_f32 v1, v1, |v104|, |v105|
    v_max3_f32 v1, v1, |v106|, |v107|
    v_max3_f32 v1, v1, |v108|, |v109|
    v_max3_f32 v1, v1, |v110|, |v111|
    v_max3_f32 v1, v1, |v112|, |v113|
    s_waitcnt vmcnt(4)
    v_mfma_f32_32x32x16_bf16 v[132:147], v[212:215], v[4:7], 0
    v_mfma_f32_32x32x16_bf16 v[132:147], v[216:219], v[8:11], v[132:147]
    v_mfma_f32_32x32x16_bf16 v[132:147], v[4:7], v[212:215], v[132:147]
    v_mfma_f32_32x32x16_bf16 v[132:147], v[8:11], v[216:219], v[132:147]
    v_max3_f32 v1, v1, |v116|, |v117|
    v_max3_f32 v1, v1, |v118|, |v119|
    v_max3_f32 v1, v1, |v120|, |v121|
    v_max3_f32 v1, v1, |v122|, |v123|
    v_max3_f32 v1, v1, |v124|, |v125|
    v_max3_f32 v1, v1, |v126|, |v127|
    v_max3_f32 v1, v1, |v128|, |v129|
    s_waitcnt vmcnt(2)
    v_mfma_f32_32x32x16_bf16 v[148:163], v[220:223], v[4:7], 0
    v_mfma_f32_32x32x16_bf16 v[148:163], v[224:227], v[8:11], v[148:163]
    v_mfma_f32_32x32x16_bf16 v[148:163], v[4:7], v[220:223], v[148:163]
    v_mfma_f32_32x32x16_bf16 v[148:163], v[8:11], v[224:227], v[148:163]
    v_max3_f32 v1, v1, |v132|, |v133|
    v_max3_f32 v1, v1, |v134|, |v135|
    v_max3_f32 v1, v1, |v136|, |v137|
    v_max3_f32 v1, v1, |v138|, |v139|
    v_max3_f32 v1, v1, |v140|, |v141|
    v_max3_f32 v1, v1, |v142|, |v143|
    v_max3_f32 v1, v1, |v144|, |v145|
    s_cmp_ge_u32 s71, 15
    s_cbranch_scc1 L_w0d
    s_waitcnt vmcnt(0)
L_w0d:
    v_mfma_f32_32x32x16_bf16 v[164:179], v[228:231], v[4:7], 0
    v_mfma_f32_32x32x16_bf16 v[164:179], v[232:235], v[8:11], v[164:179]
    v_mfma_f32_32x32x16_bf16 v[164:179], v[4:7], v[228:231], v[164:179]
    v_mfma_f32_32x32x16_bf16 v[164:179], v[8:11], v[232:235], v[164:179]
    v_max3_f32 v1, v1, |v148|, |v149|
    v_max3_f32 v1, v1, |v150|, |v151|
    v_max3_f32 v1, v1, |v152|, |v153|
    v_max3_f32 v1, v1, |v154|, |v155|
    v_max3_f32 v1, v1, |v156|, |v157|
    v_max3_f32 v1, v1, |v158|, |v159|
    v_max3_f32 v1, v1, |v160|, |v161|
    s_nop 4
    v_max3_f32 v1, v1, |v164|, |v165|
    v_max3_f32 v1, v1, |v166|, |v167|
    v_max3_f32 v1, v1, |v168|, |v169|
    v_max3_f32 v1, v1, |v170|, |v171|
    v_max3_f32 v1, v1, |v172|, |v173|
    v_max3_f32 v1, v1, |v174|, |v175|
    v_max3_f32 v1, v1, |v176|, |v177|
    s_nop 1
    v_max_u32_dpp v1, v1, v1 row_ror:8 row_mask:0xf bank_mask:0xf
    s_nop 1
    v_max_u32_dpp v1, v1, v1 row_ror:4 row_mask:0xf bank_mask:0xf
    s_nop 1
    v_max_u32_dpp v1, v1, v1 row_ror:2 row_mask:0xf bank_mask:0xf
    s_nop 1
    v_max_u32_dpp v1, v1, v1 row_ror:1 row_mask:0xf bank_mask:0xf
    v_lshrrev_b32 v2, 4, v0
    s_lshl_b32 s72, s3, 4
    s_add_u32 s72, s72, 159744
    v_lshl_add_u32 v2, v2, 2, s72
    ds_write_b32 v2, v1
    v_mov_b32 v255, 160000
    v_mov_b32 v1, 1
    s_mov_b64 exec, 1
    ds_add_u32 v255, v1 offset:84
    s_mov_b64 exec, -1
    s_cmp_lt_u32 s48, 11
    s_cbranch_scc0 L_nc_20
    s_call_b64 s[66:67], L_gsig
L_nc_20:
    s_mov_b32 s72, 1600000
L_lw_21:
    ds_read_b32 v1, v255 offset:84
    s_waitcnt lgkmcnt(0)
    v_readfirstlane_b32 s73, v1
    s_nop 0
    s_cmp_ge_u32 s73, 4
    s_cbranch_scc1 L_ld_22
    s_sleep 1
    s_sub_u32 s72, s72, 1
    s_cbranch_scc0 L_lw_21
L_ld_22:
    v_and_b32 v2, 15, v0
    v_lshlrev_b32 v2, 2, v2
    v_add_u32 v2, 159744, v2
    ds_read_b32 v1, v2
    s_waitcnt lgkmcnt(0)
    v_max_u32_dpp v1, v1, v1 row_ror:8 row_mask:0xf bank_mask:0xf
    s_nop 1
    v_max_u32_dpp v1, v1, v1 row_ror:4 row_mask:0xf bank_mask:0xf
    s_nop 1
    v_max_u32_dpp v1, v1, v1 row_ror:2 row_mask:0xf bank_mask:0xf
    s_nop 1
    v_max_u32_dpp v1, v1, v1 row_ror:1 row_mask:0xf bank_mask:0xf
    v_lshlrev_b32 v3, 4, v0
    v_mov_b32 v236, 0
    ds_write_b32 v3, v236 offset:22892
    v_lshrrev_b32 v1, 23, v1
    v_min_u32 v1, 249, v1
    v_sub_u32 v2, 124, v1
    v_subrev_u32 v1, 124, v1
    ds_write_b32 v3, v1 offset:24432
    v_ldexp_f32 v20, v20, v2
    v_ldexp_f32 v21, v21, v2
    v_ldexp_f32 v22, v22, v2
    v_ldexp_f32 v23, v23, v2
    v_ldexp_f32 v24, v24, v2
    v_ldexp_f32 v25, v25, v2
    v_ldexp_f32 v26, v26, v2
    v_mul_f32 v68, v68, v20
    v_mul_f32 v69, v69, v20
    v_mul_f32 v70, v70, v21
    v_mul_f32 v71, v71, v21
    v_mul_f32 v72, v72, v22
    v_mul_f32 v73, v73, v22
    v_mul_f32 v74, v74, v23
    v_mul_f32 v75, v75, v23
    v_mul_f32 v76, v76, v24
    v_mul_f32 v77, v77, v24
    v_mul_f32 v78, v78, v25
    v_mul_f32 v79, v79, v25
    v_mul_f32 v80, v80, v26
    v_mul_f32 v81, v81, v26
    v_cvt_pk_f16_f32 v236, v68, v69
    v_cvt_pk_f16_f32 v237, v70, v71
    v_cvt_pk_f16_f32 v238, v72, v73
    v_cvt_pk_f16_f32 v239, v74, v75
    v_cvt_pk_f16_f32 v240, v76, v77
    v_cvt_pk_f16_f32 v241, v78, v79
    v_cvt_pk_f16_f32 v242, v80, v81
    v_alignbit_b32 v236, v236, v236, v19
    v_alignbit_b32 v237, v237, v237, v19
    v_alignbit_b32 v238, v238, v238, v19
    v_alignbit_b32 v239, v239, v239, v19
    v_alignbit_b32 v240, v240, v240, v19
    v_alignbit_b32 v241, v241, v241, v19
    v_alignbit_b32 v242, v242, v242, v19
    ds_write_b32 v12, v236 offset:0
    ds_write_b32 v13, v237 offset:0
    ds_write_b32 v14, v238 offset:0
    ds_write_b32 v15, v239 offset:0
    ds_write_b32 v16, v240 offset:0
    ds_write_b32 v17, v241 offset:0
    ds_write_b32 v18, v242 offset:0
    v_mul_f32 v84, v84, v20
    v_mul_f32 v85, v85, v20
    v_mul_f32 v86, v86, v21
    v_mul_f32 v87, v87, v21
    v_mul_f32 v88, v88, v22
    v_mul_f32 v89, v89, v22
    v_mul_f32 v90, v90, v23
    v_mul_f32 v91, v91, v23
    v_mul_f32 v92, v92, v24
    v_mul_f32 v93, v93, v24
    v_mul_f32 v94, v94, v25
    v_mul_f32 v95, v95, v25
    v_mul_f32 v96, v96, v26
    v_mul_f32 v97, v97, v26
    v_cvt_pk_f16_f32 v236, v84, v85
    v_cvt_pk_f16_f32 v237, v86, v87
    v_cvt_pk_f16_f32 v238, v88, v89
    v_cvt_pk_f16_f32 v239, v90, v91
    v_cvt_pk_f16_f32 v240, v92, v93
    v_cvt_pk_f16_f32 v241, v94, v95
    v_cvt_pk_f16_f32 v242, v96, v97
    v_alignbit_b32 v236, v236, v236, v19
    v_alignbit_b32 v237, v237, v237, v19
    v_alignbit_b32 v238, v238, v238, v19
    v_alignbit_b32 v239, v239, v239, v19
    v_alignbit_b32 v240, v240, v240, v19
    v_alignbit_b32 v241, v241, v241, v19
    v_alignbit_b32 v242, v242, v242, v19
    ds_write_b32 v12, v236 offset:64
    ds_write_b32 v13, v237 offset:64
    ds_write_b32 v14, v238 offset:64
    ds_write_b32 v15, v239 offset:64
    ds_write_b32 v16, v240 offset:64
    ds_write_b32 v17, v241 offset:64
    ds_write_b32 v18, v242 offset:64
    v_mul_f32 v100, v100, v20
    v_mul_f32 v101, v101, v20
    v_mul_f32 v102, v102, v21
    v_mul_f32 v103, v103, v21
    v_mul_f32 v104, v104, v22
    v_mul_f32 v105, v105, v22
    v_mul_f32 v106, v106, v23
    v_mul_f32 v107, v107, v23
    v_mul_f32 v108, v108, v24
    v_mul_f32 v109, v109, v24
    v_mul_f32 v110, v110, v25
    v_mul_f32 v111, v111, v25
    v_mul_f32 v112, v112, v26
    v_mul_f32 v113, v113, v26
    v_cvt_pk_f16_f32 v236, v100, v101
    v_cvt_pk_f16_f32 v237, v102, v103
    v_cvt_pk_f16_f32 v238, v104, v105
    v_cvt_pk_f16_f32 v239, v106, v107
    v_cvt_pk_f16_f32 v240, v108, v109
    v_cvt_pk_f16_f32 v241, v110, v111
    v_cvt_pk_f16_f32 v242, v112, v113
    v_alignbit_b32 v236, v236, v236, v19
    v_alignbit_b32 v237, v237, v237, v19
    v_alignbit_b32 v238, v238, v238, v19
    v_alignbit_b32 v239, v239, v239, v19
    v_alignbit_b32 v240, v240, v240, v19
    v_alignbit_b32 v241, v241, v241, v19
    v_alignbit_b32 v242, v242, v242, v19
    ds_write_b32 v12, v236 offset:128
    ds_write_b32 v13, v237 offset:128
    ds_write_b32 v14, v238 offset:128
    ds_write_b32 v15, v239 offset:128
    ds_write_b32 v16, v240 offset:128
    ds_write_b32 v17, v241 offset:128
    ds_write_b32 v18, v242 offset:128
    v_mul_f32 v116, v116, v20
    v_mul_f32 v117, v117, v20
    v_mul_f32 v118, v118, v21
    v_mul_f32 v119, v119, v21
    v_mul_f32 v120, v120, v22
    v_mul_f32 v121, v121, v22
    v_mul_f32 v122, v122, v23
    v_mul_f32 v123, v123, v23
    v_mul_f32 v124, v124, v24
    v_mul_f32 v125, v125, v24
    v_mul_f32 v126, v126, v25
    v_mul_f32 v127, v127, v25
    v_mul_f32 v128, v128, v26
    v_mul_f32 v129, v129, v26
    v_cvt_pk_f16_f32 v236, v116, v117
    v_cvt_pk_f16_f32 v237, v118, v119
    v_cvt_pk_f16_f32 v238, v120, v121
    v_cvt_pk_f16_f32 v239, v122, v123
    v_cvt_pk_f16_f32 v240, v124, v125
    v_cvt_pk_f16_f32 v241, v126, v127
    v_cvt_pk_f16_f32 v242, v128, v129
    v_alignbit_b32 v236, v236, v236, v19
    v_alignbit_b32 v237, v237, v237, v19
    v_alignbit_b32 v238, v238, v238, v19
    v_alignbit_b32 v239, v239, v239, v19
    v_alignbit_b32 v240, v240, v240, v19
    v_alignbit_b32 v241, v241, v241, v19
    v_alignbit_b32 v242, v242, v242, v19
    ds_write_b32 v12, v236 offset:192
    ds_write_b32 v13, v237 offset:192
    ds_write_b32 v14, v238 offset:192
    ds_write_b32 v15, v239 offset:192
    ds_write_b32 v16, v240 offset:192
    ds_write_b32 v17, v241 offset:192
    ds_write_b32 v18, v242 offset:192
    v_mul_f32 v132, v132, v20
    v_mul_f32 v133, v133, v20
    v_mul_f32 v134, v134, v21
    v_mul_f32 v135, v135, v21
    v_mul_f32 v136, v136, v22
    v_mul_f32 v137, v137, v22
    v_mul_f32 v138, v138, v23
    v_mul_f32 v139, v139, v23
    v_mul_f32 v140, v140, v24
    v_mul_f32 v141, v141, v24
    v_mul_f32 v142, v142, v25
    v_mul_f32 v143, v143, v25
    v_mul_f32 v144, v144, v26
    v_mul_f32 v145, v145, v26
    v_cvt_pk_f16_f32 v236, v132, v133
    v_cvt_pk_f16_f32 v237, v134, v135
    v_cvt_pk_f16_f32 v238, v136, v137
    v_cvt_pk_f16_f32 v239, v138, v139
    v_cvt_pk_f16_f32 v240, v140, v141
    v_cvt_pk_f16_f32 v241, v142, v143
    v_cvt_pk_f16_f32 v242, v144, v145
    v_alignbit_b32 v236, v236, v236, v19
    v_alignbit_b32 v237, v237, v237, v19
    v_alignbit_b32 v238, v238, v238, v19
    v_alignbit_b32 v239, v239, v239, v19
    v_alignbit_b32 v240, v240, v240, v19
    v_alignbit_b32 v241, v241, v241, v19
    v_alignbit_b32 v242, v242, v242, v19
    ds_write_b32 v12, v236 offset:256
    ds_write_b32 v13, v237 offset:256
    ds_write_b32 v14, v238 offset:256
    ds_write_b32 v15, v239 offset:256
    ds_write_b32 v16, v240 offset:256
    ds_write_b32 v17, v241 offset:256
    ds_write_b32 v18, v242 offset:256
    v_mul_f32 v148, v148, v20
    v_mul_f32 v149, v149, v20
    v_mul_f32 v150, v150, v21
    v_mul_f32 v151, v151, v21
    v_mul_f32 v152, v152, v22
    v_mul_f32 v153, v153, v22
    v_mul_f32 v154, v154, v23
    v_mul_f32 v155, v155, v23
    v_mul_f32 v156, v156, v24
    v_mul_f32 v157, v157, v24
    v_mul_f32 v158, v158, v25
    v_mul_f32 v159, v159, v25
    v_mul_f32 v160, v160, v26
    v_mul_f32 v161, v161, v26
    v_cvt_pk_f16_f32 v236, v148, v149
    v_cvt_pk_f16_f32 v237, v150, v151
    v_cvt_pk_f16_f32 v238, v152, v153
    v_cvt_pk_f16_f32 v239, v154, v155
    v_cvt_pk_f16_f32 v240, v156, v157
    v_cvt_pk_f16_f32 v241, v158, v159
    v_cvt_pk_f16_f32 v242, v160, v161
    v_alignbit_b32 v236, v236, v236, v19
    v_alignbit_b32 v237, v237, v237, v19
    v_alignbit_b32 v238, v238, v238, v19
    v_alignbit_b32 v239, v239, v239, v19
    v_alignbit_b32 v240, v240, v240, v19
    v_alignbit_b32 v241, v241, v241, v19
    v_alignbit_b32 v242, v242, v242, v19
    ds_write_b32 v12, v236 offset:320
    ds_write_b32 v13, v237 offset:320
    ds_write_b32 v14, v238 offset:320
    ds_write_b32 v15, v239 offset:320
    ds_write_b32 v16, v240 offset:320
    ds_write_b32 v17, v241 offset:320
    ds_write_b32 v18, v242 offset:320
    s_cmp_eq_u32 s3, 1
    s_cselect_b32 s72, 48, 0
    v_add_u32 v12, s72, v12
    v_add_u32 v13, s72, v13
    v_add_u32 v14, s72, v14
    v_add_u32 v15, s72, v15
    v_add_u32 v16, s72, v16
    v_add_u32 v17, s72, v17
    v_add_u32 v18, s72, v18
    v_mul_f32 v164, v164, v20
    v_mul_f32 v165, v165, v20
    v_mul_f32 v166, v166, v21
    v_mul_f32 v167, v167, v21
    v_mul_f32 v168, v168, v22
    v_mul_f32 v169, v169, v22
    v_mul_f32 v170, v170, v23
    v_mul_f32 v171, v171, v23
    v_mul_f32 v172, v172, v24
    v_mul_f32 v173, v173, v24
    v_mul_f32 v174, v174, v25
    v_mul_f32 v175, v175, v25
    v_mul_f32 v176, v176, v26
    v_mul_f32 v177, v177, v26
    v_cvt_pk_f16_f32 v236, v164, v165
    v_cvt_pk_f16_f32 v237, v166, v167
    v_cvt_pk_f16_f32 v238, v168, v169
    v_cvt_pk_f16_f32 v239, v170, v171
    v_cvt_pk_f16_f32 v240, v172, v173
    v_cvt_pk_f16_f32 v241, v174, v175
    v_cvt_pk_f16_f32 v242, v176, v177
    v_alignbit_b32 v236, v236, v236, v19
    v_alignbit_b32 v237, v237, v237, v19
    v_alignbit_b32 v238, v238, v238, v19
    v_alignbit_b32 v239, v239, v239, v19
    v_alignbit_b32 v240, v240, v240, v19
    v_alignbit_b32 v241, v241, v241, v19
    v_alignbit_b32 v242, v242, v242, v19
    ds_write_b32 v12, v236 offset:384
    ds_write_b32 v13, v237 offset:384
    ds_write_b32 v14, v238 offset:384
    ds_write_b32 v15, v239 offset:384
    ds_write_b32 v16, v240 offset:384
    ds_write_b32 v17, v241 offset:384
    ds_write_b32 v18, v242 offset:384
    v_mov_b32 v1, 1
    s_mov_b64 exec, 1
    ds_add_u32 v255, v1 offset:80
    s_mov_b64 exec, -1
    v_cmp_lt_u32 vcc, 25, v254
    v_bfe_u32 v1, v0, 2, 1
    v_cmp_eq_u32 s[72:73], 0, v1
    s_nop 0
    s_and_b64 vcc, vcc, s[72:73]
    v_mov_b32 v2, 1073741824
    v_lshlrev_b32 v250, 4, v0
    v_cndmask_b32 v250, v250, v2, vcc
    s_mul_i32 s64, s71, 7
    s_lshr_b32 s64, s64, 2
    v_lshrrev_b32 v1, 3, v0
    s_lshl_b32 s72, s3, 3
    v_add_u32 v1, s72, v1
    v_mul_u32_u24 v1, 1664, v1
    v_and_b32 v2, 1, v0
    v_lshl_add_u32 v1, v2, 4, v1
    s_and_b32 s72, s3, 1
    s_lshl_b32 s72, s72, 1
    v_bfe_u32 v2, v0, 4, 1
    v_bfe_u32 v3, v0, 1, 2
    v_xor_b32 v2, v2, v3
    v_xor_b32 v2, s72, v2
    v_lshl_add_u32 v3, v2, 5, s82
    v_add_u32 v251, v1, v3
    v_lshrrev_b32 v1, 4, v0
    v_bfe_u32 v2, v0, 2, 2
    v_lshl_add_u32 v1, v1, 3, v2
    v_lshlrev_b32 v1, 7, v1
    v_and_b32 v3, 3, v0
    v_lshl_add_u32 v1, v3, 3, v1
    v_bfe_u32 v2, v0, 3, 2
    v_lshl_add_u32 v1, v2, 5, v1
    v_xor_b32 v1, s69, v1
    v_add_u32 v248, 90112, v1
    s_cmp_lt_u32 s48, 11
    s_cbranch_scc1 L_nc_23
    s_cmp_ge_u32 s48, 31
    s_cbranch_scc1 L_nc_23
    s_call_b64 s[66:67], L_pe1
L_nc_23:
    s_cmp_lt_u32 s48, 11
    s_cbranch_scc1 L_nc_24
    s_call_b64 s[66:67], L_xpub
L_nc_24:
    s_cmp_lt_u32 s48, 11
    s_cbranch_scc1 L_nc_25
    s_cmp_ge_u32 s48, 31
    s_cbranch_scc1 L_nc_25
    s_call_b64 s[66:67], L_pe2
L_nc_25:
    s_waitcnt vmcnt(1)
    s_sub_u32 s72, s48, 11
    s_cmp_lt_u32 s72, 20
    s_cbranch_scc1 L_pwr
    s_waitcnt vmcnt(0)
L_pwr:
    v_mov_b32 v1, 1
    s_mov_b64 exec, 1
    ds_add_u32 v255, v1 offset:0
    s_mov_b64 exec, -1
    s_cmp_lg_u32 s3, 0
    s_cbranch_scc1 L_nosig
    s_mov_b32 s72, 1600000
L_lw_26:
    ds_read_b32 v1, v255 offset:0
    s_waitcnt lgkmcnt(0)
    v_readfirstlane_b32 s73, v1
    s_nop 0
    s_cmp_ge_u32 s73, 4
    s_cbranch_scc1 L_ld_27
    s_sleep 4
    s_sub_u32 s72, s72, 1
    s_cbranch_scc0 L_lw_26
L_ld_27:
    s_mov_b32 s72, 200000
L_rdy:
    v_cmp_ne_u32 vcc, 0, v28
    s_nop 0
    s_and_b32 s73, vcc_lo, 0xffff
    s_cmp_eq_u32 s73, 0xffff
    s_cbranch_scc0 L_rdys
L_rdyd:
    v_mov_b32 v1, 1
    buffer_atomic_add v1, v253, s[12:15], s55 offen sc0 sc1
    buffer_load_dword v197, v253, s[32:35], 0 offen offset:128 sc1
    s_waitcnt vmcnt(0)
    v_readfirstlane_b32 s72, v1
    s_nop 0
    s_cmp_lg_u32 s72, 15
    s_cbranch_scc1 L_nosig
    buffer_store_dword v1, v253, s[12:15], s55 offen offset:256 sc1
L_nosig:
    s_setprio 3
    s_cmp_ge_u32 s71, 15
    s_cbranch_scc1 L_helper_n
    s_setprio 3
    v_xor_b32 v249, 32, v248
    v_xor_b32 v198, 64, v248
    v_xor_b32 v199, 96, v248
    v_lshrrev_b32 v1, 4, v0
    v_lshlrev_b32 v1, 3, v1
    s_xor_b32 s72, s69, 0
    s_add_u32 s72, s72, s82
    buffer_load_dwordx2 v[232:233], v1, s[24:27], s72 offen
    s_xor_b32 s72, s69, 32
    s_add_u32 s72, s72, s82
    buffer_load_dwordx2 v[234:235], v1, s[24:27], s72 offen
    s_xor_b32 s72, s69, 64
    s_add_u32 s72, s72, s82
    buffer_load_dwordx2 v[236:237], v1, s[24:27], s72 offen
    s_xor_b32 s72, s69, 96
    s_add_u32 s72, s72, s82
    buffer_load_dwordx2 v[238:239], v1, s[24:27], s72 offen
    s_waitcnt vmcnt(4)
    v_lshlrev_b32 v4, 16, v60
    v_and_b32 v5, 0xffff0000, v60
    v_lshlrev_b32 v6, 16, v61
    v_and_b32 v7, 0xffff0000, v61
    v_lshlrev_b32 v20, 16, v62
    v_and_b32 v21, 0xffff0000, v62
    v_lshlrev_b32 v22, 16, v63
    v_and_b32 v23, 0xffff0000, v63
    v_lshlrev_b32 v36, 16, v64
    v_and_b32 v37, 0xffff0000, v64
    v_lshlrev_b32 v38, 16, v65
    v_and_b32 v39, 0xffff0000, v65
    v_lshlrev_b32 v52, 16, v66
    v_and_b32 v53, 0xffff0000, v66
    v_lshlrev_b32 v54, 16, v67
    v_and_b32 v55, 0xffff0000, v67
    v_mov_b32 v8, v4
    v_mov_b32 v9, v5
    v_mov_b32 v10, v6
    v_mov_b32 v11, v7
    v_mov_b32 v12, v4
    v_mov_b32 v13, v5
    v_mov_b32 v14, v6
    v_mov_b32 v15, v7
    v_mov_b32 v16, v4
    v_mov_b32 v17, v5
    v_mov_b32 v18, v6
    v_mov_b32 v19, v7
    v_mov_b32 v24, v20
    v_mov_b32 v25, v21
    v_mov_b32 v26, v22
    v_mov_b32 v27, v23
    v_mov_b32 v28, v20
    v_mov_b32 v29, v21
    v_mov_b32 v30, v22
    v_mov_b32 v31, v23
    v_mov_b32 v32, v20
    v_mov_b32 v33, v21
    v_mov_b32 v34, v22
    v_mov_b32 v35, v23
    v_mov_b32 v40, v36
    v_mov_b32 v41, v37
    v_mov_b32 v42, v38
    v_mov_b32 v43, v39
    v_mov_b32 v44, v36
    v_mov_b32 v45, v37
    v_mov_b32 v46, v38
    v_mov_b32 v47, v39
    v_mov_b32 v48, v36
    v_mov_b32 v49, v37
    v_mov_b32 v50, v38
    v_mov_b32 v51, v39
    v_mov_b32 v56, v52
    v_mov_b32 v57, v53
    v_mov_b32 v58, v54
    v_mov_b32 v59, v55
    s_lshl_b32 s61, s70, 2
    s_add_u32 s61, s61, s3
    s_mul_i32 s61, s61, 106624
    s_add_u32 s61, s61, 655488
    s_mov_b32 s72, 1600000
L_lw_28:
    ds_read_b32 v1, v255 offset:120
    s_waitcnt lgkmcnt(0)
    v_readfirstlane_b32 s73, v1
    s_nop 0
    s_cmp_ge_u32 s73, 8
    s_cbranch_scc1 L_ld_29
    s_sleep 1
    s_sub_u32 s72, s72, 1
    s_cbranch_scc0 L_lw_28
L_ld_29:
    s_lshl_b32 s72, s3, 10
    s_add_u32 m0, s72, 90112
    s_add_u32 s73, s64, 0
    s_sub_u32 s65, s73, 26
    s_min_u32 s73, s73, s65
    s_mul_i32 s73, s73, 53248
    buffer_load_dwordx4 v251, s[16:19], s73 offen  lds
    s_add_u32 m0, s72, 94208
    s_add_u32 s73, s64, 1
    s_sub_u32 s65, s73, 26
    s_min_u32 s73, s73, s65
    s_mul_i32 s73, s73, 53248
    buffer_load_dwordx4 v251, s[16:19], s73 offen  lds
    s_add_u32 m0, s72, 98304
    s_add_u32 s73, s64, 2
    s_sub_u32 s65, s73, 26
    s_min_u32 s73, s73, s65
    s_mul_i32 s73, s73, 53248
    buffer_load_dwordx4 v251, s[16:19], s73 offen  lds
    s_add_u32 m0, s72, 102400
    s_add_u32 s73, s64, 3
    s_sub_u32 s65, s73, 26
    s_min_u32 s73, s73, s65
    s_mul_i32 s73, s73, 53248
    buffer_load_dwordx4 v251, s[16:19], s73 offen  lds
    s_add_u32 m0, s72, 106496
    s_add_u32 s73, s64, 4
    s_sub_u32 s65, s73, 26
    s_min_u32 s73, s73, s65
    s_mul_i32 s73, s73, 53248
    buffer_load_dwordx4 v251, s[16:19], s73 offen  lds
    s_add_u32 m0, s72, 110592
    s_add_u32 s73, s64, 5
    s_sub_u32 s65, s73, 26
    s_min_u32 s73, s73, s65
    s_mul_i32 s73, s73, 53248
    buffer_load_dwordx4 v251, s[16:19], s73 offen  lds
    s_add_u32 m0, s72, 114688
    s_add_u32 s73, s64, 6
    s_sub_u32 s65, s73, 26
    s_min_u32 s73, s73, s65
    s_mul_i32 s73, s73, 53248
    buffer_load_dwordx4 v251, s[16:19], s73 offen  lds
    s_add_u32 m0, s72, 118784
    s_add_u32 s73, s64, 7
    s_sub_u32 s65, s73, 26
    s_min_u32 s73, s73, s65
    s_mul_i32 s73, s73, 53248
    buffer_load_dwordx4 v251, s[16:19], s73 offen  lds
    s_add_u32 m0, s72, 122880
    s_add_u32 s73, s64, 8
    s_sub_u32 s65, s73, 26
    s_min_u32 s73, s73, s65
    s_mul_i32 s73, s73, 53248
    buffer_load_dwordx4 v251, s[16:19], s73 offen  lds
    s_add_u32 m0, s72, 126976
    s_add_u32 s73, s64, 9
    s_sub_u32 s65, s73, 26
    s_min_u32 s73, s73, s65
    s_mul_i32 s73, s73, 53248
    buffer_load_dwordx4 v251, s[16:19], s73 offen  lds
    s_cmp_lg_u32 s3, 0
    s_cbranch_scc1 L_p1_30
    s_mov_b32 s72, 200000
    s_branch L_pc_34
L_pt_32:
    buffer_load_dword v197, v253, s[32:35], 0 offen offset:128 sc1
    s_waitcnt vmcnt(0)
L_pc_34:
    v_readfirstlane_b32 s73, v197
    s_nop 0
    s_cmp_lt_u32 s73, 11
    s_cbranch_scc1 L_ps_33
L_pd_31:
    v_mov_b32 v1, 1
    s_mov_b64 exec, 1
    ds_add_u32 v255, v1 offset:68
    s_mov_b64 exec, -1
L_p1_30:
    s_mov_b32 s72, 1600000
L_lw_35:
    ds_read_b32 v1, v255 offset:68
    s_waitcnt lgkmcnt(0)
    v_readfirstlane_b32 s73, v1
    s_nop 0
    s_cmp_ge_u32 s73, 1
    s_cbranch_scc1 L_ld_36
    s_sleep 4
    s_sub_u32 s72, s72, 1
    s_cbranch_scc0 L_lw_35
L_ld_36:
    s_mov_b32 s72, 1600000
L_lw_37:
    ds_read_b32 v1, v255 offset:112
    s_waitcnt lgkmcnt(0)
    v_readfirstlane_b32 s73, v1
    s_nop 0
    s_cmp_ge_u32 s73, 4
    s_cbranch_scc1 L_ld_38
    s_sleep 4
    s_sub_u32 s72, s72, 1
    s_cbranch_scc0 L_lw_37
L_ld_38:
    s_mul_i32 s72, s3, 11264
    s_add_u32 s73, s72, 0
    s_add_u32 m0, s72, 0
    s_nop 0
    buffer_load_dwordx4 v250, s[12:15], s73 offen offset:0 sc1 lds
    buffer_load_dwordx4 v250, s[12:15], s73 offen offset:1024 sc1 lds
    buffer_load_dwordx4 v250, s[12:15], s73 offen offset:2048 sc1 lds
    buffer_load_dwordx4 v250, s[12:15], s73 offen offset:3072 sc1 lds
    s_add_u32 s73, s72, 4096
    s_add_u32 m0, s72, 4096
    s_nop 0
    buffer_load_dwordx4 v250, s[12:15], s73 offen offset:0 sc1 lds
    buffer_load_dwordx4 v250, s[12:15], s73 offen offset:1024 sc1 lds
    buffer_load_dwordx4 v250, s[12:15], s73 offen offset:2048 sc1 lds
    buffer_load_dwordx4 v250, s[12:15], s73 offen offset:3072 sc1 lds
    s_add_u32 s73, s72, 8192
    s_add_u32 m0, s72, 8192
    s_nop 0
    buffer_load_dwordx4 v250, s[12:15], s73 offen offset:0 sc1 lds
    buffer_load_dwordx4 v250, s[12:15], s73 offen offset:1024 sc1 lds
    buffer_load_dwordx4 v250, s[12:15], s73 offen offset:2048 sc1 lds
    buffer_load_dword v196, v253, s[12:15], s55 offen offset:256 sc1
    s_waitcnt vmcnt(0)
    v_mov_b32 v1, 1
    s_mov_b64 exec, 1
    ds_add_u32 v255, v1 offset:16
    ds_add_u32 v255, v1 offset:32
    s_mov_b64 exec, -1
    s_cmp_lg_u32 s3, 0
    s_cbranch_scc1 L_p1_39
    s_mov_b32 s72, 200000
    s_branch L_pc_43
L_pt_41:
    buffer_load_dword v196, v253, s[12:15], s55 offen offset:256 sc1
    s_waitcnt vmcnt(0)
L_pc_43:
    v_readfirstlane_b32 s73, v196
    s_nop 0
    s_cmp_lt_u32 s73, 1
    s_cbranch_scc1 L_ps_42
L_pd_40:
    v_mov_b32 v1, 1
    s_mov_b64 exec, 1
    ds_add_u32 v255, v1 offset:64
    s_mov_b64 exec, -1
L_p1_39:
    s_mov_b32 s72, 1600000
L_lw_44:
    ds_read_b32 v1, v255 offset:64
    s_waitcnt lgkmcnt(0)
    v_readfirstlane_b32 s73, v1
    s_nop 0
    s_cmp_ge_u32 s73, 1
    s_cbranch_scc1 L_ld_45
    s_sleep 4
    s_sub_u32 s72, s72, 1
    s_cbranch_scc0 L_lw_44
L_ld_45:
    s_and_b32 s51, s71, 1
    s_lshl_b32 s72, s51, 11
    v_lshl_add_u32 v2, v0, 4, s72
    v_xor_b32 v3, 0x800, v2
    s_setprio 3
    s_add_u32 s74, s64, 0
    s_sub_u32 s65, s74, 26
    s_min_u32 s74, s74, s65
    s_lshl_b32 s74, s74, 12
    s_add_u32 s74, s74, s61
    buffer_load_dwordx4 v[68:71], v2, s[12:15], s74 offen offset:0 sc1
    buffer_load_dwordx4 v[72:75], v2, s[12:15], s74 offen offset:1024 sc1
    buffer_load_dwordx4 v[76:79], v3, s[12:15], s74 offen offset:0 sc1
    buffer_load_dwordx4 v[80:83], v3, s[12:15], s74 offen offset:1024 sc1
    s_add_u32 s74, s64, 1
    s_sub_u32 s65, s74, 26
    s_min_u32 s74, s74, s65
    s_lshl_b32 s74, s74, 12
    s_add_u32 s74, s74, s61
    buffer_load_dwordx4 v[84:87], v2, s[12:15], s74 offen offset:0 sc1
    buffer_load_dwordx4 v[88:91], v2, s[12:15], s74 offen offset:1024 sc1
    buffer_load_dwordx4 v[92:95], v3, s[12:15], s74 offen offset:0 sc1
    buffer_load_dwordx4 v[96:99], v3, s[12:15], s74 offen offset:1024 sc1
    s_add_u32 s74, s64, 2
    s_sub_u32 s65, s74, 26
    s_min_u32 s74, s74, s65
    s_lshl_b32 s74, s74, 12
    s_add_u32 s74, s74, s61
    buffer_load_dwordx4 v[100:103], v2, s[12:15], s74 offen offset:0 sc1
    buffer_load_dwordx4 v[104:107], v2, s[12:15], s74 offen offset:1024 sc1
    buffer_load_dwordx4 v[108:111], v3, s[12:15], s74 offen offset:0 sc1
    buffer_load_dwordx4 v[112:115], v3, s[12:15], s74 offen offset:1024 sc1
    s_mov_b32 s72, 1600000
L_lw_46:
    ds_read_b32 v1, v255 offset:32
    s_waitcnt lgkmcnt(0)
    v_readfirstlane_b32 s73, v1
    s_nop 0
    s_cmp_ge_u32 s73, 4
    s_cbranch_scc1 L_ld_47
    s_sleep 1
    s_sub_u32 s72, s72, 1
    s_cbranch_scc0 L_lw_46
L_ld_47:
    ds_read_b64_tr_b16 v[208:209], v248 offset:0
    ds_read_b64_tr_b16 v[210:211], v248 offset:512
    ds_read_b64_tr_b16 v[212:213], v249 offset:0
    ds_read_b64_tr_b16 v[214:215], v249 offset:512
    ds_read_b64_tr_b16 v[216:217], v198 offset:0
    ds_read_b64_tr_b16 v[218:219], v198 offset:512
    ds_read_b64_tr_b16 v[220:221], v199 offset:0
    ds_read_b64_tr_b16 v[222:223], v199 offset:512
    s_waitcnt vmcnt(8)
    s_waitcnt lgkmcnt(4)
    v_mfma_f32_16x16x32_bf16 v[4:7], v[208:211], v[68:71], v[4:7]
    s_add_u32 s74, s64, 3
    s_sub_u32 s65, s74, 26
    v_mfma_f32_16x16x32_bf16 v[8:11], v[208:211], v[72:75], v[8:11]
    ds_read_b64_tr_b16 v[224:225], v248 offset:4096
    s_min_u32 s74, s74, s65
    v_mfma_f32_16x16x32_bf16 v[12:15], v[208:211], v[76:79], v[12:15]
    ds_read_b64_tr_b16 v[226:227], v248 offset:4608
    s_lshl_b32 s74, s74, 12
    v_mfma_f32_16x16x32_bf16 v[16:19], v[208:211], v[80:83], v[16:19]
    ds_read_b64_tr_b16 v[228:229], v249 offset:4096
    s_add_u32 s74, s74, s61
    v_mfma_f32_16x16x32_bf16 v[20:23], v[212:215], v[68:71], v[20:23]
    ds_read_b64_tr_b16 v[230:231], v249 offset:4608
    buffer_load_dwordx4 v[116:119], v2, s[12:15], s74 offen offset:0 sc1
    v_mfma_f32_16x16x32_bf16 v[24:27], v[212:215], v[72:75], v[24:27]
    buffer_load_dwordx4 v[120:123], v2, s[12:15], s74 offen offset:1024 sc1
    buffer_load_dwordx4 v[124:127], v3, s[12:15], s74 offen offset:0 sc1
    v_mfma_f32_16x16x32_bf16 v[28:31], v[212:215], v[76:79], v[28:31]
    buffer_load_dwordx4 v[128:131], v3, s[12:15], s74 offen offset:1024 sc1
    s_add_u32 s74, s64, 4
    v_mfma_f32_16x16x32_bf16 v[32:35], v[212:215], v[80:83], v[32:35]
    s_sub_u32 s65, s74, 26
    s_min_u32 s74, s74, s65
    s_waitcnt lgkmcnt(4)
    v_mfma_f32_16x16x32_bf16 v[36:39], v[216:219], v[68:71], v[36:39]
    s_lshl_b32 s74, s74, 12
    s_add_u32 s74, s74, s61
    v_mfma_f32_16x16x32_bf16 v[40:43], v[216:219], v[72:75], v[40:43]
    ds_read_b64_tr_b16 v[208:209], v198 offset:4096
    buffer_load_dwordx4 v[132:135], v2, s[12:15], s74 offen offset:0 sc1
    v_mfma_f32_16x16x32_bf16 v[44:47], v[216:219], v[76:79], v[44:47]
    ds_read_b64_tr_b16 v[210:211], v198 offset:4608
    buffer_load_dwordx4 v[136:139], v2, s[12:15], s74 offen offset:1024 sc1
    v_mfma_f32_16x16x32_bf16 v[48:51], v[216:219], v[80:83], v[48:51]
    ds_read_b64_tr_b16 v[212:213], v199 offset:4096
    buffer_load_dwordx4 v[140:143], v3, s[12:15], s74 offen offset:0 sc1
    v_mfma_f32_16x16x32_bf16 v[52:55], v[220:223], v[68:71], v[52:55]
    ds_read_b64_tr_b16 v[214:215], v199 offset:4608
    buffer_load_dwordx4 v[144:147], v3, s[12:15], s74 offen offset:1024 sc1
    v_mfma_f32_16x16x32_bf16 v[56:59], v[220:223], v[72:75], v[56:59]
    s_waitcnt vmcnt(12)
    s_waitcnt lgkmcnt(4)
    v_mfma_f32_16x16x32_bf16 v[4:7], v[224:227], v[84:87], v[4:7]
    s_add_u32 s74, s64, 5
    s_sub_u32 s65, s74, 26
    v_mfma_f32_16x16x32_bf16 v[8:11], v[224:227], v[88:91], v[8:11]
    ds_read_b64_tr_b16 v[216:217], v248 offset:8192
    s_min_u32 s74, s74, s65
    v_mfma_f32_16x16x32_bf16 v[12:15], v[224:227], v[92:95], v[12:15]
    ds_read_b64_tr_b16 v[218:219], v248 offset:8704
    s_lshl_b32 s74, s74, 12
    v_mfma_f32_16x16x32_bf16 v[16:19], v[224:227], v[96:99], v[16:19]
    ds_read_b64_tr_b16 v[220:221], v249 offset:8192
    s_add_u32 s74, s74, s61
    v_mfma_f32_16x16x32_bf16 v[20:23], v[228:231], v[84:87], v[20:23]
    ds_read_b64_tr_b16 v[222:223], v249 offset:8704
    buffer_load_dwordx4 v[148:151], v2, s[12:15], s74 offen offset:0 sc1
    v_mfma_f32_16x16x32_bf16 v[24:27], v[228:231], v[88:91], v[24:27]
    buffer_load_dwordx4 v[152:155], v2, s[12:15], s74 offen offset:1024 sc1
    buffer_load_dwordx4 v[156:159], v3, s[12:15], s74 offen offset:0 sc1
    v_mfma_f32_16x16x32_bf16 v[28:31], v[228:231], v[92:95], v[28:31]
    buffer_load_dwordx4 v[160:163], v3, s[12:15], s74 offen offset:1024 sc1
    s_add_u32 s74, s64, 6
    v_mfma_f32_16x16x32_bf16 v[32:35], v[228:231], v[96:99], v[32:35]
    s_sub_u32 s65, s74, 26
    s_min_u32 s74, s74, s65
    s_waitcnt lgkmcnt(4)
    v_mfma_f32_16x16x32_bf16 v[36:39], v[208:211], v[84:87], v[36:39]
    s_lshl_b32 s74, s74, 12
    s_add_u32 s74, s74, s61
    v_mfma_f32_16x16x32_bf16 v[40:43], v[208:211], v[88:91], v[40:43]
    ds_read_b64_tr_b16 v[224:225], v198 offset:8192
    buffer_load_dwordx4 v[68:71], v2, s[12:15], s74 offen offset:0 sc1
    v_mfma_f32_16x16x32_bf16 v[44:47], v[208:211], v[92:95], v[44:47]
    ds_read_b64_tr_b16 v[226:227], v198 offset:8704
    buffer_load_dwordx4 v[72:75], v2, s[12:15], s74 offen offset:1024 sc1
    v_mfma_f32_16x16x32_bf16 v[48:51], v[208:211], v[96:99], v[48:51]
    ds_read_b64_tr_b16 v[228:229], v199 offset:8192
    buffer_load_dwordx4 v[76:79], v3, s[12:15], s74 offen offset:0 sc1
    v_mfma_f32_16x16x32_bf16 v[52:55], v[212:215], v[84:87], v[52:55]
    ds_read_b64_tr_b16 v[230:231], v199 offset:8704
    buffer_load_dwordx4 v[80:83], v3, s[12:15], s74 offen offset:1024 sc1
    v_mfma_f32_16x16x32_bf16 v[56:59], v[212:215], v[88:91], v[56:59]
    s_lshl_b32 s72, s3, 10
    s_add_u32 m0, s72, 131072
    s_add_u32 s73, s64, 10
    s_sub_u32 s65, s73, 26
    s_min_u32 s73, s73, s65
    s_mul_i32 s73, s73, 53248
    buffer_load_dwordx4 v251, s[16:19], s73 offen  lds
    s_waitcnt vmcnt(17)
    s_waitcnt lgkmcnt(4)
    v_mfma_f32_16x16x32_bf16 v[4:7], v[216:219], v[100:103], v[4:7]
    s_add_u32 s74, s64, 7
    s_sub_u32 s65, s74, 26
    v_mfma_f32_16x16x32_bf16 v[8:11], v[216:219], v[104:107], v[8:11]
    ds_read_b64_tr_b16 v[208:209], v248 offset:12288
    s_min_u32 s74, s74, s65
    v_mfma_f32_16x16x32_bf16 v[12:15], v[216:219], v[108:111], v[12:15]
    ds_read_b64_tr_b16 v[210:211], v248 offset:12800
    s_lshl_b32 s74, s74, 12
    v_mfma_f32_16x16x32_bf16 v[16:19], v[216:219], v[112:115], v[16:19]
    ds_read_b64_tr_b16 v[212:213], v249 offset:12288
    s_add_u32 s74, s74, s61
    v_mfma_f32_16x16x32_bf16 v[20:23], v[220:223], v[100:103], v[20:23]
    ds_read_b64_tr_b16 v[214:215], v249 offset:12800
    buffer_load_dwordx4 v[84:87], v2, s[12:15], s74 offen offset:0 sc1
    v_mfma_f32_16x16x32_bf16 v[24:27], v[220:223], v[104:107], v[24:27]
    buffer_load_dwordx4 v[88:91], v2, s[12:15], s74 offen offset:1024 sc1
    buffer_load_dwordx4 v[92:95], v3, s[12:15], s74 offen offset:0 sc1
    v_mfma_f32_16x16x32_bf16 v[28:31], v[220:223], v[108:111], v[28:31]
    buffer_load_dwordx4 v[96:99], v3, s[12:15], s74 offen offset:1024 sc1
    s_lshl_b32 s72, s3, 10
    v_mfma_f32_16x16x32_bf16 v[32:35], v[220:223], v[112:115], v[32:35]
    s_add_u32 m0, s72, 135168
    s_add_u32 s73, s64, 11
    s_waitcnt lgkmcnt(4)
    v_mfma_f32_16x16x32_bf16 v[36:39], v[224:227], v[100:103], v[36:39]
    s_sub_u32 s65, s73, 26
    s_min_u32 s73, s73, s65
    v_mfma_f32_16x16x32_bf16 v[40:43], v[224:227], v[104:107], v[40:43]
    ds_read_b64_tr_b16 v[216:217], v198 offset:12288
    s_mul_i32 s73, s73, 53248
    v_mfma_f32_16x16x32_bf16 v[44:47], v[224:227], v[108:111], v[44:47]
    ds_read_b64_tr_b16 v[218:219], v198 offset:12800
    buffer_load_dwordx4 v251, s[16:19], s73 offen  lds
    v_mfma_f32_16x16x32_bf16 v[48:51], v[224:227], v[112:115], v[48:51]
    ds_read_b64_tr_b16 v[220:221], v199 offset:12288
    v_mfma_f32_16x16x32_bf16 v[52:55], v[228:231], v[100:103], v[52:55]
    ds_read_b64_tr_b16 v[222:223], v199 offset:12800
    v_mfma_f32_16x16x32_bf16 v[56:59], v[228:231], v[104:107], v[56:59]
    s_waitcnt vmcnt(18)
    s_waitcnt lgkmcnt(4)
    v_mfma_f32_16x16x32_bf16 v[4:7], v[208:211], v[116:119], v[4:7]
    s_add_u32 s74, s64, 8
    s_sub_u32 s65, s74, 26
    v_mfma_f32_16x16x32_bf16 v[8:11], v[208:211], v[120:123], v[8:11]
    ds_read_b64_tr_b16 v[224:225], v248 offset:16384
    s_min_u32 s74, s74, s65
    v_mfma_f32_16x16x32_bf16 v[12:15], v[208:211], v[124:127], v[12:15]
    ds_read_b64_tr_b16 v[226:227], v248 offset:16896
    s_lshl_b32 s74, s74, 12
    v_mfma_f32_16x16x32_bf16 v[16:19], v[208:211], v[128:131], v[16:19]
    ds_read_b64_tr_b16 v[228:229], v249 offset:16384
    s_add_u32 s74, s74, s61
    v_mfma_f32_16x16x32_bf16 v[20:23], v[212:215], v[116:119], v[20:23]
    ds_read_b64_tr_b16 v[230:231], v249 offset:16896
    buffer_load_dwordx4 v[100:103], v2, s[12:15], s74 offen offset:0 sc1
    v_mfma_f32_16x16x32_bf16 v[24:27], v[212:215], v[120:123], v[24:27]
    buffer_load_dwordx4 v[104:107], v2, s[12:15], s74 offen offset:1024 sc1
    buffer_load_dwordx4 v[108:111], v3, s[12:15], s74 offen offset:0 sc1
    v_mfma_f32_16x16x32_bf16 v[28:31], v[212:215], v[124:127], v[28:31]
    buffer_load_dwordx4 v[112:115], v3, s[12:15], s74 offen offset:1024 sc1
    s_lshl_b32 s72, s3, 10
    v_mfma_f32_16x16x32_bf16 v[32:35], v[212:215], v[128:131], v[32:35]
    s_add_u32 m0, s72, 139264
    s_add_u32 s73, s64, 12
    s_waitcnt lgkmcnt(4)
    v_mfma_f32_16x16x32_bf16 v[36:39], v[216:219], v[116:119], v[36:39]
    s_sub_u32 s65, s73, 26
    s_min_u32 s73, s73, s65
    v_mfma_f32_16x16x32_bf16 v[40:43], v[216:219], v[120:123], v[40:43]
    ds_read_b64_tr_b16 v[208:209], v198 offset:16384
    s_mul_i32 s73, s73, 53248
    v_mfma_f32_16x16x32_bf16 v[44:47], v[216:219], v[124:127], v[44:47]
    ds_read_b64_tr_b16 v[210:211], v198 offset:16896
    buffer_load_dwordx4 v251, s[16:19], s73 offen  lds
    v_mfma_f32_16x16x32_bf16 v[48:51], v[216:219], v[128:131], v[48:51]
    ds_read_b64_tr_b16 v[212:213], v199 offset:16384
    v_mfma_f32_16x16x32_bf16 v[52:55], v[220:223], v[116:119], v[52:55]
    ds_read_b64_tr_b16 v[214:215], v199 offset:16896
    v_mfma_f32_16x16x32_bf16 v[56:59], v[220:223], v[120:123], v[56:59]
    s_waitcnt vmcnt(19)
    s_waitcnt lgkmcnt(4)
    v_mfma_f32_16x16x32_bf16 v[4:7], v[224:227], v[132:135], v[4:7]
    s_add_u32 s74, s64, 9
    s_sub_u32 s65, s74, 26
    v_mfma_f32_16x16x32_bf16 v[8:11], v[224:227], v[136:139], v[8:11]
    ds_read_b64_tr_b16 v[216:217], v248 offset:20480
    s_min_u32 s74, s74, s65
    v_mfma_f32_16x16x32_bf16 v[12:15], v[224:227], v[140:143], v[12:15]
    ds_read_b64_tr_b16 v[218:219], v248 offset:20992
    s_lshl_b32 s74, s74, 12
    v_mfma_f32_16x16x32_bf16 v[16:19], v[224:227], v[144:147], v[16:19]
    ds_read_b64_tr_b16 v[220:221], v249 offset:20480
    s_add_u32 s74, s74, s61
    v_mfma_f32_16x16x32_bf16 v[20:23], v[228:231], v[132:135], v[20:23]
    ds_read_b64_tr_b16 v[222:223], v249 offset:20992
    buffer_load_dwordx4 v[116:119], v2, s[12:15], s74 offen offset:0 sc1
    v_mfma_f32_16x16x32_bf16 v[24:27], v[228:231], v[136:139], v[24:27]
    buffer_load_dwordx4 v[120:123], v2, s[12:15], s74 offen offset:1024 sc1
    buffer_load_dwordx4 v[124:127], v3, s[12:15], s74 offen offset:0 sc1
    v_mfma_f32_16x16x32_bf16 v[28:31], v[228:231], v[140:143], v[28:31]
    buffer_load_dwordx4 v[128:131], v3, s[12:15], s74 offen offset:1024 sc1
    s_lshl_b32 s72, s3, 10
    v_mfma_f32_16x16x32_bf16 v[32:35], v[228:231], v[144:147], v[32:35]
    s_add_u32 m0, s72, 143360
    s_add_u32 s73, s64, 13
    s_waitcnt lgkmcnt(4)
    v_mfma_f32_16x16x32_bf16 v[36:39], v[208:211], v[132:135], v[36:39]
    s_sub_u32 s65, s73, 26
    s_min_u32 s73, s73, s65
    v_mfma_f32_16x16x32_bf16 v[40:43], v[208:211], v[136:139], v[40:43]
    ds_read_b64_tr_b16 v[224:225], v198 offset:20480
    s_mul_i32 s73, s73, 53248
    v_mfma_f32_16x16x32_bf16 v[44:47], v[208:211], v[140:143], v[44:47]
    ds_read_b64_tr_b16 v[226:227], v198 offset:20992
    buffer_load_dwordx4 v251, s[16:19], s73 offen  lds
    v_mfma_f32_16x16x32_bf16 v[48:51], v[208:211], v[144:147], v[48:51]
    ds_read_b64_tr_b16 v[228:229], v199 offset:20480
    v_mfma_f32_16x16x32_bf16 v[52:55], v[212:215], v[132:135], v[52:55]
    ds_read_b64_tr_b16 v[230:231], v199 offset:20992
    v_mfma_f32_16x16x32_bf16 v[56:59], v[212:215], v[136:139], v[56:59]
    s_waitcnt vmcnt(20)
    s_waitcnt lgkmcnt(4)
    v_mfma_f32_16x16x32_bf16 v[4:7], v[216:219], v[148:151], v[4:7]
    s_add_u32 s74, s64, 10
    s_sub_u32 s65, s74, 26
    v_mfma_f32_16x16x32_bf16 v[8:11], v[216:219], v[152:155], v[8:11]
    ds_read_b64_tr_b16 v[208:209], v248 offset:24576
    s_min_u32 s74, s74, s65
    v_mfma_f32_16x16x32_bf16 v[12:15], v[216:219], v[156:159], v[12:15]
    ds_read_b64_tr_b16 v[210:211], v248 offset:25088
    s_lshl_b32 s74, s74, 12
    v_mfma_f32_16x16x32_bf16 v[16:19], v[216:219], v[160:163], v[16:19]
    ds_read_b64_tr_b16 v[212:213], v249 offset:24576
    s_add_u32 s74, s74, s61
    v_mfma_f32_16x16x32_bf16 v[20:23], v[220:223], v[148:151], v[20:23]
    ds_read_b64_tr_b16 v[214:215], v249 offset:25088
    buffer_load_dwordx4 v[132:135], v2, s[12:15], s74 offen offset:0 sc1
    v_mfma_f32_16x16x32_bf16 v[24:27], v[220:223], v[152:155], v[24:27]
    buffer_load_dwordx4 v[136:139], v2, s[12:15], s74 offen offset:1024 sc1
    buffer_load_dwordx4 v[140:143], v3, s[12:15], s74 offen offset:0 sc1
    v_mfma_f32_16x16x32_bf16 v[28:31], v[220:223], v[156:159], v[28:31]
    buffer_load_dwordx4 v[144:147], v3, s[12:15], s74 offen offset:1024 sc1
    s_lshl_b32 s72, s3, 10
    v_mfma_f32_16x16x32_bf16 v[32:35], v[220:223], v[160:163], v[32:35]
    s_add_u32 m0, s72, 147456
    s_add_u32 s73, s64, 14
    s_waitcnt lgkmcnt(4)
    v_mfma_f32_16x16x32_bf16 v[36:39], v[224:227], v[148:151], v[36:39]
    s_sub_u32 s65, s73, 26
    s_min_u32 s73, s73, s65
    v_mfma_f32_16x16x32_bf16 v[40:43], v[224:227], v[152:155], v[40:43]
    ds_read_b64_tr_b16 v[216:217], v198 offset:24576
    s_mul_i32 s73, s73, 53248
    v_mfma_f32_16x16x32_bf16 v[44:47], v[224:227], v[156:159], v[44:47]
    ds_read_b64_tr_b16 v[218:219], v198 offset:25088
    buffer_load_dwordx4 v251, s[16:19], s73 offen  lds
    v_mfma_f32_16x16x32_bf16 v[48:51], v[224:227], v[160:163], v[48:51]
    ds_read_b64_tr_b16 v[220:221], v199 offset:24576
    v_mfma_f32_16x16x32_bf16 v[52:55], v[228:231], v[148:151], v[52:55]
    ds_read_b64_tr_b16 v[222:223], v199 offset:25088
    v_mfma_f32_16x16x32_bf16 v[56:59], v[228:231], v[152:155], v[56:59]
    s_waitcnt vmcnt(21)
    s_waitcnt lgkmcnt(4)
    v_mfma_f32_16x16x32_bf16 v[4:7], v[208:211], v[68:71], v[4:7]
    s_add_u32 s74, s64, 11
    s_sub_u32 s65, s74, 26
    v_mfma_f32_16x16x32_bf16 v[8:11], v[208:211], v[72:75], v[8:11]
    ds_read_b64_tr_b16 v[224:225], v248 offset:28672
    s_min_u32 s74, s74, s65
    v_mfma_f32_16x16x32_bf16 v[12:15], v[208:211], v[76:79], v[12:15]
    ds_read_b64_tr_b16 v[226:227], v248 offset:29184
    s_lshl_b32 s74, s74, 12
    v_mfma_f32_16x16x32_bf16 v[16:19], v[208:211], v[80:83], v[16:19]
    ds_read_b64_tr_b16 v[228:229], v249 offset:28672
    s_add_u32 s74, s74, s61
    v_mfma_f32_16x16x32_bf16 v[20:23], v[212:215], v[68:71], v[20:23]
    ds_read_b64_tr_b16 v[230:231], v249 offset:29184
    buffer_load_dwordx4 v[148:151], v2, s[12:15], s74 offen offset:0 sc1
    v_mfma_f32_16x16x32_bf16 v[24:27], v[212:215], v[72:75], v[24:27]
    buffer_load_dwordx4 v[152:155], v2, s[12:15], s74 offen offset:1024 sc1
    buffer_load_dwordx4 v[156:159], v3, s[12:15], s74 offen offset:0 sc1
    v_mfma_f32_16x16x32_bf16 v[28:31], v[212:215], v[76:79], v[28:31]
    buffer_load_dwordx4 v[160:163], v3, s[12:15], s74 offen offset:1024 sc1
    s_lshl_b32 s72, s3, 10
    v_mfma_f32_16x16x32_bf16 v[32:35], v[212:215], v[80:83], v[32:35]
    s_add_u32 m0, s72, 151552
    s_add_u32 s73, s64, 15
    s_waitcnt lgkmcnt(4)
    v_mfma_f32_16x16x32_bf16 v[36:39], v[216:219], v[68:71], v[36:39]
    s_sub_u32 s65, s73, 26
    s_min_u32 s73, s73, s65
    v_mfma_f32_16x16x32_bf16 v[40:43], v[216:219], v[72:75], v[40:43]
    ds_read_b64_tr_b16 v[208:209], v198 offset:28672
    s_mul_i32 s73, s73, 53248
    v_mfma_f32_16x16x32_bf16 v[44:47], v[216:219], v[76:79], v[44:47]
    ds_read_b64_tr_b16 v[210:211], v198 offset:29184
    buffer_load_dwordx4 v251, s[16:19], s73 offen  lds
    v_mfma_f32_16x16x32_bf16 v[48:51], v[216:219], v[80:83], v[48:51]
    ds_read_b64_tr_b16 v[212:213], v199 offset:28672
    v_mfma_f32_16x16x32_bf16 v[52:55], v[220:223], v[68:71], v[52:55]
    ds_read_b64_tr_b16 v[214:215], v199 offset:29184
    v_mfma_f32_16x16x32_bf16 v[56:59], v[220:223], v[72:75], v[56:59]
    s_waitcnt vmcnt(21)
    s_waitcnt lgkmcnt(4)
    v_mfma_f32_16x16x32_bf16 v[4:7], v[224:227], v[84:87], v[4:7]
    s_add_u32 s74, s64, 12
    s_sub_u32 s65, s74, 26
    v_mfma_f32_16x16x32_bf16 v[8:11], v[224:227], v[88:91], v[8:11]
    ds_read_b64_tr_b16 v[216:217], v248 offset:32768
    s_min_u32 s74, s74, s65
    v_mfma_f32_16x16x32_bf16 v[12:15], v[224:227], v[92:95], v[12:15]
    ds_read_b64_tr_b16 v[218:219], v248 offset:33280
    s_lshl_b32 s74, s74, 12
    v_mfma_f32_16x16x32_bf16 v[16:19], v[224:227], v[96:99], v[16:19]
    ds_read_b64_tr_b16 v[220:221], v249 offset:32768
    s_add_u32 s74, s74, s61
    v_mfma_f32_16x16x32_bf16 v[20:23], v[228:231], v[84:87], v[20:23]
    ds_read_b64_tr_b16 v[222:223], v249 offset:33280
    buffer_load_dwordx4 v[68:71], v2, s[12:15], s74 offen offset:0 sc1
    v_mfma_f32_16x16x32_bf16 v[24:27], v[228:231], v[88:91], v[24:27]
    buffer_load_dwordx4 v[72:75], v2, s[12:15], s74 offen offset:1024 sc1
    buffer_load_dwordx4 v[76:79], v3, s[12:15], s74 offen offset:0 sc1
    v_mfma_f32_16x16x32_bf16 v[28:31], v[228:231], v[92:95], v[28:31]
    buffer_load_dwordx4 v[80:83], v3, s[12:15], s74 offen offset:1024 sc1
    v_mfma_f32_16x16x32_bf16 v[32:35], v[228:231], v[96:99], v[32:35]
    s_waitcnt lgkmcnt(4)
    v_mfma_f32_16x16x32_bf16 v[36:39], v[208:211], v[84:87], v[36:39]
    v_mfma_f32_16x16x32_bf16 v[40:43], v[208:211], v[88:91], v[40:43]
    ds_read_b64_tr_b16 v[224:225], v198 offset:32768
    v_mfma_f32_16x16x32_bf16 v[44:47], v[208:211], v[92:95], v[44:47]
    ds_read_b64_tr_b16 v[226:227], v198 offset:33280
    v_mfma_f32_16x16x32_bf16 v[48:51], v[208:211], v[96:99], v[48:51]
    ds_read_b64_tr_b16 v[228:229], v199 offset:32768
    v_mfma_f32_16x16x32_bf16 v[52:55], v[212:215], v[84:87], v[52:55]
    ds_read_b64_tr_b16 v[230:231], v199 offset:33280
    v_mfma_f32_16x16x32_bf16 v[56:59], v[212:215], v[88:91], v[56:59]
    s_waitcnt vmcnt(20)
    s_waitcnt lgkmcnt(4)
    v_mfma_f32_16x16x32_bf16 v[4:7], v[216:219], v[100:103], v[4:7]
    s_add_u32 s74, s64, 13
    s_sub_u32 s65, s74, 26
    v_mfma_f32_16x16x32_bf16 v[8:11], v[216:219], v[104:107], v[8:11]
    ds_read_b64_tr_b16 v[208:209], v248 offset:36864
    s_min_u32 s74, s74, s65
    v_mfma_f32_16x16x32_bf16 v[12:15], v[216:219], v[108:111], v[12:15]
    ds_read_b64_tr_b16 v[210:211], v248 offset:37376
    s_lshl_b32 s74, s74, 12
    v_mfma_f32_16x16x32_bf16 v[16:19], v[216:219], v[112:115], v[16:19]
    ds_read_b64_tr_b16 v[212:213], v249 offset:36864
    s_add_u32 s74, s74, s61
    v_mfma_f32_16x16x32_bf16 v[20:23], v[220:223], v[100:103], v[20:23]
    ds_read_b64_tr_b16 v[214:215], v249 offset:37376
    buffer_load_dwordx4 v[84:87], v2, s[12:15], s74 offen offset:0 sc1
    v_mfma_f32_16x16x32_bf16 v[24:27], v[220:223], v[104:107], v[24:27]
    buffer_load_dwordx4 v[88:91], v2, s[12:15], s74 offen offset:1024 sc1
    buffer_load_dwordx4 v[92:95], v3, s[12:15], s74 offen offset:0 sc1
    v_mfma_f32_16x16x32_bf16 v[28:31], v[220:223], v[108:111], v[28:31]
    buffer_load_dwordx4 v[96:99], v3, s[12:15], s74 offen offset:1024 sc1
    v_mfma_f32_16x16x32_bf16 v[32:35], v[220:223], v[112:115], v[32:35]
    s_waitcnt lgkmcnt(4)
    v_mfma_f32_16x16x32_bf16 v[36:39], v[224:227], v[100:103], v[36:39]
    v_mfma_f32_16x16x32_bf16 v[40:43], v[224:227], v[104:107], v[40:43]
    ds_read_b64_tr_b16 v[216:217], v198 offset:36864
    v_mfma_f32_16x16x32_bf16 v[44:47], v[224:227], v[108:111], v[44:47]
    ds_read_b64_tr_b16 v[218:219], v198 offset:37376
    v_mfma_f32_16x16x32_bf16 v[48:51], v[224:227], v[112:115], v[48:51]
    ds_read_b64_tr_b16 v[220:221], v199 offset:36864
    v_mfma_f32_16x16x32_bf16 v[52:55], v[228:231], v[100:103], v[52:55]
    ds_read_b64_tr_b16 v[222:223], v199 offset:37376
    v_mfma_f32_16x16x32_bf16 v[56:59], v[228:231], v[104:107], v[56:59]
    buffer_load_dword v196, v253, s[12:15], s55 offen offset:512 sc1
    s_waitcnt vmcnt(19)
    s_waitcnt lgkmcnt(4)
    v_mfma_f32_16x16x32_bf16 v[4:7], v[208:211], v[116:119], v[4:7]
    s_add_u32 s74, s64, 14
    s_sub_u32 s65, s74, 26
    v_mfma_f32_16x16x32_bf16 v[8:11], v[208:211], v[120:123], v[8:11]
    s_min_u32 s74, s74, s65
    s_lshl_b32 s74, s74, 12
    v_mfma_f32_16x16x32_bf16 v[12:15], v[208:211], v[124:127], v[12:15]
    s_add_u32 s74, s74, s61
    buffer_load_dwordx4 v[100:103], v2, s[12:15], s74 offen offset:0 sc1
    v_mfma_f32_16x16x32_bf16 v[16:19], v[208:211], v[128:131], v[16:19]
    buffer_load_dwordx4 v[104:107], v2, s[12:15], s74 offen offset:1024 sc1
    buffer_load_dwordx4 v[108:111], v3, s[12:15], s74 offen offset:0 sc1
    v_mfma_f32_16x16x32_bf16 v[20:23], v[212:215], v[116:119], v[20:23]
    buffer_load_dwordx4 v[112:115], v3, s[12:15], s74 offen offset:1024 sc1
    v_mfma_f32_16x16x32_bf16 v[24:27], v[212:215], v[120:123], v[24:27]
    v_mfma_f32_16x16x32_bf16 v[28:31], v[212:215], v[124:127], v[28:31]
    v_mfma_f32_16x16x32_bf16 v[32:35], v[212:215], v[128:131], v[32:35]
    s_waitcnt lgkmcnt(0)
    v_mfma_f32_16x16x32_bf16 v[36:39], v[216:219], v[116:119], v[36:39]
    v_mfma_f32_16x16x32_bf16 v[40:43], v[216:219], v[120:123], v[40:43]
    v_mfma_f32_16x16x32_bf16 v[44:47], v[216:219], v[124:127], v[44:47]
    v_mfma_f32_16x16x32_bf16 v[48:51], v[216:219], v[128:131], v[48:51]
    v_mfma_f32_16x16x32_bf16 v[52:55], v[220:223], v[116:119], v[52:55]
    v_mfma_f32_16x16x32_bf16 v[56:59], v[220:223], v[120:123], v[56:59]
    s_waitcnt vmcnt(12)
    v_mov_b32 v1, 1
    s_mov_b64 exec, 1
    ds_add_u32 v255, v1 offset:36
    s_mov_b64 exec, -1
    s_mov_b32 s72, 1600000
L_lw_48:
    ds_read_b32 v1, v255 offset:36
    s_waitcnt lgkmcnt(0)
    v_readfirstlane_b32 s73, v1
    s_nop 0
    s_cmp_ge_u32 s73, 4
    s_cbranch_scc1 L_ld_49
    s_sleep 1
    s_sub_u32 s72, s72, 1
    s_cbranch_scc0 L_lw_48
L_ld_49:
    ds_read_b64_tr_b16 v[224:225], v248 offset:40960
    ds_read_b64_tr_b16 v[226:227], v248 offset:41472
    ds_read_b64_tr_b16 v[228:229], v249 offset:40960
    ds_read_b64_tr_b16 v[230:231], v249 offset:41472
    ds_read_b64_tr_b16 v[208:209], v198 offset:40960
    ds_read_b64_tr_b16 v[210:211], v198 offset:41472
    ds_read_b64_tr_b16 v[212:213], v199 offset:40960
    ds_read_b64_tr_b16 v[214:215], v199 offset:41472
    s_waitcnt vmcnt(18)
    s_waitcnt lgkmcnt(4)
    v_mfma_f32_16x16x32_bf16 v[4:7], v[224:227], v[132:135], v[4:7]
    s_add_u32 s74, s64, 15
    s_sub_u32 s65, s74, 26
    v_mfma_f32_16x16x32_bf16 v[8:11], v[224:227], v[136:139], v[8:11]
    ds_read_b64_tr_b16 v[216:217], v248 offset:45056
    s_min_u32 s74, s74, s65
    v_mfma_f32_16x16x32_bf16 v[12:15], v[224:227], v[140:143], v[12:15]
    ds_read_b64_tr_b16 v[218:219], v248 offset:45568
    s_lshl_b32 s74, s74, 12
    v_mfma_f32_16x16x32_bf16 v[16:19], v[224:227], v[144:147], v[16:19]
    ds_read_b64_tr_b16 v[220:221], v249 offset:45056
    s_add_u32 s74, s74, s61
    v_mfma_f32_16x16x32_bf16 v[20:23], v[228:231], v[132:135], v[20:23]
    ds_read_b64_tr_b16 v[222:223], v249 offset:45568
    buffer_load_dwordx4 v[116:119], v2, s[12:15], s74 offen offset:0 sc1
    v_mfma_f32_16x16x32_bf16 v[24:27], v[228:231], v[136:139], v[24:27]
    buffer_load_dwordx4 v[120:123], v2, s[12:15], s74 offen offset:1024 sc1
    buffer_load_dwordx4 v[124:127], v3, s[12:15], s74 offen offset:0 sc1
    v_mfma_f32_16x16x32_bf16 v[28:31], v[228:231], v[140:143], v[28:31]
    buffer_load_dwordx4 v[128:131], v3, s[12:15], s74 offen offset:1024 sc1
    s_lshl_b32 s72, s3, 10
    v_mfma_f32_16x16x32_bf16 v[32:35], v[228:231], v[144:147], v[32:35]
    s_add_u32 m0, s72, 90112
    s_add_u32 s73, s64, 16
    s_waitcnt lgkmcnt(4)
    v_mfma_f32_16x16x32_bf16 v[36:39], v[208:211], v[132:135], v[36:39]
    s_sub_u32 s65, s73, 26
    s_min_u32 s73, s73, s65
    v_mfma_f32_16x16x32_bf16 v[40:43], v[208:211], v[136:139], v[40:43]
    ds_read_b64_tr_b16 v[224:225], v198 offset:45056
    s_mul_i32 s73, s73, 53248
    v_mfma_f32_16x16x32_bf16 v[44:47], v[208:211], v[140:143], v[44:47]
    ds_read_b64_tr_b16 v[226:227], v198 offset:45568
    buffer_load_dwordx4 v251, s[16:19], s73 offen  lds
    v_mfma_f32_16x16x32_bf16 v[48:51], v[208:211], v[144:147], v[48:51]
    ds_read_b64_tr_b16 v[228:229], v199 offset:45056
    s_add_u32 m0, s72, 94208
    v_mfma_f32_16x16x32_bf16 v[52:55], v[212:215], v[132:135], v[52:55]
    ds_read_b64_tr_b16 v[230:231], v199 offset:45568
    s_add_u32 s73, s64, 17
    v_mfma_f32_16x16x32_bf16 v[56:59], v[212:215], v[136:139], v[56:59]
    s_sub_u32 s65, s73, 26
    s_min_u32 s73, s73, s65
    s_mul_i32 s73, s73, 53248
    buffer_load_dwordx4 v251, s[16:19], s73 offen  lds
    s_waitcnt vmcnt(19)
    s_waitcnt lgkmcnt(4)
    v_mfma_f32_16x16x32_bf16 v[4:7], v[216:219], v[148:151], v[4:7]
    s_add_u32 s74, s64, 16
    s_sub_u32 s65, s74, 26
    v_mfma_f32_16x16x32_bf16 v[8:11], v[216:219], v[152:155], v[8:11]
    ds_read_b64_tr_b16 v[208:209], v248 offset:49152
    s_min_u32 s74, s74, s65
    v_mfma_f32_16x16x32_bf16 v[12:15], v[216:219], v[156:159], v[12:15]
    ds_read_b64_tr_b16 v[210:211], v248 offset:49664
    s_lshl_b32 s74, s74, 12
    v_mfma_f32_16x16x32_bf16 v[16:19], v[216:219], v[160:163], v[16:19]
    ds_read_b64_tr_b16 v[212:213], v249 offset:49152
    s_add_u32 s74, s74, s61
    v_mfma_f32_16x16x32_bf16 v[20:23], v[220:223], v[148:151], v[20:23]
    ds_read_b64_tr_b16 v[214:215], v249 offset:49664
    buffer_load_dwordx4 v[132:135], v2, s[12:15], s74 offen offset:0 sc1
    v_mfma_f32_16x16x32_bf16 v[24:27], v[220:223], v[152:155], v[24:27]
    buffer_load_dwordx4 v[136:139], v2, s[12:15], s74 offen offset:1024 sc1
    buffer_load_dwordx4 v[140:143], v3, s[12:15], s74 offen offset:0 sc1
    v_mfma_f32_16x16x32_bf16 v[28:31], v[220:223], v[156:159], v[28:31]
    buffer_load_dwordx4 v[144:147], v3, s[12:15], s74 offen offset:1024 sc1
    s_lshl_b32 s72, s3, 10
    v_mfma_f32_16x16x32_bf16 v[32:35], v[220:223], v[160:163], v[32:35]
    s_add_u32 m0, s72, 98304
    s_add_u32 s73, s64, 18
    s_waitcnt lgkmcnt(4)
    v_mfma_f32_16x16x32_bf16 v[36:39], v[224:227], v[148:151], v[36:39]
    s_sub_u32 s65, s73, 26
    s_min_u32 s73, s73, s65
    v_mfma_f32_16x16x32_bf16 v[40:43], v[224:227], v[152:155], v[40:43]
    ds_read_b64_tr_b16 v[216:217], v198 offset:49152
    s_mul_i32 s73, s73, 53248
    v_mfma_f32_16x16x32_bf16 v[44:47], v[224:227], v[156:159], v[44:47]
    ds_read_b64_tr_b16 v[218:219], v198 offset:49664
    buffer_load_dwordx4 v251, s[16:19], s73 offen  lds
    v_mfma_f32_16x16x32_bf16 v[48:51], v[224:227], v[160:163], v[48:51]
    ds_read_b64_tr_b16 v[220:221], v199 offset:49152
    s_add_u32 m0, s72, 102400
    v_mfma_f32_16x16x32_bf16 v[52:55], v[228:231], v[148:151], v[52:55]
    ds_read_b64_tr_b16 v[222:223], v199 offset:49664
    s_add_u32 s73, s64, 19
    v_mfma_f32_16x16x32_bf16 v[56:59], v[228:231], v[152:155], v[56:59]
    s_sub_u32 s65, s73, 26
    s_min_u32 s73, s73, s65
    s_mul_i32 s73, s73, 53248
    buffer_load_dwordx4 v251, s[16:19], s73 offen  lds
    s_mov_b32 s72, 1600000
L_lw_50:
    ds_read_b32 v1, v255 offset:116
    s_waitcnt lgkmcnt(0)
    v_readfirstlane_b32 s73, v1
    s_nop 0
    s_cmp_ge_u32 s73, 4
    s_cbranch_scc1 L_ld_51
    s_sleep 4
    s_sub_u32 s72, s72, 1
    s_cbranch_scc0 L_lw_50
L_ld_51:
    s_waitcnt vmcnt(16)
    s_cmp_lg_u32 s3, 0
    s_cbranch_scc1 L_p1_52
    s_mov_b32 s72, 200000
    s_branch L_pc_56
L_pt_54:
    buffer_load_dword v196, v253, s[12:15], s55 offen offset:512 sc1
    s_waitcnt vmcnt(0)
L_pc_56:
    v_readfirstlane_b32 s73, v196
    s_nop 0
    s_cmp_lt_u32 s73, 11
    s_cbranch_scc1 L_ps_55
L_pd_53:
    v_mov_b32 v1, 1
    s_mov_b64 exec, 1
    ds_add_u32 v255, v1 offset:72
    s_mov_b64 exec, -1
L_p1_52:
    s_mov_b32 s72, 1600000
L_lw_57:
    ds_read_b32 v1, v255 offset:72
    s_waitcnt lgkmcnt(0)
    v_readfirstlane_b32 s73, v1
    s_nop 0
    s_cmp_ge_u32 s73, 1
    s_cbranch_scc1 L_ld_58
    s_sleep 4
    s_sub_u32 s72, s72, 1
    s_cbranch_scc0 L_lw_57
L_ld_58:
    s_waitcnt vmcnt(20)
    s_waitcnt lgkmcnt(4)
    v_mfma_f32_16x16x32_bf16 v[4:7], v[208:211], v[68:71], v[4:7]
    s_add_u32 s74, s64, 17
    s_sub_u32 s65, s74, 26
    v_mfma_f32_16x16x32_bf16 v[8:11], v[208:211], v[72:75], v[8:11]
    ds_read_b64_tr_b16 v[224:225], v248 offset:53248
    s_min_u32 s74, s74, s65
    v_mfma_f32_16x16x32_bf16 v[12:15], v[208:211], v[76:79], v[12:15]
    ds_read_b64_tr_b16 v[226:227], v248 offset:53760
    s_lshl_b32 s74, s74, 12
    v_mfma_f32_16x16x32_bf16 v[16:19], v[208:211], v[80:83], v[16:19]
    ds_read_b64_tr_b16 v[228:229], v249 offset:53248
    s_add_u32 s74, s74, s61
    v_mfma_f32_16x16x32_bf16 v[20:23], v[212:215], v[68:71], v[20:23]
    ds_read_b64_tr_b16 v[230:231], v249 offset:53760
    buffer_load_dwordx4 v[148:151], v2, s[12:15], s74 offen offset:0 sc1
    v_mfma_f32_16x16x32_bf16 v[24:27], v[212:215], v[72:75], v[24:27]
    buffer_load_dwordx4 v[152:155], v2, s[12:15], s74 offen offset:1024 sc1
    buffer_load_dwordx4 v[156:159], v3, s[12:15], s74 offen offset:0 sc1
    v_mfma_f32_16x16x32_bf16 v[28:31], v[212:215], v[76:79], v[28:31]
    buffer_load_dwordx4 v[160:163], v3, s[12:15], s74 offen offset:1024 sc1
    s_lshl_b32 s72, s3, 10
    v_mfma_f32_16x16x32_bf16 v[32:35], v[212:215], v[80:83], v[32:35]
    s_add_u32 m0, s72, 106496
    s_add_u32 s73, s64, 20
    s_waitcnt lgkmcnt(4)
    v_mfma_f32_16x16x32_bf16 v[36:39], v[216:219], v[68:71], v[36:39]
    s_sub_u32 s65, s73, 26
    s_min_u32 s73, s73, s65
    v_mfma_f32_16x16x32_bf16 v[40:43], v[216:219], v[72:75], v[40:43]
    ds_read_b64_tr_b16 v[208:209], v198 offset:53248
    s_mul_i32 s73, s73, 53248
    v_mfma_f32_16x16x32_bf16 v[44:47], v[216:219], v[76:79], v[44:47]
    ds_read_b64_tr_b16 v[210:211], v198 offset:53760
    buffer_load_dwordx4 v251, s[16:19], s73 offen  lds
    v_mfma_f32_16x16x32_bf16 v[48:51], v[216:219], v[80:83], v[48:51]
    ds_read_b64_tr_b16 v[212:213], v199 offset:53248
    s_mul_i32 s72, s3, 11264
    v_mfma_f32_16x16x32_bf16 v[52:55], v[220:223], v[68:71], v[52:55]
    ds_read_b64_tr_b16 v[214:215], v199 offset:53760
    s_add_u32 s73, s72, 45056
    v_mfma_f32_16x16x32_bf16 v[56:59], v[220:223], v[72:75], v[56:59]
    s_add_u32 m0, s72, 45056
    s_nop 0
    buffer_load_dwordx4 v250, s[12:15], s73 offen offset:0 sc1 lds
    buffer_load_dwordx4 v250, s[12:15], s73 offen offset:1024 sc1 lds
    buffer_load_dwordx4 v250, s[12:15], s73 offen offset:2048 sc1 lds
    s_waitcnt vmcnt(24)
    s_waitcnt lgkmcnt(4)
    v_mfma_f32_16x16x32_bf16 v[4:7], v[224:227], v[84:87], v[4:7]
    s_add_u32 s74, s64, 18
    s_sub_u32 s65, s74, 26
    v_mfma_f32_16x16x32_bf16 v[8:11], v[224:227], v[88:91], v[8:11]
    ds_read_b64_tr_b16 v[216:217], v248 offset:57344
    s_min_u32 s74, s74, s65
    v_mfma_f32_16x16x32_bf16 v[12:15], v[224:227], v[92:95], v[12:15]
    ds_read_b64_tr_b16 v[218:219], v248 offset:57856
    s_lshl_b32 s74, s74, 12
    v_mfma_f32_16x16x32_bf16 v[16:19], v[224:227], v[96:99], v[16:19]
    ds_read_b64_tr_b16 v[220:221], v249 offset:57344
    s_add_u32 s74, s74, s61
    v_mfma_f32_16x16x32_bf16 v[20:23], v[228:231], v[84:87], v[20:23]
    ds_read_b64_tr_b16 v[222:223], v249 offset:57856
    buffer_load_dwordx4 v[68:71], v2, s[12:15], s74 offen offset:0 sc1
    v_mfma_f32_16x16x32_bf16 v[24:27], v[228:231], v[88:91], v[24:27]
    buffer_load_dwordx4 v[72:75], v2, s[12:15], s74 offen offset:1024 sc1
    buffer_load_dwordx4 v[76:79], v3, s[12:15], s74 offen offset:0 sc1
    v_mfma_f32_16x16x32_bf16 v[28:31], v[228:231], v[92:95], v[28:31]
    buffer_load_dwordx4 v[80:83], v3, s[12:15], s74 offen offset:1024 sc1
    s_lshl_b32 s72, s3, 10
    v_mfma_f32_16x16x32_bf16 v[32:35], v[228:231], v[96:99], v[32:35]
    s_add_u32 m0, s72, 110592
    s_add_u32 s73, s64, 21
    s_waitcnt lgkmcnt(4)
    v_mfma_f32_16x16x32_bf16 v[36:39], v[208:211], v[84:87], v[36:39]
    s_sub_u32 s65, s73, 26
    s_min_u32 s73, s73, s65
    v_mfma_f32_16x16x32_bf16 v[40:43], v[208:211], v[88:91], v[40:43]
    ds_read_b64_tr_b16 v[224:225], v198 offset:57344
    s_mul_i32 s73, s73, 53248
    v_mfma_f32_16x16x32_bf16 v[44:47], v[208:211], v[92:95], v[44:47]
    ds_read_b64_tr_b16 v[226:227], v198 offset:57856
    buffer_load_dwordx4 v251, s[16:19], s73 offen  lds
    v_mfma_f32_16x16x32_bf16 v[48:51], v[208:211], v[96:99], v[48:51]
    ds_read_b64_tr_b16 v[228:229], v199 offset:57344
    s_mul_i32 s72, s3, 11264
    v_mfma_f32_16x16x32_bf16 v[52:55], v[212:215], v[84:87], v[52:55]
    ds_read_b64_tr_b16 v[230:231], v199 offset:57856
    s_add_u32 s73, s72, 48128
    v_mfma_f32_16x16x32_bf16 v[56:59], v[212:215], v[88:91], v[56:59]
    s_add_u32 m0, s72, 48128
    s_nop 0
    buffer_load_dwordx4 v250, s[12:15], s73 offen offset:0 sc1 lds
    buffer_load_dwordx4 v250, s[12:15], s73 offen offset:1024 sc1 lds
    buffer_load_dwordx4 v250, s[12:15], s73 offen offset:2048 sc1 lds
    s_waitcnt vmcnt(28)
    s_waitcnt lgkmcnt(4)
    v_mfma_f32_16x16x32_bf16 v[4:7], v[216:219], v[100:103], v[4:7]
    s_add_u32 s74, s64, 19
    s_sub_u32 s65, s74, 26
    v_mfma_f32_16x16x32_bf16 v[8:11], v[216:219], v[104:107], v[8:11]
    ds_read_b64_tr_b16 v[208:209], v248 offset:61440
    s_min_u32 s74, s74, s65
    v_mfma_f32_16x16x32_bf16 v[12:15], v[216:219], v[108:111], v[12:15]
    ds_read_b64_tr_b16 v[210:211], v248 offset:61952
    s_lshl_b32 s74, s74, 12
    v_mfma_f32_16x16x32_bf16 v[16:19], v[216:219], v[112:115], v[16:19]
    ds_read_b64_tr_b16 v[212:213], v249 offset:61440
    s_add_u32 s74, s74, s61
    v_mfma_f32_16x16x32_bf16 v[20:23], v[220:223], v[100:103], v[20:23]
    ds_read_b64_tr_b16 v[214:215], v249 offset:61952
    buffer_load_dwordx4 v[84:87], v2, s[12:15], s74 offen offset:0 sc1
    v_mfma_f32_16x16x32_bf16 v[24:27], v[220:223], v[104:107], v[24:27]
    buffer_load_dwordx4 v[88:91], v2, s[12:15], s74 offen offset:1024 sc1
    buffer_load_dwordx4 v[92:95], v3, s[12:15], s74 offen offset:0 sc1
    v_mfma_f32_16x16x32_bf16 v[28:31], v[220:223], v[108:111], v[28:31]
    buffer_load_dwordx4 v[96:99], v3, s[12:15], s74 offen offset:1024 sc1
    s_lshl_b32 s72, s3, 10
    v_mfma_f32_16x16x32_bf16 v[32:35], v[220:223], v[112:115], v[32:35]
    s_add_u32 m0, s72, 114688
    s_add_u32 s73, s64, 22
    s_waitcnt lgkmcnt(4)
    v_mfma_f32_16x16x32_bf16 v[36:39], v[224:227], v[100:103], v[36:39]
    s_sub_u32 s65, s73, 26
    s_min_u32 s73, s73, s65
    v_mfma_f32_16x16x32_bf16 v[40:43], v[224:227], v[104:107], v[40:43]
    ds_read_b64_tr_b16 v[216:217], v198 offset:61440
    s_mul_i32 s73, s73, 53248
    v_mfma_f32_16x16x32_bf16 v[44:47], v[224:227], v[108:111], v[44:47]
    ds_read_b64_tr_b16 v[218:219], v198 offset:61952
    buffer_load_dwordx4 v251, s[16:19], s73 offen  lds
    v_mfma_f32_16x16x32_bf16 v[48:51], v[224:227], v[112:115], v[48:51]
    ds_read_b64_tr_b16 v[220:221], v199 offset:61440
    s_mul_i32 s72, s3, 11264
    v_mfma_f32_16x16x32_bf16 v[52:55], v[228:231], v[100:103], v[52:55]
    ds_read_b64_tr_b16 v[222:223], v199 offset:61952
    s_add_u32 s73, s72, 51200
    v_mfma_f32_16x16x32_bf16 v[56:59], v[228:231], v[104:107], v[56:59]
    s_add_u32 m0, s72, 51200
    s_nop 0
    buffer_load_dwordx4 v250, s[12:15], s73 offen offset:0 sc1 lds
    buffer_load_dwordx4 v250, s[12:15], s73 offen offset:1024 sc1 lds
    buffer_load_dwordx4 v250, s[12:15], s73 offen offset:2048 sc1 lds
    s_waitcnt vmcnt(32)
    s_waitcnt lgkmcnt(4)
    v_mfma_f32_16x16x32_bf16 v[4:7], v[208:211], v[116:119], v[4:7]
    s_add_u32 s74, s64, 20
    s_sub_u32 s65, s74, 26
    v_mfma_f32_16x16x32_bf16 v[8:11], v[208:211], v[120:123], v[8:11]
    s_min_u32 s74, s74, s65
    s_lshl_b32 s74, s74, 12
    v_mfma_f32_16x16x32_bf16 v[12:15], v[208:211], v[124:127], v[12:15]
    s_add_u32 s74, s74, s61
    buffer_load_dwordx4 v[100:103], v2, s[12:15], s74 offen offset:0 sc1
    v_mfma_f32_16x16x32_bf16 v[16:19], v[208:211], v[128:131], v[16:19]
    buffer_load_dwordx4 v[104:107], v2, s[12:15], s74 offen offset:1024 sc1
    buffer_load_dwordx4 v[108:111], v3, s[12:15], s74 offen offset:0 sc1
    v_mfma_f32_16x16x32_bf16 v[20:23], v[212:215], v[116:119], v[20:23]
    buffer_load_dwordx4 v[112:115], v3, s[12:15], s74 offen offset:1024 sc1
    s_lshl_b32 s72, s3, 10
    v_mfma_f32_16x16x32_bf16 v[24:27], v[212:215], v[120:123], v[24:27]
    s_add_u32 m0, s72, 118784
    s_add_u32 s73, s64, 23
    v_mfma_f32_16x16x32_bf16 v[28:31], v[212:215], v[124:127], v[28:31]
    s_sub_u32 s65, s73, 26
    s_min_u32 s73, s73, s65
    v_mfma_f32_16x16x32_bf16 v[32:35], v[212:215], v[128:131], v[32:35]
    s_mul_i32 s73, s73, 53248
    buffer_load_dwordx4 v251, s[16:19], s73 offen  lds
    s_waitcnt lgkmcnt(0)
    v_mfma_f32_16x16x32_bf16 v[36:39], v[216:219], v[116:119], v[36:39]
    s_mul_i32 s72, s3, 11264
    s_add_u32 s73, s72, 54272
    v_mfma_f32_16x16x32_bf16 v[40:43], v[216:219], v[120:123], v[40:43]
    s_add_u32 m0, s72, 54272
    s_nop 0
    buffer_load_dwordx4 v250, s[12:15], s73 offen offset:0 sc1 lds
    v_mfma_f32_16x16x32_bf16 v[44:47], v[216:219], v[124:127], v[44:47]
    buffer_load_dwordx4 v250, s[12:15], s73 offen offset:1024 sc1 lds
    v_mfma_f32_16x16x32_bf16 v[48:51], v[216:219], v[128:131], v[48:51]
    v_mfma_f32_16x16x32_bf16 v[52:55], v[220:223], v[116:119], v[52:55]
    v_mfma_f32_16x16x32_bf16 v[56:59], v[220:223], v[120:123], v[56:59]
    s_waitcnt vmcnt(26)
    v_mov_b32 v1, 1
    s_mov_b64 exec, 1
    ds_add_u32 v255, v1 offset:40
    s_mov_b64 exec, -1
    s_mov_b32 s72, 1600000
L_lw_59:
    ds_read_b32 v1, v255 offset:40
    s_waitcnt lgkmcnt(0)
    v_readfirstlane_b32 s73, v1
    s_nop 0
    s_cmp_ge_u32 s73, 4
    s_cbranch_scc1 L_ld_60
    s_sleep 1
    s_sub_u32 s72, s72, 1
    s_cbranch_scc0 L_lw_59
L_ld_60:
    ds_read_b64_tr_b16 v[224:225], v248 offset:0
    ds_read_b64_tr_b16 v[226:227], v248 offset:512
    ds_read_b64_tr_b16 v[228:229], v249 offset:0
    ds_read_b64_tr_b16 v[230:231], v249 offset:512
    ds_read_b64_tr_b16 v[208:209], v198 offset:0
    ds_read_b64_tr_b16 v[210:211], v198 offset:512
    ds_read_b64_tr_b16 v[212:213], v199 offset:0
    ds_read_b64_tr_b16 v[214:215], v199 offset:512
    s_waitcnt vmcnt(33)
    s_waitcnt lgkmcnt(4)
    v_mfma_f32_16x16x32_bf16 v[4:7], v[224:227], v[132:135], v[4:7]
    s_add_u32 s74, s64, 21
    s_sub_u32 s65, s74, 26
    v_mfma_f32_16x16x32_bf16 v[8:11], v[224:227], v[136:139], v[8:11]
    ds_read_b64_tr_b16 v[216:217], v248 offset:4096
    s_min_u32 s74, s74, s65
    v_mfma_f32_16x16x32_bf16 v[12:15], v[224:227], v[140:143], v[12:15]
    ds_read_b64_tr_b16 v[218:219], v248 offset:4608
    s_lshl_b32 s74, s74, 12
    v_mfma_f32_16x16x32_bf16 v[16:19], v[224:227], v[144:147], v[16:19]
    ds_read_b64_tr_b16 v[220:221], v249 offset:4096
    s_add_u32 s74, s74, s61
    v_mfma_f32_16x16x32_bf16 v[20:23], v[228:231], v[132:135], v[20:23]
    ds_read_b64_tr_b16 v[222:223], v249 offset:4608
    buffer_load_dwordx4 v[116:119], v2, s[12:15], s74 offen offset:0 sc1
    v_mfma_f32_16x16x32_bf16 v[24:27], v[228:231], v[136:139], v[24:27]
    buffer_load_dwordx4 v[120:123], v2, s[12:15], s74 offen offset:1024 sc1
    buffer_load_dwordx4 v[124:127], v3, s[12:15], s74 offen offset:0 sc1
    v_mfma_f32_16x16x32_bf16 v[28:31], v[228:231], v[140:143], v[28:31]
    buffer_load_dwordx4 v[128:131], v3, s[12:15], s74 offen offset:1024 sc1
    s_lshl_b32 s72, s3, 10
    v_mfma_f32_16x16x32_bf16 v[32:35], v[228:231], v[144:147], v[32:35]
    s_add_u32 m0, s72, 122880
    s_add_u32 s73, s64, 24
    s_waitcnt lgkmcnt(4)
    v_mfma_f32_16x16x32_bf16 v[36:39], v[208:211], v[132:135], v[36:39]
    s_sub_u32 s65, s73, 26
    s_min_u32 s73, s73, s65
    v_mfma_f32_16x16x32_bf16 v[40:43], v[208:211], v[136:139], v[40:43]
    ds_read_b64_tr_b16 v[224:225], v198 offset:4096
    s_mul_i32 s73, s73, 53248
    v_mfma_f32_16x16x32_bf16 v[44:47], v[208:211], v[140:143], v[44:47]
    ds_read_b64_tr_b16 v[226:227], v198 offset:4608
    buffer_load_dwordx4 v251, s[16:19], s73 offen  lds
    v_mfma_f32_16x16x32_bf16 v[48:51], v[208:211], v[144:147], v[48:51]
    ds_read_b64_tr_b16 v[228:229], v199 offset:4096
    v_mfma_f32_16x16x32_bf16 v[52:55], v[212:215], v[132:135], v[52:55]
    ds_read_b64_tr_b16 v[230:231], v199 offset:4608
    v_mfma_f32_16x16x32_bf16 v[56:59], v[212:215], v[136:139], v[56:59]
    s_waitcnt vmcnt(32)
    s_waitcnt lgkmcnt(4)
    v_mfma_f32_16x16x32_bf16 v[4:7], v[216:219], v[148:151], v[4:7]
    s_add_u32 s74, s64, 22
    s_sub_u32 s65, s74, 26
    v_mfma_f32_16x16x32_bf16 v[8:11], v[216:219], v[152:155], v[8:11]
    ds_read_b64_tr_b16 v[208:209], v248 offset:8192
    s_min_u32 s74, s74, s65
    v_mfma_f32_16x16x32_bf16 v[12:15], v[216:219], v[156:159], v[12:15]
    ds_read_b64_tr_b16 v[210:211], v248 offset:8704
    s_lshl_b32 s74, s74, 12
    v_mfma_f32_16x16x32_bf16 v[16:19], v[216:219], v[160:163], v[16:19]
    ds_read_b64_tr_b16 v[212:213], v249 offset:8192
    s_add_u32 s74, s74, s61
    v_mfma_f32_16x16x32_bf16 v[20:23], v[220:223], v[148:151], v[20:23]
    ds_read_b64_tr_b16 v[214:215], v249 offset:8704
    buffer_load_dwordx4 v[132:135], v2, s[12:15], s74 offen offset:0 sc1
    v_mfma_f32_16x16x32_bf16 v[24:27], v[220:223], v[152:155], v[24:27]
    buffer_load_dwordx4 v[136:139], v2, s[12:15], s74 offen offset:1024 sc1
    buffer_load_dwordx4 v[140:143], v3, s[12:15], s74 offen offset:0 sc1
    v_mfma_f32_16x16x32_bf16 v[28:31], v[220:223], v[156:159], v[28:31]
    buffer_load_dwordx4 v[144:147], v3, s[12:15], s74 offen offset:1024 sc1
    s_lshl_b32 s72, s3, 10
    v_mfma_f32_16x16x32_bf16 v[32:35], v[220:223], v[160:163], v[32:35]
    s_add_u32 m0, s72, 126976
    s_add_u32 s73, s64, 25
    s_waitcnt lgkmcnt(4)
    v_mfma_f32_16x16x32_bf16 v[36:39], v[224:227], v[148:151], v[36:39]
    s_sub_u32 s65, s73, 26
    s_min_u32 s73, s73, s65
    v_mfma_f32_16x16x32_bf16 v[40:43], v[224:227], v[152:155], v[40:43]
    ds_read_b64_tr_b16 v[216:217], v198 offset:8192
    s_mul_i32 s73, s73, 53248
    v_mfma_f32_16x16x32_bf16 v[44:47], v[224:227], v[156:159], v[44:47]
    ds_read_b64_tr_b16 v[218:219], v198 offset:8704
    buffer_load_dwordx4 v251, s[16:19], s73 offen  lds
    v_mfma_f32_16x16x32_bf16 v[48:51], v[224:227], v[160:163], v[48:51]
    ds_read_b64_tr_b16 v[220:221], v199 offset:8192
    v_mfma_f32_16x16x32_bf16 v[52:55], v[228:231], v[148:151], v[52:55]
    ds_read_b64_tr_b16 v[222:223], v199 offset:8704
    v_mfma_f32_16x16x32_bf16 v[56:59], v[228:231], v[152:155], v[56:59]
    s_waitcnt vmcnt(10)
    v_mov_b32 v1, 1
    s_mov_b64 exec, 1
    ds_add_u32 v255, v1 offset:24
    s_mov_b64 exec, -1
    s_waitcnt vmcnt(29)
    s_waitcnt lgkmcnt(4)
    v_mfma_f32_16x16x32_bf16 v[4:7], v[208:211], v[68:71], v[4:7]
    s_add_u32 s74, s64, 23
    s_sub_u32 s65, s74, 26
    v_mfma_f32_16x16x32_bf16 v[8:11], v[208:211], v[72:75], v[8:11]
    ds_read_b64_tr_b16 v[224:225], v248 offset:12288
    s_min_u32 s74, s74, s65
    v_mfma_f32_16x16x32_bf16 v[12:15], v[208:211], v[76:79], v[12:15]
    ds_read_b64_tr_b16 v[226:227], v248 offset:12800
    s_lshl_b32 s74, s74, 12
    v_mfma_f32_16x16x32_bf16 v[16:19], v[208:211], v[80:83], v[16:19]
    ds_read_b64_tr_b16 v[228:229], v249 offset:12288
    s_add_u32 s74, s74, s61
    v_mfma_f32_16x16x32_bf16 v[20:23], v[212:215], v[68:71], v[20:23]
    ds_read_b64_tr_b16 v[230:231], v249 offset:12800
    buffer_load_dwordx4 v[148:151], v2, s[12:15], s74 offen offset:0 sc1
    v_mfma_f32_16x16x32_bf16 v[24:27], v[212:215], v[72:75], v[24:27]
    buffer_load_dwordx4 v[152:155], v2, s[12:15], s74 offen offset:1024 sc1
    buffer_load_dwordx4 v[156:159], v3, s[12:15], s74 offen offset:0 sc1
    v_mfma_f32_16x16x32_bf16 v[28:31], v[212:215], v[76:79], v[28:31]
    buffer_load_dwordx4 v[160:163], v3, s[12:15], s74 offen offset:1024 sc1
    v_mfma_f32_16x16x32_bf16 v[32:35], v[212:215], v[80:83], v[32:35]
    s_waitcnt lgkmcnt(4)
    v_mfma_f32_16x16x32_bf16 v[36:39], v[216:219], v[68:71], v[36:39]
    v_mfma_f32_16x16x32_bf16 v[40:43], v[216:219], v[72:75], v[40:43]
    ds_read_b64_tr_b16 v[208:209], v198 offset:12288
    v_mfma_f32_16x16x32_bf16 v[44:47], v[216:219], v[76:79], v[44:47]
    ds_read_b64_tr_b16 v[210:211], v198 offset:12800
    v_mfma_f32_16x16x32_bf16 v[48:51], v[216:219], v[80:83], v[48:51]
    ds_read_b64_tr_b16 v[212:213], v199 offset:12288
    v_mfma_f32_16x16x32_bf16 v[52:55], v[220:223], v[68:71], v[52:55]
    ds_read_b64_tr_b16 v[214:215], v199 offset:12800
    v_mfma_f32_16x16x32_bf16 v[56:59], v[220:223], v[72:75], v[56:59]
    s_waitcnt vmcnt(25)
    s_waitcnt lgkmcnt(4)
    v_mfma_f32_16x16x32_bf16 v[4:7], v[224:227], v[84:87], v[4:7]
    s_add_u32 s74, s64, 24
    s_sub_u32 s65, s74, 26
    v_mfma_f32_16x16x32_bf16 v[8:11], v[224:227], v[88:91], v[8:11]
    ds_read_b64_tr_b16 v[216:217], v248 offset:16384
    s_min_u32 s74, s74, s65
    v_mfma_f32_16x16x32_bf16 v[12:15], v[224:227], v[92:95], v[12:15]
    ds_read_b64_tr_b16 v[218:219], v248 offset:16896
    s_lshl_b32 s74, s74, 12
    v_mfma_f32_16x16x32_bf16 v[16:19], v[224:227], v[96:99], v[16:19]
    ds_read_b64_tr_b16 v[220:221], v249 offset:16384
    s_add_u32 s74, s74, s61
    v_mfma_f32_16x16x32_bf16 v[20:23], v[228:231], v[84:87], v[20:23]
    ds_read_b64_tr_b16 v[222:223], v249 offset:16896
    buffer_load_dwordx4 v[68:71], v2, s[12:15], s74 offen offset:0 sc1
    v_mfma_f32_16x16x32_bf16 v[24:27], v[228:231], v[88:91], v[24:27]
    buffer_load_dwordx4 v[72:75], v2, s[12:15], s74 offen offset:1024 sc1
    buffer_load_dwordx4 v[76:79], v3, s[12:15], s74 offen offset:0 sc1
    v_mfma_f32_16x16x32_bf16 v[28:31], v[228:231], v[92:95], v[28:31]
    buffer_load_dwordx4 v[80:83], v3, s[12:15], s74 offen offset:1024 sc1
    v_mfma_f32_16x16x32_bf16 v[32:35], v[228:231], v[96:99], v[32:35]
    s_waitcnt lgkmcnt(4)
    v_mfma_f32_16x16x32_bf16 v[36:39], v[208:211], v[84:87], v[36:39]
    v_mfma_f32_16x16x32_bf16 v[40:43], v[208:211], v[88:91], v[40:43]
    ds_read_b64_tr_b16 v[224:225], v198 offset:16384
    v_mfma_f32_16x16x32_bf16 v[44:47], v[208:211], v[92:95], v[44:47]
    ds_read_b64_tr_b16 v[226:227], v198 offset:16896
    v_mfma_f32_16x16x32_bf16 v[48:51], v[208:211], v[96:99], v[48:51]
    ds_read_b64_tr_b16 v[228:229], v199 offset:16384
    v_mfma_f32_16x16x32_bf16 v[52:55], v[212:215], v[84:87], v[52:55]
    ds_read_b64_tr_b16 v[230:231], v199 offset:16896
    v_mfma_f32_16x16x32_bf16 v[56:59], v[212:215], v[88:91], v[56:59]
    s_waitcnt vmcnt(21)
    s_waitcnt lgkmcnt(4)
    v_mfma_f32_16x16x32_bf16 v[4:7], v[216:219], v[100:103], v[4:7]
    s_add_u32 s74, s64, 25
    s_sub_u32 s65, s74, 26
    v_mfma_f32_16x16x32_bf16 v[8:11], v[216:219], v[104:107], v[8:11]
    s_min_u32 s74, s74, s65
    s_lshl_b32 s74, s74, 12
    v_mfma_f32_16x16x32_bf16 v[12:15], v[216:219], v[108:111], v[12:15]
    s_add_u32 s74, s74, s61
    buffer_load_dwordx4 v[84:87], v2, s[12:15], s74 offen offset:0 sc1
    v_mfma_f32_16x16x32_bf16 v[16:19], v[216:219], v[112:115], v[16:19]
    buffer_load_dwordx4 v[88:91], v2, s[12:15], s74 offen offset:1024 sc1
    buffer_load_dwordx4 v[92:95], v3, s[12:15], s74 offen offset:0 sc1
    v_mfma_f32_16x16x32_bf16 v[20:23], v[220:223], v[100:103], v[20:23]
    buffer_load_dwordx4 v[96:99], v3, s[12:15], s74 offen offset:1024 sc1
    v_mfma_f32_16x16x32_bf16 v[24:27], v[220:223], v[104:107], v[24:27]
    v_mfma_f32_16x16x32_bf16 v[28:31], v[220:223], v[108:111], v[28:31]
    v_mfma_f32_16x16x32_bf16 v[32:35], v[220:223], v[112:115], v[32:35]
    s_waitcnt lgkmcnt(0)
    v_mfma_f32_16x16x32_bf16 v[36:39], v[224:227], v[100:103], v[36:39]
    v_mfma_f32_16x16x32_bf16 v[40:43], v[224:227], v[104:107], v[40:43]
    v_mfma_f32_16x16x32_bf16 v[44:47], v[224:227], v[108:111], v[44:47]
    v_mfma_f32_16x16x32_bf16 v[48:51], v[224:227], v[112:115], v[48:51]
    v_mfma_f32_16x16x32_bf16 v[52:55], v[228:231], v[100:103], v[52:55]
    v_mfma_f32_16x16x32_bf16 v[56:59], v[228:231], v[104:107], v[56:59]
    s_waitcnt vmcnt(12)
    v_mov_b32 v1, 1
    s_mov_b64 exec, 1
    ds_add_u32 v255, v1 offset:44
    s_mov_b64 exec, -1
    s_mov_b32 s72, 1600000
L_lw_61:
    ds_read_b32 v1, v255 offset:44
    s_waitcnt lgkmcnt(0)
    v_readfirstlane_b32 s73, v1
    s_nop 0
    s_cmp_ge_u32 s73, 4
    s_cbranch_scc1 L_ld_62
    s_sleep 1
    s_sub_u32 s72, s72, 1
    s_cbranch_scc0 L_lw_61
L_ld_62:
    ds_read_b64_tr_b16 v[208:209], v248 offset:20480
    ds_read_b64_tr_b16 v[210:211], v248 offset:20992
    ds_read_b64_tr_b16 v[212:213], v249 offset:20480
    ds_read_b64_tr_b16 v[214:215], v249 offset:20992
    ds_read_b64_tr_b16 v[216:217], v198 offset:20480
    ds_read_b64_tr_b16 v[218:219], v198 offset:20992
    ds_read_b64_tr_b16 v[220:221], v199 offset:20480
    ds_read_b64_tr_b16 v[222:223], v199 offset:20992
    s_waitcnt vmcnt(18)
    s_waitcnt lgkmcnt(4)
    v_mfma_f32_16x16x32_bf16 v[4:7], v[208:211], v[116:119], v[4:7]
    v_mfma_f32_16x16x32_bf16 v[8:11], v[208:211], v[120:123], v[8:11]
    ds_read_b64_tr_b16 v[224:225], v248 offset:24576
    v_mfma_f32_16x16x32_bf16 v[12:15], v[208:211], v[124:127], v[12:15]
    ds_read_b64_tr_b16 v[226:227], v248 offset:25088
    v_mfma_f32_16x16x32_bf16 v[16:19], v[208:211], v[128:131], v[16:19]
    ds_read_b64_tr_b16 v[228:229], v249 offset:24576
    v_mfma_f32_16x16x32_bf16 v[20:23], v[212:215], v[116:119], v[20:23]
    ds_read_b64_tr_b16 v[230:231], v249 offset:25088
    v_mfma_f32_16x16x32_bf16 v[24:27], v[212:215], v[120:123], v[24:27]
    v_mfma_f32_16x16x32_bf16 v[28:31], v[212:215], v[124:127], v[28:31]
    v_mfma_f32_16x16x32_bf16 v[32:35], v[212:215], v[128:131], v[32:35]
    s_waitcnt lgkmcnt(4)
    v_mfma_f32_16x16x32_bf16 v[36:39], v[216:219], v[116:119], v[36:39]
    v_mfma_f32_16x16x32_bf16 v[40:43], v[216:219], v[120:123], v[40:43]
    ds_read_b64_tr_b16 v[208:209], v198 offset:24576
    v_mfma_f32_16x16x32_bf16 v[44:47], v[216:219], v[124:127], v[44:47]
    ds_read_b64_tr_b16 v[210:211], v198 offset:25088
    v_mfma_f32_16x16x32_bf16 v[48:51], v[216:219], v[128:131], v[48:51]
    ds_read_b64_tr_b16 v[212:213], v199 offset:24576
    v_mfma_f32_16x16x32_bf16 v[52:55], v[220:223], v[116:119], v[52:55]
    ds_read_b64_tr_b16 v[214:215], v199 offset:25088
    v_mfma_f32_16x16x32_bf16 v[56:59], v[220:223], v[120:123], v[56:59]
    s_waitcnt vmcnt(13)
    s_waitcnt lgkmcnt(4)
    v_mfma_f32_16x16x32_bf16 v[4:7], v[224:227], v[132:135], v[4:7]
    v_mfma_f32_16x16x32_bf16 v[8:11], v[224:227], v[136:139], v[8:11]
    ds_read_b64_tr_b16 v[216:217], v248 offset:28672
    v_mfma_f32_16x16x32_bf16 v[12:15], v[224:227], v[140:143], v[12:15]
    ds_read_b64_tr_b16 v[218:219], v248 offset:29184
    v_mfma_f32_16x16x32_bf16 v[16:19], v[224:227], v[144:147], v[16:19]
    ds_read_b64_tr_b16 v[220:221], v249 offset:28672
    v_mfma_f32_16x16x32_bf16 v[20:23], v[228:231], v[132:135], v[20:23]
    ds_read_b64_tr_b16 v[222:223], v249 offset:29184
    v_mfma_f32_16x16x32_bf16 v[24:27], v[228:231], v[136:139], v[24:27]
    v_mfma_f32_16x16x32_bf16 v[28:31], v[228:231], v[140:143], v[28:31]
    v_mfma_f32_16x16x32_bf16 v[32:35], v[228:231], v[144:147], v[32:35]
    s_waitcnt lgkmcnt(4)
    v_mfma_f32_16x16x32_bf16 v[36:39], v[208:211], v[132:135], v[36:39]
    v_mfma_f32_16x16x32_bf16 v[40:43], v[208:211], v[136:139], v[40:43]
    ds_read_b64_tr_b16 v[224:225], v198 offset:28672
    v_mfma_f32_16x16x32_bf16 v[44:47], v[208:211], v[140:143], v[44:47]
    ds_read_b64_tr_b16 v[226:227], v198 offset:29184
    v_mfma_f32_16x16x32_bf16 v[48:51], v[208:211], v[144:147], v[48:51]
    ds_read_b64_tr_b16 v[228:229], v199 offset:28672
    v_mfma_f32_16x16x32_bf16 v[52:55], v[212:215], v[132:135], v[52:55]
    ds_read_b64_tr_b16 v[230:231], v199 offset:29184
    v_mfma_f32_16x16x32_bf16 v[56:59], v[212:215], v[136:139], v[56:59]
    buffer_load_dword v197, v253, s[12:15], s55 offen offset:516 sc1
    s_waitcnt vmcnt(8)
    s_waitcnt lgkmcnt(4)
    v_mfma_f32_16x16x32_bf16 v[4:7], v[216:219], v[148:151], v[4:7]
    v_mfma_f32_16x16x32_bf16 v[8:11], v[216:219], v[152:155], v[8:11]
    ds_read_b64_tr_b16 v[208:209], v248 offset:32768
    v_mfma_f32_16x16x32_bf16 v[12:15], v[216:219], v[156:159], v[12:15]
    ds_read_b64_tr_b16 v[210:211], v248 offset:33280
    v_mfma_f32_16x16x32_bf16 v[16:19], v[216:219], v[160:163], v[16:19]
    ds_read_b64_tr_b16 v[212:213], v249 offset:32768
    v_mfma_f32_16x16x32_bf16 v[20:23], v[220:223], v[148:151], v[20:23]
    ds_read_b64_tr_b16 v[214:215], v249 offset:33280
    v_mfma_f32_16x16x32_bf16 v[24:27], v[220:223], v[152:155], v[24:27]
    v_mfma_f32_16x16x32_bf16 v[28:31], v[220:223], v[156:159], v[28:31]
    v_mfma_f32_16x16x32_bf16 v[32:35], v[220:223], v[160:163], v[32:35]
    s_waitcnt lgkmcnt(4)
    v_mfma_f32_16x16x32_bf16 v[36:39], v[224:227], v[148:151], v[36:39]
    v_mfma_f32_16x16x32_bf16 v[40:43], v[224:227], v[152:155], v[40:43]
    ds_read_b64_tr_b16 v[216:217], v198 offset:32768
    v_mfma_f32_16x16x32_bf16 v[44:47], v[224:227], v[156:159], v[44:47]
    ds_read_b64_tr_b16 v[218:219], v198 offset:33280
    v_mfma_f32_16x16x32_bf16 v[48:51], v[224:227], v[160:163], v[48:51]
    ds_read_b64_tr_b16 v[220:221], v199 offset:32768
    v_mfma_f32_16x16x32_bf16 v[52:55], v[228:231], v[148:151], v[52:55]
    ds_read_b64_tr_b16 v[222:223], v199 offset:33280
    v_mfma_f32_16x16x32_bf16 v[56:59], v[228:231], v[152:155], v[56:59]
    s_waitcnt vmcnt(4)
    s_waitcnt lgkmcnt(4)
    v_mfma_f32_16x16x32_bf16 v[4:7], v[208:211], v[68:71], v[4:7]
    v_mfma_f32_16x16x32_bf16 v[8:11], v[208:211], v[72:75], v[8:11]
    ds_read_b64_tr_b16 v[224:225], v248 offset:36864
    v_mfma_f32_16x16x32_bf16 v[12:15], v[208:211], v[76:79], v[12:15]
    ds_read_b64_tr_b16 v[226:227], v248 offset:37376
    v_mfma_f32_16x16x32_bf16 v[16:19], v[208:211], v[80:83], v[16:19]
    ds_read_b64_tr_b16 v[228:229], v249 offset:36864
    v_mfma_f32_16x16x32_bf16 v[20:23], v[212:215], v[68:71], v[20:23]
    ds_read_b64_tr_b16 v[230:231], v249 offset:37376
    v_mfma_f32_16x16x32_bf16 v[24:27], v[212:215], v[72:75], v[24:27]
    v_mfma_f32_16x16x32_bf16 v[28:31], v[212:215], v[76:79], v[28:31]
    v_mfma_f32_16x16x32_bf16 v[32:35], v[212:215], v[80:83], v[32:35]
    s_waitcnt lgkmcnt(4)
    v_mfma_f32_16x16x32_bf16 v[36:39], v[216:219], v[68:71], v[36:39]
    v_mfma_f32_16x16x32_bf16 v[40:43], v[216:219], v[72:75], v[40:43]
    ds_read_b64_tr_b16 v[208:209], v198 offset:36864
    v_mfma_f32_16x16x32_bf16 v[44:47], v[216:219], v[76:79], v[44:47]
    ds_read_b64_tr_b16 v[210:211], v198 offset:37376
    v_mfma_f32_16x16x32_bf16 v[48:51], v[216:219], v[80:83], v[48:51]
    ds_read_b64_tr_b16 v[212:213], v199 offset:36864
    v_mfma_f32_16x16x32_bf16 v[52:55], v[220:223], v[68:71], v[52:55]
    ds_read_b64_tr_b16 v[214:215], v199 offset:37376
    v_mfma_f32_16x16x32_bf16 v[56:59], v[220:223], v[72:75], v[56:59]
    s_waitcnt vmcnt(0)
    s_waitcnt lgkmcnt(4)
    v_mfma_f32_16x16x32_bf16 v[4:7], v[224:227], v[84:87], v[4:7]
    v_mfma_f32_16x16x32_bf16 v[8:11], v[224:227], v[88:91], v[8:11]
    v_mfma_f32_16x16x32_bf16 v[12:15], v[224:227], v[92:95], v[12:15]
    v_mfma_f32_16x16x32_bf16 v[16:19], v[224:227], v[96:99], v[16:19]
    v_mfma_f32_16x16x32_bf16 v[20:23], v[228:231], v[84:87], v[20:23]
    v_mfma_f32_16x16x32_bf16 v[24:27], v[228:231], v[88:91], v[24:27]
    v_mfma_f32_16x16x32_bf16 v[28:31], v[228:231], v[92:95], v[28:31]
    v_mfma_f32_16x16x32_bf16 v[32:35], v[228:231], v[96:99], v[32:35]
    s_waitcnt lgkmcnt(0)
    v_mfma_f32_16x16x32_bf16 v[36:39], v[208:211], v[84:87], v[36:39]
    v_mfma_f32_16x16x32_bf16 v[40:43], v[208:211], v[88:91], v[40:43]
    v_mfma_f32_16x16x32_bf16 v[44:47], v[208:211], v[92:95], v[44:47]
    v_mfma_f32_16x16x32_bf16 v[48:51], v[208:211], v[96:99], v[48:51]
    v_mfma_f32_16x16x32_bf16 v[52:55], v[212:215], v[84:87], v[52:55]
    v_mfma_f32_16x16x32_bf16 v[56:59], v[212:215], v[88:91], v[56:59]
    s_waitcnt vmcnt(0)
    v_lshlrev_b32 v68, 16, v232
    v_and_b32 v69, 0xffff0000, v232
    v_lshlrev_b32 v70, 16, v233
    v_and_b32 v71, 0xffff0000, v233
    v_lshlrev_b32 v72, 16, v234
    v_and_b32 v73, 0xffff0000, v234
    v_lshlrev_b32 v74, 16, v235
    v_and_b32 v75, 0xffff0000, v235
    v_lshlrev_b32 v76, 16, v236
    v_and_b32 v77, 0xffff0000, v236
    v_lshlrev_b32 v78, 16, v237
    v_and_b32 v79, 0xffff0000, v237
    v_lshlrev_b32 v80, 16, v238
    v_and_b32 v81, 0xffff0000, v238
    v_lshlrev_b32 v82, 16, v239
    v_and_b32 v83, 0xffff0000, v239
    s_mov_b32 s81, 0x3dd2d3e8
    v_mov_b32 v2, 0x40135761
    s_cmp_lg_u32 s3, 0
    s_cbranch_scc1 L_p1_63
    s_mov_b32 s72, 200000
    s_branch L_pc_67
L_pt_65:
    buffer_load_dword v197, v253, s[12:15], s55 offen offset:516 sc1
    s_waitcnt vmcnt(0)
L_pc_67:
    v_readfirstlane_b32 s73, v197
    s_nop 0
    s_cmp_lt_u32 s73, 9
    s_cbranch_scc1 L_ps_66
L_pd_64:
    v_mov_b32 v1, 1
    s_mov_b64 exec, 1
    ds_add_u32 v255, v1 offset:76
    s_mov_b64 exec, -1
L_p1_63:
    s_mov_b32 s72, 1600000
L_lw_68:
    ds_read_b32 v1, v255 offset:76
    s_waitcnt lgkmcnt(0)
    v_readfirstlane_b32 s73, v1
    s_nop 0
    s_cmp_ge_u32 s73, 1
    s_cbranch_scc1 L_ld_69
    s_sleep 4
    s_sub_u32 s72, s72, 1
    s_cbranch_scc0 L_lw_68
L_ld_69:
    v_and_b32 v1, 31, v0
    v_subrev_u32 v1, 29, v1
    v_cmp_gt_u32 vcc, 2, v1
    v_mov_b32 v1, 1073741824
    s_nop 0
    v_cndmask_b32 v1, v250, v1, vcc
    s_mul_i32 s72, s3, 7168
    s_add_u32 s73, s72, 90112
    s_add_u32 m0, s72, 131072
    s_nop 0
    buffer_load_dwordx4 v1, s[12:15], s73 offen offset:0 sc1 lds
    buffer_load_dwordx4 v1, s[12:15], s73 offen offset:1024 sc1 lds
    buffer_load_dwordx4 v1, s[12:15], s73 offen offset:2048 sc1 lds
    buffer_load_dwordx4 v1, s[12:15], s73 offen offset:3072 sc1 lds
    s_add_u32 s73, s72, 94208
    s_add_u32 m0, s72, 135168
    s_nop 0
    buffer_load_dwordx4 v1, s[12:15], s73 offen offset:0 sc1 lds
    buffer_load_dwordx4 v1, s[12:15], s73 offen offset:1024 sc1 lds
    buffer_load_dwordx4 v1, s[12:15], s73 offen offset:2048 sc1 lds
    v_mul_f32 v100, v4, v4
    v_mul_f32 v101, v5, v5
    v_mul_f32 v102, v6, v6
    v_mul_f32 v103, v7, v7
    v_fma_f32 v100, v100, s81, v2
    v_fma_f32 v101, v101, s81, v2
    v_fma_f32 v102, v102, s81, v2
    v_fma_f32 v103, v103, s81, v2
    v_mul_f32 v100, v100, v4
    v_mul_f32 v101, v101, v5
    v_mul_f32 v102, v102, v6
    v_mul_f32 v103, v103, v7
    v_exp_f32 v100, -v100
    v_exp_f32 v101, -v101
    v_exp_f32 v102, -v102
    v_exp_f32 v103, -v103
    v_mul_f32 v4, v4, v68
    v_mul_f32 v5, v5, v69
    v_mul_f32 v6, v6, v70
    v_mul_f32 v7, v7, v71
    v_add_f32 v100, 1.0, v100
    v_add_f32 v101, 1.0, v101
    v_add_f32 v102, 1.0, v102
    v_add_f32 v103, 1.0, v103
    v_rcp_f32 v100, v100
    v_rcp_f32 v101, v101
    v_rcp_f32 v102, v102
    v_rcp_f32 v103, v103
    v_mul_f32 v116, v4, v100
    v_fmac_f32 v116, v5, v101
    v_fmac_f32 v116, v6, v102
    v_fmac_f32 v116, v7, v103
    s_setprio 1
    v_mul_f32 v100, v8, v8
    v_mul_f32 v101, v9, v9
    v_mul_f32 v102, v10, v10
    v_mul_f32 v103, v11, v11
    v_fma_f32 v100, v100, s81, v2
    v_fma_f32 v101, v101, s81, v2
    v_fma_f32 v102, v102, s81, v2
    v_fma_f32 v103, v103, s81, v2
    v_mul_f32 v100, v100, v8
    v_mul_f32 v101, v101, v9
    v_mul_f32 v102, v102, v10
    v_mul_f32 v103, v103, v11
    v_exp_f32 v100, -v100
    v_exp_f32 v101, -v101
    v_exp_f32 v102, -v102
    v_exp_f32 v103, -v103
    v_mul_f32 v8, v8, v68
    v_mul_f32 v9, v9, v69
    v_mul_f32 v10, v10, v70
    v_mul_f32 v11, v11, v71
    v_add_f32 v100, 1.0, v100
    v_add_f32 v101, 1.0, v101
    v_add_f32 v102, 1.0, v102
    v_add_f32 v103, 1.0, v103
    v_rcp_f32 v100, v100
    v_rcp_f32 v101, v101
    v_rcp_f32 v102, v102
    v_rcp_f32 v103, v103
    v_mul_f32 v117, v8, v100
    v_fmac_f32 v117, v9, v101
    v_fmac_f32 v117, v10, v102
    v_fmac_f32 v117, v11, v103
    v_mul_f32 v100, v12, v12
    v_mul_f32 v101, v13, v13
    v_mul_f32 v102, v14, v14
    v_mul_f32 v103, v15, v15
    v_fma_f32 v100, v100, s81, v2
    v_fma_f32 v101, v101, s81, v2
    v_fma_f32 v102, v102, s81, v2
    v_fma_f32 v103, v103, s81, v2
    v_mul_f32 v100, v100, v12
    v_mul_f32 v101, v101, v13
    v_mul_f32 v102, v102, v14
    v_mul_f32 v103, v103, v15
    v_exp_f32 v100, -v100
    v_exp_f32 v101, -v101
    v_exp_f32 v102, -v102
    v_exp_f32 v103, -v103
    v_mul_f32 v12, v12, v68
    v_mul_f32 v13, v13, v69
    v_mul_f32 v14, v14, v70
    v_mul_f32 v15, v15, v71
    v_add_f32 v100, 1.0, v100
    v_add_f32 v101, 1.0, v101
    v_add_f32 v102, 1.0, v102
    v_add_f32 v103, 1.0, v103
    v_rcp_f32 v100, v100
    v_rcp_f32 v101, v101
    v_rcp_f32 v102, v102
    v_rcp_f32 v103, v103
    v_mul_f32 v118, v12, v100
    v_fmac_f32 v118, v13, v101
    v_fmac_f32 v118, v14, v102
    v_fmac_f32 v118, v15, v103
    s_waitcnt vmcnt(0)
    v_mov_b32 v1, 1
    s_mov_b64 exec, 1
    ds_add_u32 v255, v1 offset:28
    s_mov_b64 exec, -1
    v_mul_f32 v100, v16, v16
    v_mul_f32 v101, v17, v17
    v_mul_f32 v102, v18, v18
    v_mul_f32 v103, v19, v19
    v_fma_f32 v100, v100, s81, v2
    v_fma_f32 v101, v101, s81, v2
    v_fma_f32 v102, v102, s81, v2
    v_fma_f32 v103, v103, s81, v2
    v_mul_f32 v100, v100, v16
    v_mul_f32 v101, v101, v17
    v_mul_f32 v102, v102, v18
    v_mul_f32 v103, v103, v19
    v_exp_f32 v100, -v100
    v_exp_f32 v101, -v101
    v_exp_f32 v102, -v102
    v_exp_f32 v103, -v103
    v_mul_f32 v16, v16, v68
    v_mul_f32 v17, v17, v69
    v_mul_f32 v18, v18, v70
    v_mul_f32 v19, v19, v71
    v_add_f32 v100, 1.0, v100
    v_add_f32 v101, 1.0, v101
    v_add_f32 v102, 1.0, v102
    v_add_f32 v103, 1.0, v103
    v_rcp_f32 v100, v100
    v_rcp_f32 v101, v101
    v_rcp_f32 v102, v102
    v_rcp_f32 v103, v103
    v_mul_f32 v119, v16, v100
    v_fmac_f32 v119, v17, v101
    v_fmac_f32 v119, v18, v102
    v_fmac_f32 v119, v19, v103
    v_mul_f32 v100, v20, v20
    v_mul_f32 v101, v21, v21
    v_mul_f32 v102, v22, v22
    v_mul_f32 v103, v23, v23
    v_fma_f32 v100, v100, s81, v2
    v_fma_f32 v101, v101, s81, v2
    v_fma_f32 v102, v102, s81, v2
    v_fma_f32 v103, v103, s81, v2
    v_mul_f32 v100, v100, v20
    v_mul_f32 v101, v101, v21
    v_mul_f32 v102, v102, v22
    v_mul_f32 v103, v103, v23
    v_exp_f32 v100, -v100
    v_exp_f32 v101, -v101
    v_exp_f32 v102, -v102
    v_exp_f32 v103, -v103
    v_mul_f32 v20, v20, v72
    v_mul_f32 v21, v21, v73
    v_mul_f32 v22, v22, v74
    v_mul_f32 v23, v23, v75
    v_add_f32 v100, 1.0, v100
    v_add_f32 v101, 1.0, v101
    v_add_f32 v102, 1.0, v102
    v_add_f32 v103, 1.0, v103
    v_rcp_f32 v100, v100
    v_rcp_f32 v101, v101
    v_rcp_f32 v102, v102
    v_rcp_f32 v103, v103
    v_fmac_f32 v116, v20, v100
    v_fmac_f32 v116, v21, v101
    v_fmac_f32 v116, v22, v102
    v_fmac_f32 v116, v23, v103
    v_mul_f32 v100, v24, v24
    v_mul_f32 v101, v25, v25
    v_mul_f32 v102, v26, v26
    v_mul_f32 v103, v27, v27
    v_fma_f32 v100, v100, s81, v2
    v_fma_f32 v101, v101, s81, v2
    v_fma_f32 v102, v102, s81, v2
    v_fma_f32 v103, v103, s81, v2
    v_mul_f32 v100, v100, v24
    v_mul_f32 v101, v101, v25
    v_mul_f32 v102, v102, v26
    v_mul_f32 v103, v103, v27
    v_exp_f32 v100, -v100
    v_exp_f32 v101, -v101
    v_exp_f32 v102, -v102
    v_exp_f32 v103, -v103
    v_mul_f32 v24, v24, v72
    v_mul_f32 v25, v25, v73
    v_mul_f32 v26, v26, v74
    v_mul_f32 v27, v27, v75
    v_add_f32 v100, 1.0, v100
    v_add_f32 v101, 1.0, v101
    v_add_f32 v102, 1.0, v102
    v_add_f32 v103, 1.0, v103
    v_rcp_f32 v100, v100
    v_rcp_f32 v101, v101
    v_rcp_f32 v102, v102
    v_rcp_f32 v103, v103
    v_fmac_f32 v117, v24, v100
    v_fmac_f32 v117, v25, v101
    v_fmac_f32 v117, v26, v102
    v_fmac_f32 v117, v27, v103
    v_mul_f32 v100, v28, v28
    v_mul_f32 v101, v29, v29
    v_mul_f32 v102, v30, v30
    v_mul_f32 v103, v31, v31
    v_fma_f32 v100, v100, s81, v2
    v_fma_f32 v101, v101, s81, v2
    v_fma_f32 v102, v102, s81, v2
    v_fma_f32 v103, v103, s81, v2
    v_mul_f32 v100, v100, v28
    v_mul_f32 v101, v101, v29
    v_mul_f32 v102, v102, v30
    v_mul_f32 v103, v103, v31
    v_exp_f32 v100, -v100
    v_exp_f32 v101, -v101
    v_exp_f32 v102, -v102
    v_exp_f32 v103, -v103
    v_mul_f32 v28, v28, v72
    v_mul_f32 v29, v29, v73
    v_mul_f32 v30, v30, v74
    v_mul_f32 v31, v31, v75
    v_add_f32 v100, 1.0, v100
    v_add_f32 v101, 1.0, v101
    v_add_f32 v102, 1.0, v102
    v_add_f32 v103, 1.0, v103
    v_rcp_f32 v100, v100
    v_rcp_f32 v101, v101
    v_rcp_f32 v102, v102
    v_rcp_f32 v103, v103
    v_fmac_f32 v118, v28, v100
    v_fmac_f32 v118, v29, v101
    v_fmac_f32 v118, v30, v102
    v_fmac_f32 v118, v31, v103
    v_mul_f32 v100, v32, v32
    v_mul_f32 v101, v33, v33
    v_mul_f32 v102, v34, v34
    v_mul_f32 v103, v35, v35
    v_fma_f32 v100, v100, s81, v2
    v_fma_f32 v101, v101, s81, v2
    v_fma_f32 v102, v102, s81, v2
    v_fma_f32 v103, v103, s81, v2
    v_mul_f32 v100, v100, v32
    v_mul_f32 v101, v101, v33
    v_mul_f32 v102, v102, v34
    v_mul_f32 v103, v103, v35
    v_exp_f32 v100, -v100
    v_exp_f32 v101, -v101
    v_exp_f32 v102, -v102
    v_exp_f32 v103, -v103
    v_mul_f32 v32, v32, v72
    v_mul_f32 v33, v33, v73
    v_mul_f32 v34, v34, v74
    v_mul_f32 v35, v35, v75
    v_add_f32 v100, 1.0, v100
    v_add_f32 v101, 1.0, v101
    v_add_f32 v102, 1.0, v102
    v_add_f32 v103, 1.0, v103
    v_rcp_f32 v100, v100
    v_rcp_f32 v101, v101
    v_rcp_f32 v102, v102
    v_rcp_f32 v103, v103
    v_fmac_f32 v119, v32, v100
    v_fmac_f32 v119, v33, v101
    v_fmac_f32 v119, v34, v102
    v_fmac_f32 v119, v35, v103
    v_mul_f32 v100, v36, v36
    v_mul_f32 v101, v37, v37
    v_mul_f32 v102, v38, v38
    v_mul_f32 v103, v39, v39
    v_fma_f32 v100, v100, s81, v2
    v_fma_f32 v101, v101, s81, v2
    v_fma_f32 v102, v102, s81, v2
    v_fma_f32 v103, v103, s81, v2
    v_mul_f32 v100, v100, v36
    v_mul_f32 v101, v101, v37
    v_mul_f32 v102, v102, v38
    v_mul_f32 v103, v103, v39
    v_exp_f32 v100, -v100
    v_exp_f32 v101, -v101
    v_exp_f32 v102, -v102
    v_exp_f32 v103, -v103
    v_mul_f32 v36, v36, v76
    v_mul_f32 v37, v37, v77
    v_mul_f32 v38, v38, v78
    v_mul_f32 v39, v39, v79
    v_add_f32 v100, 1.0, v100
    v_add_f32 v101, 1.0, v101
    v_add_f32 v102, 1.0, v102
    v_add_f32 v103, 1.0, v103
    v_rcp_f32 v100, v100
    v_rcp_f32 v101, v101
    v_rcp_f32 v102, v102
    v_rcp_f32 v103, v103
    v_fmac_f32 v116, v36, v100
    v_fmac_f32 v116, v37, v101
    v_fmac_f32 v116, v38, v102
    v_fmac_f32 v116, v39, v103
    v_mul_f32 v100, v40, v40
    v_mul_f32 v101, v41, v41
    v_mul_f32 v102, v42, v42
    v_mul_f32 v103, v43, v43
    v_fma_f32 v100, v100, s81, v2
    v_fma_f32 v101, v101, s81, v2
    v_fma_f32 v102, v102, s81, v2
    v_fma_f32 v103, v103, s81, v2
    v_mul_f32 v100, v100, v40
    v_mul_f32 v101, v101, v41
    v_mul_f32 v102, v102, v42
    v_mul_f32 v103, v103, v43
    v_exp_f32 v100, -v100
    v_exp_f32 v101, -v101
    v_exp_f32 v102, -v102
    v_exp_f32 v103, -v103
    v_mul_f32 v40, v40, v76
    v_mul_f32 v41, v41, v77
    v_mul_f32 v42, v42, v78
    v_mul_f32 v43, v43, v79
    v_add_f32 v100, 1.0, v100
    v_add_f32 v101, 1.0, v101
    v_add_f32 v102, 1.0, v102
    v_add_f32 v103, 1.0, v103
    v_rcp_f32 v100, v100
    v_rcp_f32 v101, v101
    v_rcp_f32 v102, v102
    v_rcp_f32 v103, v103
    v_fmac_f32 v117, v40, v100
    v_fmac_f32 v117, v41, v101
    v_fmac_f32 v117, v42, v102
    v_fmac_f32 v117, v43, v103
    v_mul_f32 v100, v44, v44
    v_mul_f32 v101, v45, v45
    v_mul_f32 v102, v46, v46
    v_mul_f32 v103, v47, v47
    v_fma_f32 v100, v100, s81, v2
    v_fma_f32 v101, v101, s81, v2
    v_fma_f32 v102, v102, s81, v2
    v_fma_f32 v103, v103, s81, v2
    v_mul_f32 v100, v100, v44
    v_mul_f32 v101, v101, v45
    v_mul_f32 v102, v102, v46
    v_mul_f32 v103, v103, v47
    v_exp_f32 v100, -v100
    v_exp_f32 v101, -v101
    v_exp_f32 v102, -v102
    v_exp_f32 v103, -v103
    v_mul_f32 v44, v44, v76
    v_mul_f32 v45, v45, v77
    v_mul_f32 v46, v46, v78
    v_mul_f32 v47, v47, v79
    v_add_f32 v100, 1.0, v100
    v_add_f32 v101, 1.0, v101
    v_add_f32 v102, 1.0, v102
    v_add_f32 v103, 1.0, v103
    v_rcp_f32 v100, v100
    v_rcp_f32 v101, v101
    v_rcp_f32 v102, v102
    v_rcp_f32 v103, v103
    v_fmac_f32 v118, v44, v100
    v_fmac_f32 v118, v45, v101
    v_fmac_f32 v118, v46, v102
    v_fmac_f32 v118, v47, v103
    v_mul_f32 v100, v48, v48
    v_mul_f32 v101, v49, v49
    v_mul_f32 v102, v50, v50
    v_mul_f32 v103, v51, v51
    v_fma_f32 v100, v100, s81, v2
    v_fma_f32 v101, v101, s81, v2
    v_fma_f32 v102, v102, s81, v2
    v_fma_f32 v103, v103, s81, v2
    v_mul_f32 v100, v100, v48
    v_mul_f32 v101, v101, v49
    v_mul_f32 v102, v102, v50
    v_mul_f32 v103, v103, v51
    v_exp_f32 v100, -v100
    v_exp_f32 v101, -v101
    v_exp_f32 v102, -v102
    v_exp_f32 v103, -v103
    v_mul_f32 v48, v48, v76
    v_mul_f32 v49, v49, v77
    v_mul_f32 v50, v50, v78
    v_mul_f32 v51, v51, v79
    v_add_f32 v100, 1.0, v100
    v_add_f32 v101, 1.0, v101
    v_add_f32 v102, 1.0, v102
    v_add_f32 v103, 1.0, v103
    v_rcp_f32 v100, v100
    v_rcp_f32 v101, v101
    v_rcp_f32 v102, v102
    v_rcp_f32 v103, v103
    v_fmac_f32 v119, v48, v100
    v_fmac_f32 v119, v49, v101
    v_fmac_f32 v119, v50, v102
    v_fmac_f32 v119, v51, v103
    v_mul_f32 v100, v52, v52
    v_mul_f32 v101, v53, v53
    v_mul_f32 v102, v54, v54
    v_mul_f32 v103, v55, v55
    v_fma_f32 v100, v100, s81, v2
    v_fma_f32 v101, v101, s81, v2
    v_fma_f32 v102, v102, s81, v2
    v_fma_f32 v103, v103, s81, v2
    v_mul_f32 v100, v100, v52
    v_mul_f32 v101, v101, v53
    v_mul_f32 v102, v102, v54
    v_mul_f32 v103, v103, v55
    v_exp_f32 v100, -v100
    v_exp_f32 v101, -v101
    v_exp_f32 v102, -v102
    v_exp_f32 v103, -v103
    v_mul_f32 v52, v52, v80
    v_mul_f32 v53, v53, v81
    v_mul_f32 v54, v54, v82
    v_mul_f32 v55, v55, v83
    v_add_f32 v100, 1.0, v100
    v_add_f32 v101, 1.0, v101
    v_add_f32 v102, 1.0, v102
    v_add_f32 v103, 1.0, v103
    v_rcp_f32 v100, v100
    v_rcp_f32 v101, v101
    v_rcp_f32 v102, v102
    v_rcp_f32 v103, v103
    v_fmac_f32 v116, v52, v100
    v_fmac_f32 v116, v53, v101
    v_fmac_f32 v116, v54, v102
    v_fmac_f32 v116, v55, v103
    v_mul_f32 v100, v56, v56
    v_mul_f32 v101, v57, v57
    v_mul_f32 v102, v58, v58
    v_mul_f32 v103, v59, v59
    v_fma_f32 v100, v100, s81, v2
    v_fma_f32 v101, v101, s81, v2
    v_fma_f32 v102, v102, s81, v2
    v_fma_f32 v103, v103, s81, v2
    v_mul_f32 v100, v100, v56
    v_mul_f32 v101, v101, v57
    v_mul_f32 v102, v102, v58
    v_mul_f32 v103, v103, v59
    v_exp_f32 v100, -v100
    v_exp_f32 v101, -v101
    v_exp_f32 v102, -v102
    v_exp_f32 v103, -v103
    v_mul_f32 v56, v56, v80
    v_mul_f32 v57, v57, v81
    v_mul_f32 v58, v58, v82
    v_mul_f32 v59, v59, v83
    v_add_f32 v100, 1.0, v100
    v_add_f32 v101, 1.0, v101
    v_add_f32 v102, 1.0, v102
    v_add_f32 v103, 1.0, v103
    v_rcp_f32 v100, v100
    v_rcp_f32 v101, v101
    v_rcp_f32 v102, v102
    v_rcp_f32 v103, v103
    v_fmac_f32 v117, v56, v100
    v_fmac_f32 v117, v57, v101
    v_fmac_f32 v117, v58, v102
    v_fmac_f32 v117, v59, v103
    s_setprio 3
    v_permlane32_swap_b32 v116, v118
    v_permlane32_swap_b32 v117, v119
    v_add_f32 v116, v116, v118
    v_add_f32 v117, v117, v119
    s_nop 1
    v_permlane16_swap_b32 v116, v117
    v_add_f32 v116, v116, v117
    v_min_u32 v116, -2, v116
    s_lshl_b32 s72, s51, 7
    v_lshlrev_b32 v1, 2, v0
    v_xor_b32 v1, s72, v1
    buffer_store_dword v116, v1, s[12:15], s54 offen sc1
    s_endpgm
L_helper_n:
    s_add_u32 s48, s70, 16
    s_cmp_ge_u32 s48, 31
    s_cbranch_scc1 L_j2d
    s_call_b64 s[66:67], L_pe1
L_nc_70:
    s_cmp_lt_u32 s48, 22
    s_cbranch_scc1 L_noql
    v_and_b32 v2, 31, v0
    v_lshrrev_b32 v3, 5, v0
    v_mul_u32_u24 v1, 676, v3
    v_add_lshl_u32 v1, v1, v2, 1
    s_mul_i32 s72, s50, 52
    s_add_u32 s72, s72, 140608
    buffer_load_ushort v108, v1, s[56:59], s72 offen
    s_add_u32 s72, s72, 2704
    buffer_load_ushort v109, v1, s[56:59], s72 offen
    s_add_u32 s72, s72, 2704
    buffer_load_ushort v110, v1, s[56:59], s72 offen
    s_add_u32 s72, s72, 2704
    buffer_load_ushort v111, v1, s[56:59], s72 offen
    s_add_u32 s72, s72, 2704
    buffer_load_ushort v112, v1, s[56:59], s72 offen
    s_add_u32 s72, s72, 2704
    buffer_load_ushort v113, v1, s[56:59], s72 offen
    s_add_u32 s72, s72, 2704
    buffer_load_ushort v114, v1, s[56:59], s72 offen
    s_add_u32 s72, s72, 2704
    buffer_load_ushort v115, v1, s[56:59], s72 offen
    s_add_u32 s72, s72, 2704
    buffer_load_ushort v116, v1, s[56:59], s72 offen
    s_add_u32 s72, s72, 2704
    buffer_load_ushort v117, v1, s[56:59], s72 offen
    s_add_u32 s72, s72, 2704
    buffer_load_ushort v118, v1, s[56:59], s72 offen
    s_add_u32 s72, s72, 2704
    buffer_load_ushort v119, v1, s[56:59], s72 offen
    s_add_u32 s72, s72, 2704
    buffer_load_ushort v120, v1, s[56:59], s72 offen
    s_add_u32 s72, s72, 2704
    s_cmp_eq_u32 s48, 29
    s_cselect_b32 s63, 4, 5
    s_cmp_eq_u32 s48, 30
    s_cselect_b32 s63, 0, s63
    s_mul_i32 s53, s63, 35152
    s_add_u32 s58, s53, 35152
    v_lshlrev_b32 v1, 1, v0
    v_cmp_lt_u32 vcc, 25, v0
    v_mov_b32 v2, 1073741824
    s_nop 0
    v_cndmask_b32 v1, v1, v2, vcc
    s_mul_i32 s72, s63, 52
    buffer_load_ushort v121, v1, s[44:47], s72 offen
    v_lshlrev_b32 v1, 4, v0
    s_mul_i32 s72, s3, 1352
    s_add_u32 s72, s72, s53
    buffer_load_dwordx4 v[180:183], v1, s[56:59], s72 offen offset:0
    buffer_load_dwordx4 v[184:187], v1, s[56:59], s72 offen offset:1024
    s_add_u32 s72, s72, 5408
    buffer_load_dwordx4 v[188:191], v1, s[56:59], s72 offen offset:0
    buffer_load_dwordx4 v[192:195], v1, s[56:59], s72 offen offset:1024
    s_add_u32 s72, s72, 5408
    buffer_load_dwordx4 v[196:199], v1, s[56:59], s72 offen offset:0
    buffer_load_dwordx4 v[200:203], v1, s[56:59], s72 offen offset:1024
    s_add_u32 s72, s72, 5408
    buffer_load_dwordx4 v[204:207], v1, s[56:59], s72 offen offset:0
    buffer_load_dwordx4 v[208:211], v1, s[56:59], s72 offen offset:1024
    s_add_u32 s72, s72, 5408
    buffer_load_dwordx4 v[212:215], v1, s[56:59], s72 offen offset:0
    buffer_load_dwordx4 v[216:219], v1, s[56:59], s72 offen offset:1024
    s_add_u32 s72, s72, 5408
    buffer_load_dwordx4 v[220:223], v1, s[56:59], s72 offen offset:0
    buffer_load_dwordx4 v[224:227], v1, s[56:59], s72 offen offset:1024
    s_add_u32 s72, s72, 5408
    buffer_load_dwordx4 v[228:231], v1, s[56:59], s72 offen offset:0
    buffer_load_dwordx4 v[232:235], v1, s[56:59], s72 offen offset:1024
    s_add_u32 s72, s72, 5408
L_noql:
    s_mov_b32 s72, 1600000
L_lw_71:
    ds_read_b32 v1, v255 offset:0
    s_waitcnt lgkmcnt(0)
    v_readfirstlane_b32 s73, v1
    s_nop 0
    s_cmp_ge_u32 s73, 4
    s_cbranch_scc1 L_ld_72
    s_sleep 4
    s_sub_u32 s72, s72, 1
    s_cbranch_scc0 L_lw_71
L_ld_72:
    s_waitcnt vmcnt(0)
    s_call_b64 s[66:67], L_pe2
L_nc_73:
L_j2d:
    s_sub_u32 s72, s70, 6
    s_cmp_lt_u32 s72, 5
    s_cbranch_scc1 L_nol3
    s_mov_b32 s74, 365056
    s_waitcnt vmcnt(0)
    v_mov_b32 v1, 1
    s_mov_b64 exec, 1
    ds_add_u32 v255, v1 offset:72
    s_mov_b64 exec, -1
    s_cmp_lg_u32 s3, 0
    s_cbranch_scc1 L_sg_74
    s_mov_b32 s72, 1600000
L_lw_75:
    ds_read_b32 v1, v255 offset:72
    s_waitcnt lgkmcnt(0)
    v_readfirstlane_b32 s73, v1
    s_nop 0
    s_cmp_ge_u32 s73, 4
    s_cbranch_scc1 L_ld_76
    s_sleep 4
    s_sub_u32 s72, s72, 1
    s_cbranch_scc0 L_lw_75
L_ld_76:
    v_mul_u32_u24 v2, 4352, v0
    v_cmp_lt_u32 vcc, 15, v0
    v_mov_b32 v3, 1073741824
    s_nop 0
    v_cndmask_b32 v2, v2, v3, vcc
    v_mov_b32 v1, 1
    buffer_atomic_add v1, v2, s[12:15], s74 offen sc1
L_sg_74:
L_nol3:
    s_cmp_ge_u32 s48, 31
    s_cbranch_scc1 L_idle
    s_cmp_ge_u32 s48, 22
    s_cbranch_scc1 L_nog
    s_branch L_idle
L_nog:
    s_mov_b32 s72, 1600000
L_lw_77:
    ds_read_b32 v1, v255 offset:120
    s_waitcnt lgkmcnt(0)
    v_readfirstlane_b32 s73, v1
    s_nop 0
    s_cmp_ge_u32 s73, 8
    s_cbranch_scc1 L_ld_78
    s_sleep 1
    s_sub_u32 s72, s72, 1
    s_cbranch_scc0 L_lw_77
L_ld_78:
    v_lshl_or_b32 v64, v109, 16, v108
    v_lshl_or_b32 v65, v111, 16, v110
    v_lshl_or_b32 v66, v113, 16, v112
    v_lshl_or_b32 v67, v115, 16, v114
    v_lshl_or_b32 v244, v117, 16, v116
    v_lshl_or_b32 v245, v119, 16, v118
    v_mov_b32 v246, v120
    v_mov_b32 v247, 0
    v_lshlrev_b32 v121, 16, v121
    v_and_b32 v1, 0x7fffffff, v121
    s_nop 1
    v_max_u32_dpp v1, v1, v1 row_ror:8 row_mask:0xf bank_mask:0xf
    s_nop 1
    v_max_u32_dpp v1, v1, v1 row_ror:4 row_mask:0xf bank_mask:0xf
    s_nop 1
    v_max_u32_dpp v1, v1, v1 row_ror:2 row_mask:0xf bank_mask:0xf
    s_nop 1
    v_max_u32_dpp v1, v1, v1 row_ror:1 row_mask:0xf bank_mask:0xf
    s_nop 0
    v_readlane_b32 s52, v1, 0
    v_readlane_b32 s72, v1, 16
    s_nop 0
    s_max_u32 s52, s52, s72
    v_readlane_b32 s72, v1, 32
    s_nop 0
    s_max_u32 s52, s52, s72
    v_readlane_b32 s72, v1, 48
    s_nop 0
    s_max_u32 s52, s52, s72
    s_lshr_b32 s52, s52, 23
    s_sub_u32 s52, s52, 126
    s_sub_u32 s72, 0, s52
    v_ldexp_f32 v121, v121, s72
    v_mov_b32 v68, 0
    v_mov_b32 v69, 0
    v_mov_b32 v70, 0
    v_mov_b32 v71, 0
    v_mov_b32 v72, 0
    v_mov_b32 v73, 0
    v_mov_b32 v74, 0
    v_mov_b32 v75, 0
    v_mov_b32 v76, 0
    v_mov_b32 v77, 0
    v_mov_b32 v78, 0
    v_mov_b32 v79, 0
    v_mov_b32 v80, 0
    v_mov_b32 v81, 0
    v_mov_b32 v82, 0
    v_mov_b32 v83, 0
    s_add_u32 s72, s3, 0
    v_readlane_b32 s73, v121, s72
    v_lshlrev_b32 v84, 16, v180
    v_and_b32 v85, 0xffff0000, v180
    v_lshlrev_b32 v86, 16, v181
    v_and_b32 v87, 0xffff0000, v181
    v_lshlrev_b32 v88, 16, v182
    v_and_b32 v89, 0xffff0000, v182
    v_lshlrev_b32 v90, 16, v183
    v_and_b32 v91, 0xffff0000, v183
    v_lshlrev_b32 v92, 16, v184
    v_and_b32 v93, 0xffff0000, v184
    v_lshlrev_b32 v94, 16, v185
    v_and_b32 v95, 0xffff0000, v185
    v_lshlrev_b32 v96, 16, v186
    v_and_b32 v97, 0xffff0000, v186
    v_lshlrev_b32 v98, 16, v187
    v_and_b32 v99, 0xffff0000, v187
    v_fmac_f32 v68, s73, v84
    v_fmac_f32 v69, s73, v85
    v_fmac_f32 v70, s73, v86
    v_fmac_f32 v71, s73, v87
    v_fmac_f32 v72, s73, v88
    v_fmac_f32 v73, s73, v89
    v_fmac_f32 v74, s73, v90
    v_fmac_f32 v75, s73, v91
    v_fmac_f32 v76, s73, v92
    v_fmac_f32 v77, s73, v93
    v_fmac_f32 v78, s73, v94
    v_fmac_f32 v79, s73, v95
    v_fmac_f32 v80, s73, v96
    v_fmac_f32 v81, s73, v97
    v_fmac_f32 v82, s73, v98
    v_fmac_f32 v83, s73, v99
    s_add_u32 s72, s3, 4
    v_readlane_b32 s73, v121, s72
    v_lshlrev_b32 v84, 16, v188
    v_and_b32 v85, 0xffff0000, v188
    v_lshlrev_b32 v86, 16, v189
    v_and_b32 v87, 0xffff0000, v189
    v_lshlrev_b32 v88, 16, v190
    v_and_b32 v89, 0xffff0000, v190
    v_lshlrev_b32 v90, 16, v191
    v_and_b32 v91, 0xffff0000, v191
    v_lshlrev_b32 v92, 16, v192
    v_and_b32 v93, 0xffff0000, v192
    v_lshlrev_b32 v94, 16, v193
    v_and_b32 v95, 0xffff0000, v193
    v_lshlrev_b32 v96, 16, v194
    v_and_b32 v97, 0xffff0000, v194
    v_lshlrev_b32 v98, 16, v195
    v_and_b32 v99, 0xffff0000, v195
    v_fmac_f32 v68, s73, v84
    v_fmac_f32 v69, s73, v85
    v_fmac_f32 v70, s73, v86
    v_fmac_f32 v71, s73, v87
    v_fmac_f32 v72, s73, v88
    v_fmac_f32 v73, s73, v89
    v_fmac_f32 v74, s73, v90
    v_fmac_f32 v75, s73, v91
    v_fmac_f32 v76, s73, v92
    v_fmac_f32 v77, s73, v93
    v_fmac_f32 v78, s73, v94
    v_fmac_f32 v79, s73, v95
    v_fmac_f32 v80, s73, v96
    v_fmac_f32 v81, s73, v97
    v_fmac_f32 v82, s73, v98
    v_fmac_f32 v83, s73, v99
    s_add_u32 s72, s3, 8
    v_readlane_b32 s73, v121, s72
    v_lshlrev_b32 v84, 16, v196
    v_and_b32 v85, 0xffff0000, v196
    v_lshlrev_b32 v86, 16, v197
    v_and_b32 v87, 0xffff0000, v197
    v_lshlrev_b32 v88, 16, v198
    v_and_b32 v89, 0xffff0000, v198
    v_lshlrev_b32 v90, 16, v199
    v_and_b32 v91, 0xffff0000, v199
    v_lshlrev_b32 v92, 16, v200
    v_and_b32 v93, 0xffff0000, v200
    v_lshlrev_b32 v94, 16, v201
    v_and_b32 v95, 0xffff0000, v201
    v_lshlrev_b32 v96, 16, v202
    v_and_b32 v97, 0xffff0000, v202
    v_lshlrev_b32 v98, 16, v203
    v_and_b32 v99, 0xffff0000, v203
    v_fmac_f32 v68, s73, v84
    v_fmac_f32 v69, s73, v85
    v_fmac_f32 v70, s73, v86
    v_fmac_f32 v71, s73, v87
    v_fmac_f32 v72, s73, v88
    v_fmac_f32 v73, s73, v89
    v_fmac_f32 v74, s73, v90
    v_fmac_f32 v75, s73, v91
    v_fmac_f32 v76, s73, v92
    v_fmac_f32 v77, s73, v93
    v_fmac_f32 v78, s73, v94
    v_fmac_f32 v79, s73, v95
    v_fmac_f32 v80, s73, v96
    v_fmac_f32 v81, s73, v97
    v_fmac_f32 v82, s73, v98
    v_fmac_f32 v83, s73, v99
    s_add_u32 s72, s3, 12
    v_readlane_b32 s73, v121, s72
    v_lshlrev_b32 v84, 16, v204
    v_and_b32 v85, 0xffff0000, v204
    v_lshlrev_b32 v86, 16, v205
    v_and_b32 v87, 0xffff0000, v205
    v_lshlrev_b32 v88, 16, v206
    v_and_b32 v89, 0xffff0000, v206
    v_lshlrev_b32 v90, 16, v207
    v_and_b32 v91, 0xffff0000, v207
    v_lshlrev_b32 v92, 16, v208
    v_and_b32 v93, 0xffff0000, v208
    v_lshlrev_b32 v94, 16, v209
    v_and_b32 v95, 0xffff0000, v209
    v_lshlrev_b32 v96, 16, v210
    v_and_b32 v97, 0xffff0000, v210
    v_lshlrev_b32 v98, 16, v211
    v_and_b32 v99, 0xffff0000, v211
    v_fmac_f32 v68, s73, v84
    v_fmac_f32 v69, s73, v85
    v_fmac_f32 v70, s73, v86
    v_fmac_f32 v71, s73, v87
    v_fmac_f32 v72, s73, v88
    v_fmac_f32 v73, s73, v89
    v_fmac_f32 v74, s73, v90
    v_fmac_f32 v75, s73, v91
    v_fmac_f32 v76, s73, v92
    v_fmac_f32 v77, s73, v93
    v_fmac_f32 v78, s73, v94
    v_fmac_f32 v79, s73, v95
    v_fmac_f32 v80, s73, v96
    v_fmac_f32 v81, s73, v97
    v_fmac_f32 v82, s73, v98
    v_fmac_f32 v83, s73, v99
    s_add_u32 s72, s3, 16
    v_readlane_b32 s73, v121, s72
    v_lshlrev_b32 v84, 16, v212
    v_and_b32 v85, 0xffff0000, v212
    v_lshlrev_b32 v86, 16, v213
    v_and_b32 v87, 0xffff0000, v213
    v_lshlrev_b32 v88, 16, v214
    v_and_b32 v89, 0xffff0000, v214
    v_lshlrev_b32 v90, 16, v215
    v_and_b32 v91, 0xffff0000, v215
    v_lshlrev_b32 v92, 16, v216
    v_and_b32 v93, 0xffff0000, v216
    v_lshlrev_b32 v94, 16, v217
    v_and_b32 v95, 0xffff0000, v217
    v_lshlrev_b32 v96, 16, v218
    v_and_b32 v97, 0xffff0000, v218
    v_lshlrev_b32 v98, 16, v219
    v_and_b32 v99, 0xffff0000, v219
    v_fmac_f32 v68, s73, v84
    v_fmac_f32 v69, s73, v85
    v_fmac_f32 v70, s73, v86
    v_fmac_f32 v71, s73, v87
    v_fmac_f32 v72, s73, v88
    v_fmac_f32 v73, s73, v89
    v_fmac_f32 v74, s73, v90
    v_fmac_f32 v75, s73, v91
    v_fmac_f32 v76, s73, v92
    v_fmac_f32 v77, s73, v93
    v_fmac_f32 v78, s73, v94
    v_fmac_f32 v79, s73, v95
    v_fmac_f32 v80, s73, v96
    v_fmac_f32 v81, s73, v97
    v_fmac_f32 v82, s73, v98
    v_fmac_f32 v83, s73, v99
    s_add_u32 s72, s3, 20
    v_readlane_b32 s73, v121, s72
    v_lshlrev_b32 v84, 16, v220
    v_and_b32 v85, 0xffff0000, v220
    v_lshlrev_b32 v86, 16, v221
    v_and_b32 v87, 0xffff0000, v221
    v_lshlrev_b32 v88, 16, v222
    v_and_b32 v89, 0xffff0000, v222
    v_lshlrev_b32 v90, 16, v223
    v_and_b32 v91, 0xffff0000, v223
    v_lshlrev_b32 v92, 16, v224
    v_and_b32 v93, 0xffff0000, v224
    v_lshlrev_b32 v94, 16, v225
    v_and_b32 v95, 0xffff0000, v225
    v_lshlrev_b32 v96, 16, v226
    v_and_b32 v97, 0xffff0000, v226
    v_lshlrev_b32 v98, 16, v227
    v_and_b32 v99, 0xffff0000, v227
    v_fmac_f32 v68, s73, v84
    v_fmac_f32 v69, s73, v85
    v_fmac_f32 v70, s73, v86
    v_fmac_f32 v71, s73, v87
    v_fmac_f32 v72, s73, v88
    v_fmac_f32 v73, s73, v89
    v_fmac_f32 v74, s73, v90
    v_fmac_f32 v75, s73, v91
    v_fmac_f32 v76, s73, v92
    v_fmac_f32 v77, s73, v93
    v_fmac_f32 v78, s73, v94
    v_fmac_f32 v79, s73, v95
    v_fmac_f32 v80, s73, v96
    v_fmac_f32 v81, s73, v97
    v_fmac_f32 v82, s73, v98
    v_fmac_f32 v83, s73, v99
    s_add_u32 s72, s3, 24
    v_readlane_b32 s73, v121, s72
    v_lshlrev_b32 v84, 16, v228
    v_and_b32 v85, 0xffff0000, v228
    v_lshlrev_b32 v86, 16, v229
    v_and_b32 v87, 0xffff0000, v229
    v_lshlrev_b32 v88, 16, v230
    v_and_b32 v89, 0xffff0000, v230
    v_lshlrev_b32 v90, 16, v231
    v_and_b32 v91, 0xffff0000, v231
    v_lshlrev_b32 v92, 16, v232
    v_and_b32 v93, 0xffff0000, v232
    v_lshlrev_b32 v94, 16, v233
    v_and_b32 v95, 0xffff0000, v233
    v_lshlrev_b32 v96, 16, v234
    v_and_b32 v97, 0xffff0000, v234
    v_lshlrev_b32 v98, 16, v235
    v_and_b32 v99, 0xffff0000, v235
    v_fmac_f32 v68, s73, v84
    v_fmac_f32 v69, s73, v85
    v_fmac_f32 v70, s73, v86
    v_fmac_f32 v71, s73, v87
    v_fmac_f32 v72, s73, v88
    v_fmac_f32 v73, s73, v89
    v_fmac_f32 v74, s73, v90
    v_fmac_f32 v75, s73, v91
    v_fmac_f32 v76, s73, v92
    v_fmac_f32 v77, s73, v93
    v_fmac_f32 v78, s73, v94
    v_fmac_f32 v79, s73, v95
    v_fmac_f32 v80, s73, v96
    v_fmac_f32 v81, s73, v97
    v_fmac_f32 v82, s73, v98
    v_fmac_f32 v83, s73, v99
    s_mul_i32 s72, s3, 4096
    s_add_u32 s72, s72, 90112
    v_lshl_add_u32 v1, v0, 5, s72
    ds_write_b128 v1, v[68:71] offset:0
    ds_write_b128 v1, v[72:75] offset:16
    ds_write_b128 v1, v[76:79] offset:2048
    ds_write_b128 v1, v[80:83] offset:2064
    s_nop 0
    v_mov_b32 v1, 1
    s_mov_b64 exec, 1
    ds_add_u32 v255, v1 offset:56
    s_mov_b64 exec, -1
    s_mov_b32 s72, 1600000
L_lw_79:
    ds_read_b32 v1, v255 offset:56
    s_waitcnt lgkmcnt(0)
    v_readfirstlane_b32 s73, v1
    s_nop 0
    s_cmp_ge_u32 s73, 4
    s_cbranch_scc1 L_ld_80
    s_sleep 1
    s_sub_u32 s72, s72, 1
    s_cbranch_scc0 L_lw_79
L_ld_80:
    s_call_b64 s[66:67], L_l2
L_nc_81:
    s_cmp_eq_u32 s50, 28
    s_cbranch_scc1 L_lin
    s_cmp_lt_u32 s50, 26
    s_cbranch_scc1 L_q
    s_cmp_lg_u32 s50, 32
    s_cbranch_scc1 L_noq
L_q:
    v_and_b32 v2, 31, v0
    v_lshrrev_b32 v3, 5, v0
    v_mad_u32_u24 v1, v3, 26, v2
    v_lshlrev_b32 v1, 2, v1
    v_add_u32 v1, 90112, v1
    ds_read_b32 v100, v1 offset:0
    ds_read_b32 v101, v1 offset:208
    ds_read_b32 v102, v1 offset:416
    ds_read_b32 v103, v1 offset:624
    ds_read_b32 v104, v1 offset:832
    ds_read_b32 v105, v1 offset:1040
    ds_read_b32 v106, v1 offset:1248
    ds_read_b32 v107, v1 offset:1456
    ds_read_b32 v108, v1 offset:1664
    ds_read_b32 v109, v1 offset:1872
    ds_read_b32 v110, v1 offset:2080
    ds_read_b32 v111, v1 offset:2288
    ds_read_b32 v112, v1 offset:2496
    ds_read_b32 v113, v1 offset:4096
    ds_read_b32 v114, v1 offset:4304
    ds_read_b32 v115, v1 offset:4512
    ds_read_b32 v116, v1 offset:4720
    ds_read_b32 v117, v1 offset:4928
    ds_read_b32 v118, v1 offset:5136
    ds_read_b32 v119, v1 offset:5344
    ds_read_b32 v120, v1 offset:5552
    ds_read_b32 v121, v1 offset:5760
    ds_read_b32 v122, v1 offset:5968
    ds_read_b32 v123, v1 offset:6176
    ds_read_b32 v124, v1 offset:6384
    ds_read_b32 v125, v1 offset:6592
    s_waitcnt lgkmcnt(13)
    ds_read_b32 v126, v1 offset:8192
    ds_read_b32 v127, v1 offset:8400
    ds_read_b32 v128, v1 offset:8608
    ds_read_b32 v129, v1 offset:8816
    ds_read_b32 v130, v1 offset:9024
    ds_read_b32 v131, v1 offset:9232
    ds_read_b32 v132, v1 offset:9440
    ds_read_b32 v133, v1 offset:9648
    ds_read_b32 v134, v1 offset:9856
    ds_read_b32 v135, v1 offset:10064
    ds_read_b32 v136, v1 offset:10272
    ds_read_b32 v137, v1 offset:10480
    ds_read_b32 v138, v1 offset:10688
    s_waitcnt lgkmcnt(13)
    ds_read_b32 v139, v1 offset:12288
    ds_read_b32 v140, v1 offset:12496
    ds_read_b32 v141, v1 offset:12704
    ds_read_b32 v142, v1 offset:12912
    ds_read_b32 v143, v1 offset:13120
    ds_read_b32 v144, v1 offset:13328
    ds_read_b32 v145, v1 offset:13536
    ds_read_b32 v146, v1 offset:13744
    ds_read_b32 v147, v1 offset:13952
    ds_read_b32 v148, v1 offset:14160
    ds_read_b32 v149, v1 offset:14368
    ds_read_b32 v150, v1 offset:14576
    ds_read_b32 v151, v1 offset:14784
    s_waitcnt lgkmcnt(13)
    s_waitcnt lgkmcnt(0)
    v_add_f32 v100, v100, v113
    v_add_f32 v126, v126, v139
    v_add_f32 v101, v101, v114
    v_add_f32 v127, v127, v140
    v_add_f32 v102, v102, v115
    v_add_f32 v128, v128, v141
    v_add_f32 v103, v103, v116
    v_add_f32 v129, v129, v142
    v_add_f32 v104, v104, v117
    v_add_f32 v130, v130, v143
    v_add_f32 v105, v105, v118
    v_add_f32 v131, v131, v144
    v_add_f32 v106, v106, v119
    v_add_f32 v132, v132, v145
    v_add_f32 v107, v107, v120
    v_add_f32 v133, v133, v146
    v_add_f32 v108, v108, v121
    v_add_f32 v134, v134, v147
    v_add_f32 v109, v109, v122
    v_add_f32 v135, v135, v148
    v_add_f32 v110, v110, v123
    v_add_f32 v136, v136, v149
    v_add_f32 v111, v111, v124
    v_add_f32 v137, v137, v150
    v_add_f32 v112, v112, v125
    v_add_f32 v138, v138, v151
    v_add_f32 v84, v100, v126
    v_add_f32 v85, v101, v127
    v_add_f32 v86, v102, v128
    v_add_f32 v87, v103, v129
    v_add_f32 v88, v104, v130
    v_add_f32 v89, v105, v131
    v_add_f32 v90, v106, v132
    v_add_f32 v91, v107, v133
    v_add_f32 v92, v108, v134
    v_add_f32 v93, v109, v135
    v_add_f32 v94, v110, v136
    v_add_f32 v95, v111, v137
    v_add_f32 v96, v112, v138
    v_cmp_gt_u32 vcc, 26, v2
    s_nop 1
    v_cndmask_b32 v84, 0, v84, vcc
    v_cndmask_b32 v85, 0, v85, vcc
    v_cndmask_b32 v86, 0, v86, vcc
    v_cndmask_b32 v87, 0, v87, vcc
    v_cndmask_b32 v88, 0, v88, vcc
    v_cndmask_b32 v89, 0, v89, vcc
    v_cndmask_b32 v90, 0, v90, vcc
    v_cndmask_b32 v91, 0, v91, vcc
    v_cndmask_b32 v92, 0, v92, vcc
    v_cndmask_b32 v93, 0, v93, vcc
    v_cndmask_b32 v94, 0, v94, vcc
    v_cndmask_b32 v95, 0, v95, vcc
    v_cndmask_b32 v96, 0, v96, vcc
    v_max3_f32 v1, |v84|, |v85|, |v86|
    v_max3_f32 v1, v1, |v87|, |v88|
    v_max3_f32 v1, v1, |v89|, |v90|
    v_max3_f32 v1, v1, |v91|, |v92|
    v_max3_f32 v1, v1, |v93|, |v94|
    v_max3_f32 v1, v1, |v95|, |v96|
    s_nop 1
    v_max_u32_dpp v1, v1, v1 row_ror:8 row_mask:0xf bank_mask:0xf
    s_nop 1
    v_max_u32_dpp v1, v1, v1 row_ror:4 row_mask:0xf bank_mask:0xf
    s_nop 1
    v_max_u32_dpp v1, v1, v1 row_ror:2 row_mask:0xf bank_mask:0xf
    s_nop 1
    v_max_u32_dpp v1, v1, v1 row_ror:1 row_mask:0xf bank_mask:0xf
    s_nop 0
    v_readlane_b32 s53, v1, 0
    v_readlane_b32 s72, v1, 16
    s_nop 0
    s_max_u32 s53, s53, s72
    v_readlane_b32 s72, v1, 32
    s_nop 0
    s_max_u32 s53, s53, s72
    v_readlane_b32 s72, v1, 48
    s_nop 0
    s_max_u32 s53, s53, s72
    s_lshr_b32 s53, s53, 23
    s_sub_u32 s53, s53, 126
    s_sub_u32 s72, 0, s53
    v_ldexp_f32 v84, v84, s72
    v_ldexp_f32 v85, v85, s72
    v_ldexp_f32 v86, v86, s72
    v_ldexp_f32 v87, v87, s72
    v_ldexp_f32 v88, v88, s72
    v_ldexp_f32 v89, v89, s72
    v_ldexp_f32 v90, v90, s72
    v_ldexp_f32 v91, v91, s72
    v_ldexp_f32 v92, v92, s72
    v_ldexp_f32 v93, v93, s72
    v_ldexp_f32 v94, v94, s72
    v_ldexp_f32 v95, v95, s72
    v_ldexp_f32 v96, v96, s72
    s_max_u32 s51, s51, 10
    s_sub_u32 s51, s51, 126
    v_mov_b32 v97, 0
    v_mov_b32 v107, 0
    v_mov_b32 v115, 0
    v_cvt_pk_bf16_f32 v100, v84, v85
    v_cvt_pk_bf16_f32 v101, v86, v87
    v_cvt_pk_bf16_f32 v102, v88, v89
    v_cvt_pk_bf16_f32 v103, v90, v91
    v_cvt_pk_bf16_f32 v104, v92, v93
    v_cvt_pk_bf16_f32 v105, v94, v95
    v_cvt_pk_bf16_f32 v106, v96, v97
    v_lshlrev_b32 v116, 16, v100
    v_and_b32 v117, 0xffff0000, v100
    v_lshlrev_b32 v118, 16, v101
    v_and_b32 v119, 0xffff0000, v101
    v_lshlrev_b32 v120, 16, v102
    v_and_b32 v121, 0xffff0000, v102
    v_lshlrev_b32 v122, 16, v103
    v_and_b32 v123, 0xffff0000, v103
    v_lshlrev_b32 v124, 16, v104
    v_and_b32 v125, 0xffff0000, v104
    v_lshlrev_b32 v126, 16, v105
    v_and_b32 v127, 0xffff0000, v105
    v_lshlrev_b32 v128, 16, v106
    v_and_b32 v129, 0xffff0000, v106
    v_sub_f32 v84, v84, v116
    v_sub_f32 v85, v85, v117
    v_sub_f32 v86, v86, v118
    v_sub_f32 v87, v87, v119
    v_sub_f32 v88, v88, v120
    v_sub_f32 v89, v89, v121
    v_sub_f32 v90, v90, v122
    v_sub_f32 v91, v91, v123
    v_sub_f32 v92, v92, v124
    v_sub_f32 v93, v93, v125
    v_sub_f32 v94, v94, v126
    v_sub_f32 v95, v95, v127
    v_sub_f32 v96, v96, v128
    v_sub_f32 v97, v97, v129
    v_cvt_pk_bf16_f32 v108, v84, v85
    v_cvt_pk_bf16_f32 v109, v86, v87
    v_cvt_pk_bf16_f32 v110, v88, v89
    v_cvt_pk_bf16_f32 v111, v90, v91
    v_cvt_pk_bf16_f32 v112, v92, v93
    v_cvt_pk_bf16_f32 v113, v94, v95
    v_cvt_pk_bf16_f32 v114, v96, v97
    s_cmp_ge_u32 s50, 13
    s_cselect_b32 s73, 13, 0
    s_cselect_b32 s74, 4, 0
    s_sub_u32 s73, s50, s73
    s_and_b32 s75, s73, 3
    s_add_u32 s74, s74, s75
    s_lshr_b32 s73, s73, 2
    s_lshl_b32 s73, s73, 3
    s_add_u32 s82, s74, s73
    s_mov_b32 s49, 0
    s_cmp_lg_u32 s50, 32
    s_cbranch_scc1 L_q2
    v_sub_u32 v1, v2, v3
    v_cmp_eq_u32 vcc, 0, v1
    s_nop 1
    v_cndmask_b32 v44, 0, 1.0, vcc
    v_cmp_eq_u32 vcc, 2, v1
    s_nop 1
    v_cndmask_b32 v45, 0, 1.0, vcc
    v_cmp_eq_u32 vcc, 4, v1
    s_nop 1
    v_cndmask_b32 v46, 0, 1.0, vcc
    v_cmp_eq_u32 vcc, 6, v1
    s_nop 1
    v_cndmask_b32 v47, 0, 1.0, vcc
    v_cmp_eq_u32 vcc, 8, v1
    s_nop 1
    v_cndmask_b32 v48, 0, 1.0, vcc
    v_cmp_eq_u32 vcc, 10, v1
    s_nop 1
    v_cndmask_b32 v49, 0, 1.0, vcc
    v_cmp_eq_u32 vcc, 12, v1
    s_nop 1
    v_cndmask_b32 v50, 0, 1.0, vcc
    v_cmp_eq_u32 vcc, 14, v1
    s_nop 1
    v_cndmask_b32 v51, 0, 1.0, vcc
    v_cmp_eq_u32 vcc, 16, v1
    s_nop 1
    v_cndmask_b32 v52, 0, 1.0, vcc
    v_cmp_eq_u32 vcc, 18, v1
    s_nop 1
    v_cndmask_b32 v53, 0, 1.0, vcc
    v_cmp_eq_u32 vcc, 20, v1
    s_nop 1
    v_cndmask_b32 v54, 0, 1.0, vcc
    v_cmp_eq_u32 vcc, 22, v1
    s_nop 1
    v_cndmask_b32 v55, 0, 1.0, vcc
    v_cmp_eq_u32 vcc, 24, v1
    s_nop 1
    v_cndmask_b32 v56, 0, 1.0, vcc
    v_mov_b32 v57, 0
    v_cvt_pk_bf16_f32 v64, v44, v45
    v_cvt_pk_bf16_f32 v65, v46, v47
    v_cvt_pk_bf16_f32 v66, v48, v49
    v_cvt_pk_bf16_f32 v67, v50, v51
    v_cvt_pk_bf16_f32 v244, v52, v53
    v_cvt_pk_bf16_f32 v245, v54, v55
    v_cvt_pk_bf16_f32 v246, v56, v57
    s_mov_b32 s51, 0
    s_mov_b32 s82, 31
    s_mov_b32 s49, 8
L_q2:
    s_nop 1
    v_mfma_f32_32x32x16_bf16 v[164:179], v[64:67], v[108:111], 0
    v_mfma_f32_32x32x16_bf16 v[164:179], v[108:111], v[64:67], v[164:179]
    v_mfma_f32_32x32x16_bf16 v[164:179], v[244:247], v[112:115], v[164:179]
    v_mfma_f32_32x32x16_bf16 v[164:179], v[112:115], v[244:247], v[164:179]
    v_mfma_f32_32x32x16_bf16 v[164:179], v[64:67], v[100:103], v[164:179]
    v_mfma_f32_32x32x16_bf16 v[164:179], v[100:103], v[64:67], v[164:179]
    v_mfma_f32_32x32x16_bf16 v[164:179], v[244:247], v[104:107], v[164:179]
    v_mfma_f32_32x32x16_bf16 v[164:179], v[104:107], v[244:247], v[164:179]
    v_max_f32 v1, v20, v21
    s_sub_u32 s72, 137, s51
    s_lshl_b32 s72, s72, 23
    v_mov_b32 v30, s72
    v_mul_f32 v31, 0.5, v30
    v_cmp_eq_f32 vcc, v1, v20
    s_nop 1
    v_cndmask_b32 v20, v31, v30, vcc
    v_cmp_eq_f32 vcc, v1, v21
    s_nop 1
    v_cndmask_b32 v21, v31, v30, vcc
    v_cmp_eq_f32 vcc, v1, v22
    s_nop 1
    v_cndmask_b32 v22, v31, v30, vcc
    v_cmp_eq_f32 vcc, v1, v23
    s_nop 1
    v_cndmask_b32 v23, v31, v30, vcc
    v_cmp_eq_f32 vcc, v1, v24
    s_nop 1
    v_cndmask_b32 v24, v31, v30, vcc
    v_cmp_eq_f32 vcc, v1, v25
    s_nop 1
    v_cndmask_b32 v25, v31, v30, vcc
    v_cmp_eq_f32 vcc, v1, v26
    s_nop 1
    v_cndmask_b32 v26, v31, v30, vcc
    s_cmp_eq_u32 s3, 1
    s_cselect_b32 s72, 48, 0
    s_sub_u32 s72, 118784, s72
    v_add_u32 v12, s72, v12
    v_add_u32 v13, s72, v13
    v_add_u32 v14, s72, v14
    v_add_u32 v15, s72, v15
    v_add_u32 v16, s72, v16
    v_add_u32 v17, s72, v17
    v_add_u32 v18, s72, v18
    v_mul_u32_u24 v1, 1040, v2
    v_lshl_add_u32 v1, v3, 9, v1
    s_lshl_b32 s72, s3, 4
    s_add_u32 s72, s72, 118784
    v_min_u32 v1, 23392, v1
    v_add_u32 v1, s72, v1
    v_lshl_add_u32 v28, v3, 9, s72
    v_mov_b32 v29, 0
    ds_write_b32 v28, v29 offset:22892
    v_mul_f32 v164, v164, v20
    v_mul_f32 v165, v165, v20
    v_mul_f32 v166, v166, v21
    v_mul_f32 v167, v167, v21
    v_mul_f32 v168, v168, v22
    v_mul_f32 v169, v169, v22
    v_mul_f32 v170, v170, v23
    v_mul_f32 v171, v171, v23
    v_mul_f32 v172, v172, v24
    v_mul_f32 v173, v173, v24
    v_mul_f32 v174, v174, v25
    v_mul_f32 v175, v175, v25
    v_mul_f32 v176, v176, v26
    v_mul_f32 v177, v177, v26
    v_cvt_pk_f16_f32 v236, v164, v165
    v_cvt_pk_f16_f32 v237, v166, v167
    v_cvt_pk_f16_f32 v238, v168, v169
    v_cvt_pk_f16_f32 v239, v170, v171
    v_cvt_pk_f16_f32 v240, v172, v173
    v_cvt_pk_f16_f32 v241, v174, v175
    v_cvt_pk_f16_f32 v242, v176, v177
    v_alignbit_b32 v236, v236, v236, v19
    v_alignbit_b32 v237, v237, v237, v19
    v_alignbit_b32 v238, v238, v238, v19
    v_alignbit_b32 v239, v239, v239, v19
    v_alignbit_b32 v240, v240, v240, v19
    v_alignbit_b32 v241, v241, v241, v19
    v_alignbit_b32 v242, v242, v242, v19
    ds_write_b32 v12, v236 offset:0
    ds_write_b32 v13, v237 offset:0
    ds_write_b32 v14, v238 offset:0
    ds_write_b32 v15, v239 offset:0
    ds_write_b32 v16, v240 offset:0
    ds_write_b32 v17, v241 offset:0
    ds_write_b32 v18, v242 offset:0
    s_waitcnt lgkmcnt(0)
    ds_read_b128 v[44:47], v1
    v_lshlrev_b32 v1, 10, v2
    v_lshl_add_u32 v1, v3, 9, v1
    v_cmp_lt_u32 vcc, 22, v2
    v_mov_b32 v28, 1073741824
    s_nop 0
    v_cndmask_b32 v1, v1, v28, vcc
    s_lshl_b32 s72, s82, 4
    s_add_u32 s72, s72, 90112
    s_waitcnt lgkmcnt(0)
    buffer_store_dwordx4 v[44:47], v1, s[12:15], s72 offen sc1
    s_add_u32 s51, s51, s53
    s_add_u32 s51, s51, s52
    s_sub_u32 s51, s51, 10
    s_and_b32 s72, s50, 31
    s_cmp_lg_u32 s72, 0
    s_cbranch_scc1 L_noq
L_qh:
    v_mov_b32 v1, s51
    s_add_u32 s72, s49, 113664
    buffer_store_dword v1, v253, s[12:15], s72 offen sc1
    s_branch L_noq
L_lin:
    v_lshrrev_b32 v3, 5, v0
    v_min_u32 v2, 25, v254
    v_mad_u32_u24 v1, v2, 26, v3
    v_lshlrev_b32 v1, 2, v1
    v_add_u32 v1, 90112, v1
    ds_read_b32 v100, v1 offset:0
    ds_read_b32 v101, v1 offset:8
    ds_read_b32 v102, v1 offset:16
    ds_read_b32 v103, v1 offset:24
    ds_read_b32 v104, v1 offset:32
    ds_read_b32 v105, v1 offset:40
    ds_read_b32 v106, v1 offset:48
    ds_read_b32 v107, v1 offset:56
    ds_read_b32 v108, v1 offset:64
    ds_read_b32 v109, v1 offset:72
    ds_read_b32 v110, v1 offset:80
    ds_read_b32 v111, v1 offset:88
    ds_read_b32 v112, v1 offset:96
    ds_read_b32 v113, v1 offset:4096
    ds_read_b32 v114, v1 offset:4104
    ds_read_b32 v115, v1 offset:4112
    ds_read_b32 v116, v1 offset:4120
    ds_read_b32 v117, v1 offset:4128
    ds_read_b32 v118, v1 offset:4136
    ds_read_b32 v119, v1 offset:4144
    ds_read_b32 v120, v1 offset:4152
    ds_read_b32 v121, v1 offset:4160
    ds_read_b32 v122, v1 offset:4168
    ds_read_b32 v123, v1 offset:4176
    ds_read_b32 v124, v1 offset:4184
    ds_read_b32 v125, v1 offset:4192
    s_waitcnt lgkmcnt(13)
    ds_read_b32 v126, v1 offset:8192
    ds_read_b32 v127, v1 offset:8200
    ds_read_b32 v128, v1 offset:8208
    ds_read_b32 v129, v1 offset:8216
    ds_read_b32 v130, v1 offset:8224
    ds_read_b32 v131, v1 offset:8232
    ds_read_b32 v132, v1 offset:8240
    ds_read_b32 v133, v1 offset:8248
    ds_read_b32 v134, v1 offset:8256
    ds_read_b32 v135, v1 offset:8264
    ds_read_b32 v136, v1 offset:8272
    ds_read_b32 v137, v1 offset:8280
    ds_read_b32 v138, v1 offset:8288
    s_waitcnt lgkmcnt(13)
    ds_read_b32 v139, v1 offset:12288
    ds_read_b32 v140, v1 offset:12296
    ds_read_b32 v141, v1 offset:12304
    ds_read_b32 v142, v1 offset:12312
    ds_read_b32 v143, v1 offset:12320
    ds_read_b32 v144, v1 offset:12328
    ds_read_b32 v145, v1 offset:12336
    ds_read_b32 v146, v1 offset:12344
    ds_read_b32 v147, v1 offset:12352
    ds_read_b32 v148, v1 offset:12360
    ds_read_b32 v149, v1 offset:12368
    ds_read_b32 v150, v1 offset:12376
    ds_read_b32 v151, v1 offset:12384
    s_waitcnt lgkmcnt(13)
    s_waitcnt lgkmcnt(0)
    v_add_f32 v100, v100, v113
    v_add_f32 v126, v126, v139
    v_add_f32 v101, v101, v114
    v_add_f32 v127, v127, v140
    v_add_f32 v102, v102, v115
    v_add_f32 v128, v128, v141
    v_add_f32 v103, v103, v116
    v_add_f32 v129, v129, v142
    v_add_f32 v104, v104, v117
    v_add_f32 v130, v130, v143
    v_add_f32 v105, v105, v118
    v_add_f32 v131, v131, v144
    v_add_f32 v106, v106, v119
    v_add_f32 v132, v132, v145
    v_add_f32 v107, v107, v120
    v_add_f32 v133, v133, v146
    v_add_f32 v108, v108, v121
    v_add_f32 v134, v134, v147
    v_add_f32 v109, v109, v122
    v_add_f32 v135, v135, v148
    v_add_f32 v110, v110, v123
    v_add_f32 v136, v136, v149
    v_add_f32 v111, v111, v124
    v_add_f32 v137, v137, v150
    v_add_f32 v112, v112, v125
    v_add_f32 v138, v138, v151
    v_add_f32 v84, v100, v126
    v_add_f32 v85, v101, v127
    v_add_f32 v86, v102, v128
    v_add_f32 v87, v103, v129
    v_add_f32 v88, v104, v130
    v_add_f32 v89, v105, v131
    v_add_f32 v90, v106, v132
    v_add_f32 v91, v107, v133
    v_add_f32 v92, v108, v134
    v_add_f32 v93, v109, v135
    v_add_f32 v94, v110, v136
    v_add_f32 v95, v111, v137
    v_add_f32 v96, v112, v138
    v_cmp_gt_u32 vcc, 26, v254
    s_nop 1
    v_cndmask_b32 v84, 0, v84, vcc
    v_cndmask_b32 v85, 0, v85, vcc
    v_cndmask_b32 v86, 0, v86, vcc
    v_cndmask_b32 v87, 0, v87, vcc
    v_cndmask_b32 v88, 0, v88, vcc
    v_cndmask_b32 v89, 0, v89, vcc
    v_cndmask_b32 v90, 0, v90, vcc
    v_cndmask_b32 v91, 0, v91, vcc
    v_cndmask_b32 v92, 0, v92, vcc
    v_cndmask_b32 v93, 0, v93, vcc
    v_cndmask_b32 v94, 0, v94, vcc
    v_cndmask_b32 v95, 0, v95, vcc
    v_cndmask_b32 v96, 0, v96, vcc
    v_max3_f32 v1, |v84|, |v85|, |v86|
    v_max3_f32 v1, v1, |v87|, |v88|
    v_max3_f32 v1, v1, |v89|, |v90|
    v_max3_f32 v1, v1, |v91|, |v92|
    v_max3_f32 v1, v1, |v93|, |v94|
    v_max3_f32 v1, v1, |v95|, |v96|
    s_nop 1
    v_max_u32_dpp v1, v1, v1 row_ror:8 row_mask:0xf bank_mask:0xf
    s_nop 1
    v_max_u32_dpp v1, v1, v1 row_ror:4 row_mask:0xf bank_mask:0xf
    s_nop 1
    v_max_u32_dpp v1, v1, v1 row_ror:2 row_mask:0xf bank_mask:0xf
    s_nop 1
    v_max_u32_dpp v1, v1, v1 row_ror:1 row_mask:0xf bank_mask:0xf
    s_nop 0
    v_readlane_b32 s53, v1, 0
    v_readlane_b32 s72, v1, 16
    s_nop 0
    s_max_u32 s53, s53, s72
    v_readlane_b32 s72, v1, 32
    s_nop 0
    s_max_u32 s53, s53, s72
    v_readlane_b32 s72, v1, 48
    s_nop 0
    s_max_u32 s53, s53, s72
    s_lshr_b32 s53, s53, 23
    s_sub_u32 s53, s53, 126
    s_sub_u32 s72, 15, s53
    v_ldexp_f32 v84, v84, s72
    v_ldexp_f32 v85, v85, s72
    v_ldexp_f32 v86, v86, s72
    v_ldexp_f32 v87, v87, s72
    v_ldexp_f32 v88, v88, s72
    v_ldexp_f32 v89, v89, s72
    v_ldexp_f32 v90, v90, s72
    v_ldexp_f32 v91, v91, s72
    v_ldexp_f32 v92, v92, s72
    v_ldexp_f32 v93, v93, s72
    v_ldexp_f32 v94, v94, s72
    v_ldexp_f32 v95, v95, s72
    v_ldexp_f32 v96, v96, s72
    v_mov_b32 v97, 0
    v_mov_b32 v51, 0
    v_cvt_pk_f16_f32 v44, v84, v85
    v_cvt_pk_f16_f32 v45, v86, v87
    v_cvt_pk_f16_f32 v46, v88, v89
    v_cvt_pk_f16_f32 v47, v90, v91
    v_cvt_pk_f16_f32 v48, v92, v93
    v_cvt_pk_f16_f32 v49, v94, v95
    v_cvt_pk_f16_f32 v50, v96, v97
    v_lshlrev_b32 v1, 4, v0
    s_mov_b32 s72, 114688
    buffer_store_dwordx4 v[44:47], v1, s[12:15], s72 offen offset:0 sc1
    buffer_store_dwordx4 v[48:51], v1, s[12:15], s72 offen offset:1024 sc1
    s_add_u32 s51, s53, s52
    s_sub_u32 s51, s51, 15
    s_mov_b32 s49, 4
    s_branch L_qh
L_noq:
    s_mov_b32 s74, 365060
    s_waitcnt vmcnt(0)
    v_mov_b32 v1, 1
    s_mov_b64 exec, 1
    ds_add_u32 v255, v1 offset:60
    s_mov_b64 exec, -1
    s_cmp_lg_u32 s3, 0
    s_cbranch_scc1 L_sg_82
    s_mov_b32 s72, 1600000
L_lw_83:
    ds_read_b32 v1, v255 offset:60
    s_waitcnt lgkmcnt(0)
    v_readfirstlane_b32 s73, v1
    s_nop 0
    s_cmp_ge_u32 s73, 4
    s_cbranch_scc1 L_ld_84
    s_sleep 1
    s_sub_u32 s72, s72, 1
    s_cbranch_scc0 L_lw_83
L_ld_84:
    v_mul_u32_u24 v2, 4352, v0
    v_cmp_lt_u32 vcc, 15, v0
    v_mov_b32 v3, 1073741824
    s_nop 0
    v_cndmask_b32 v2, v2, v3, vcc
    v_mov_b32 v1, 1
    buffer_atomic_add v1, v2, s[12:15], s74 offen sc1
L_sg_82:
    s_mov_b32 s72, 1600000
L_lw_85:
    ds_read_b32 v1, v255 offset:60
    s_waitcnt lgkmcnt(0)
    v_readfirstlane_b32 s73, v1
    s_nop 0
    s_cmp_ge_u32 s73, 4
    s_cbranch_scc1 L_ld_86
    s_sleep 1
    s_sub_u32 s72, s72, 1
    s_cbranch_scc0 L_lw_85
L_ld_86:
    s_branch L_idle2
L_l2:
    s_mov_b32 s72, 1600000
L_lw_87:
    ds_read_b32 v1, v255 offset:112
    s_waitcnt lgkmcnt(0)
    v_readfirstlane_b32 s73, v1
    s_nop 0
    s_cmp_ge_u32 s73, 4
    s_cbranch_scc1 L_ld_88
    s_sleep 4
    s_sub_u32 s72, s72, 1
    s_cbranch_scc0 L_lw_87
L_ld_88:
    s_cmp_lg_u32 s3, 0
    s_cbranch_scc1 L_p1_89
    s_mov_b32 s72, 200000
L_pt_91:
    buffer_load_dword v2, v253, s[32:35], 0 offen offset:128 sc1
    s_waitcnt vmcnt(0)
L_pc_93:
    v_readfirstlane_b32 s73, v2
    s_nop 0
    s_cmp_lt_u32 s73, 11
    s_cbranch_scc1 L_ps_92
L_pd_90:
    v_mov_b32 v1, 1
    s_mov_b64 exec, 1
    ds_add_u32 v255, v1 offset:68
    s_mov_b64 exec, -1
L_p1_89:
    s_mov_b32 s72, 1600000
L_lw_94:
    ds_read_b32 v1, v255 offset:68
    s_waitcnt lgkmcnt(0)
    v_readfirstlane_b32 s73, v1
    s_nop 0
    s_cmp_ge_u32 s73, 1
    s_cbranch_scc1 L_ld_95
    s_sleep 4
    s_sub_u32 s72, s72, 1
    s_cbranch_scc0 L_lw_94
L_ld_95:
    s_mul_i32 s72, s3, 11264
    s_add_u32 s73, s72, 0
    s_add_u32 m0, s72, 0
    s_nop 0
    buffer_load_dwordx4 v250, s[12:15], s73 offen offset:0 sc1 lds
    buffer_load_dwordx4 v250, s[12:15], s73 offen offset:1024 sc1 lds
    buffer_load_dwordx4 v250, s[12:15], s73 offen offset:2048 sc1 lds
    buffer_load_dwordx4 v250, s[12:15], s73 offen offset:3072 sc1 lds
    s_add_u32 s73, s72, 4096
    s_add_u32 m0, s72, 4096
    s_nop 0
    buffer_load_dwordx4 v250, s[12:15], s73 offen offset:0 sc1 lds
    buffer_load_dwordx4 v250, s[12:15], s73 offen offset:1024 sc1 lds
    buffer_load_dwordx4 v250, s[12:15], s73 offen offset:2048 sc1 lds
    buffer_load_dwordx4 v250, s[12:15], s73 offen offset:3072 sc1 lds
    s_add_u32 s73, s72, 8192
    s_add_u32 m0, s72, 8192
    s_nop 0
    buffer_load_dwordx4 v250, s[12:15], s73 offen offset:0 sc1 lds
    buffer_load_dwordx4 v250, s[12:15], s73 offen offset:1024 sc1 lds
    buffer_load_dwordx4 v250, s[12:15], s73 offen offset:2048 sc1 lds
    s_waitcnt vmcnt(0)
    v_mov_b32 v1, 1
    s_mov_b64 exec, 1
    ds_add_u32 v255, v1 offset:16
    s_mov_b64 exec, -1
    s_setpc_b64 s[66:67]
L_idle:
    s_call_b64 s[66:67], L_l2
L_nc_96:
L_idle2:
    s_mov_b32 s72, 1600000
L_lw_97:
    ds_read_b32 v1, v255 offset:116
    s_waitcnt lgkmcnt(0)
    v_readfirstlane_b32 s73, v1
    s_nop 0
    s_cmp_ge_u32 s73, 4
    s_cbranch_scc1 L_ld_98
    s_sleep 4
    s_sub_u32 s72, s72, 1
    s_cbranch_scc0 L_lw_97
L_ld_98:
    s_cmp_lg_u32 s3, 0
    s_cbranch_scc1 L_p1_99
    s_mov_b32 s72, 200000
L_pt_101:
    buffer_load_dword v2, v253, s[12:15], s55 offen offset:512 sc1
    s_waitcnt vmcnt(0)
L_pc_103:
    v_readfirstlane_b32 s73, v2
    s_nop 0
    s_cmp_lt_u32 s73, 11
    s_cbranch_scc1 L_ps_102
L_pd_100:
    v_mov_b32 v1, 1
    s_mov_b64 exec, 1
    ds_add_u32 v255, v1 offset:64
    s_mov_b64 exec, -1
L_p1_99:
    s_mov_b32 s72, 1600000
L_lw_104:
    ds_read_b32 v1, v255 offset:64
    s_waitcnt lgkmcnt(0)
    v_readfirstlane_b32 s73, v1
    s_nop 0
    s_cmp_ge_u32 s73, 1
    s_cbranch_scc1 L_ld_105
    s_sleep 4
    s_sub_u32 s72, s72, 1
    s_cbranch_scc0 L_lw_104
L_ld_105:
    s_mul_i32 s72, s3, 11264
    s_add_u32 s73, s72, 45056
    s_add_u32 m0, s72, 45056
    s_nop 0
    buffer_load_dwordx4 v250, s[12:15], s73 offen offset:0 sc1 lds
    buffer_load_dwordx4 v250, s[12:15], s73 offen offset:1024 sc1 lds
    buffer_load_dwordx4 v250, s[12:15], s73 offen offset:2048 sc1 lds
    buffer_load_dwordx4 v250, s[12:15], s73 offen offset:3072 sc1 lds
    s_add_u32 s73, s72, 49152
    s_add_u32 m0, s72, 49152
    s_nop 0
    buffer_load_dwordx4 v250, s[12:15], s73 offen offset:0 sc1 lds
    buffer_load_dwordx4 v250, s[12:15], s73 offen offset:1024 sc1 lds
    buffer_load_dwordx4 v250, s[12:15], s73 offen offset:2048 sc1 lds
    buffer_load_dwordx4 v250, s[12:15], s73 offen offset:3072 sc1 lds
    s_add_u32 s73, s72, 53248
    s_add_u32 m0, s72, 53248
    s_nop 0
    buffer_load_dwordx4 v250, s[12:15], s73 offen offset:0 sc1 lds
    buffer_load_dwordx4 v250, s[12:15], s73 offen offset:1024 sc1 lds
    buffer_load_dwordx4 v250, s[12:15], s73 offen offset:2048 sc1 lds
    s_waitcnt vmcnt(0)
    v_mov_b32 v1, 1
    s_mov_b64 exec, 1
    ds_add_u32 v255, v1 offset:24
    s_mov_b64 exec, -1
    s_cmp_lg_u32 s3, 0
    s_cbranch_scc1 L_p1_106
    s_mov_b32 s72, 200000
L_pt_108:
    buffer_load_dword v2, v253, s[12:15], s55 offen offset:516 sc1
    buffer_load_dword v3, v253, s[12:15], s55 offen offset:256 sc1
    s_waitcnt vmcnt(0)
L_pc_110:
    v_readfirstlane_b32 s73, v2
    s_nop 0
    s_cmp_lt_u32 s73, 9
    s_cbranch_scc1 L_ps_109
    v_readfirstlane_b32 s73, v3
    s_nop 0
    s_cmp_lt_u32 s73, 1
    s_cbranch_scc1 L_ps_109
L_pd_107:
    v_mov_b32 v1, 1
    s_mov_b64 exec, 1
    ds_add_u32 v255, v1 offset:76
    s_mov_b64 exec, -1
L_p1_106:
    s_mov_b32 s72, 1600000
L_lw_111:
    ds_read_b32 v1, v255 offset:76
    s_waitcnt lgkmcnt(0)
    v_readfirstlane_b32 s73, v1
    s_nop 0
    s_cmp_ge_u32 s73, 1
    s_cbranch_scc1 L_ld_112
    s_sleep 4
    s_sub_u32 s72, s72, 1
    s_cbranch_scc0 L_lw_111
L_ld_112:
    v_and_b32 v1, 31, v0
    v_subrev_u32 v1, 29, v1
    v_cmp_gt_u32 vcc, 2, v1
    v_mov_b32 v1, 1073741824
    s_nop 0
    v_cndmask_b32 v1, v250, v1, vcc
    s_mul_i32 s72, s3, 7168
    s_add_u32 s73, s72, 90112
    s_add_u32 m0, s72, 131072
    s_nop 0
    buffer_load_dwordx4 v1, s[12:15], s73 offen offset:0 sc1 lds
    buffer_load_dwordx4 v1, s[12:15], s73 offen offset:1024 sc1 lds
    buffer_load_dwordx4 v1, s[12:15], s73 offen offset:2048 sc1 lds
    buffer_load_dwordx4 v1, s[12:15], s73 offen offset:3072 sc1 lds
    s_add_u32 s73, s72, 94208
    s_add_u32 m0, s72, 135168
    s_nop 0
    buffer_load_dwordx4 v1, s[12:15], s73 offen offset:0 sc1 lds
    buffer_load_dwordx4 v1, s[12:15], s73 offen offset:1024 sc1 lds
    buffer_load_dwordx4 v1, s[12:15], s73 offen offset:2048 sc1 lds
    s_waitcnt vmcnt(0)
    v_mov_b32 v1, 1
    s_mov_b64 exec, 1
    ds_add_u32 v255, v1 offset:28
    s_mov_b64 exec, -1
    s_endpgm
L_gsig:
    s_waitcnt vmcnt(0)
    v_mov_b32 v1, 1
    s_mov_b64 exec, 1
    ds_add_u32 v255, v1 offset:52
    s_mov_b64 exec, -1
    s_cmp_lg_u32 s3, 0
    s_cbranch_scc1 L_xpub
    s_mov_b32 s72, 1600000
L_lw_113:
    ds_read_b32 v1, v255 offset:52
    s_waitcnt lgkmcnt(0)
    v_readfirstlane_b32 s73, v1
    s_nop 0
    s_cmp_ge_u32 s73, 4
    s_cbranch_scc1 L_ld_114
    s_sleep 1
    s_sub_u32 s72, s72, 1
    s_cbranch_scc0 L_lw_113
L_ld_114:
    v_mov_b32 v1, 1
    buffer_atomic_add v1, v253, s[32:35], 0 offen offset:128 sc1
L_xpub:
    s_mov_b32 s72, 1600000
L_lw_115:
    ds_read_b32 v1, v255 offset:88
    s_waitcnt lgkmcnt(0)
    v_readfirstlane_b32 s73, v1
    s_nop 0
    s_cmp_ge_u32 s73, 4
    s_cbranch_scc1 L_ld_116
    s_sleep 1
    s_sub_u32 s72, s72, 1
    s_cbranch_scc0 L_lw_115
L_ld_116:
    ds_read_b128 v[180:183], v245 offset:0
    ds_read_b128 v[184:187], v245 offset:256
    ds_read_b128 v[188:191], v245 offset:512
    ds_read_b128 v[192:195], v245 offset:768
    ds_read_b128 v[196:199], v245 offset:1024
    ds_read_b128 v[200:203], v245 offset:1280
    ds_read_b128 v[204:207], v245 offset:1536
    s_cmp_ge_u32 s3, 2
    s_cselect_b32 s72, 1073741824, 0
    v_add_u32 v245, s72, v246
    s_waitcnt lgkmcnt(6)
    buffer_store_dwordx4 v[180:183], v246, s[12:15], s61 offen sc1
    s_add_u32 s61, s61, 16384
    s_waitcnt lgkmcnt(5)
    buffer_store_dwordx4 v[184:187], v246, s[12:15], s61 offen sc1
    s_add_u32 s61, s61, 16384
    s_waitcnt lgkmcnt(4)
    buffer_store_dwordx4 v[188:191], v246, s[12:15], s61 offen sc1
    s_add_u32 s61, s61, 16384
    s_waitcnt lgkmcnt(3)
    buffer_store_dwordx4 v[192:195], v246, s[12:15], s61 offen sc1
    s_add_u32 s61, s61, 16384
    s_waitcnt lgkmcnt(2)
    buffer_store_dwordx4 v[196:199], v246, s[12:15], s61 offen sc1
    s_add_u32 s61, s61, 16384
    s_waitcnt lgkmcnt(1)
    buffer_store_dwordx4 v[200:203], v246, s[12:15], s61 offen sc1
    s_add_u32 s61, s61, 16384
    s_waitcnt lgkmcnt(0)
    buffer_store_dwordx4 v[204:207], v245, s[12:15], s61 offen sc1
    s_add_u32 s61, s61, 16384
    v_mov_b32 v1, 1
    s_mov_b64 exec, 1
    ds_add_u32 v255, v1 offset:120
    s_mov_b64 exec, -1
    s_cmp_ge_u32 s71, 15
    s_cselect_b32 s72, 1073741824, 0
    v_lshl_add_u32 v1, v0, 2, s72
    v_mov_b32 v3, -1
    buffer_store_dword v3, v1, s[12:15], s54 offen sc1
    s_lshl_b32 s72, s3, 8
    v_lshrrev_b32 v29, 4, v0
    v_lshl_add_u32 v29, v29, 8, s72
    v_lshl_add_u32 v29, v0, 2, v29
    buffer_load_dword v28, v29, s[32:35], 0 offen offset:0 sc1
    v_lshrrev_b32 v1, 4, v0
    v_lshlrev_b32 v1, 3, v1
    s_xor_b32 s72, s69, 0
    s_add_u32 s72, s72, s82
    buffer_load_dwordx2 v[60:61], v1, s[20:23], s72 offen
    s_xor_b32 s72, s69, 32
    s_add_u32 s72, s72, s82
    buffer_load_dwordx2 v[62:63], v1, s[20:23], s72 offen
    s_xor_b32 s72, s69, 64
    s_add_u32 s72, s72, s82
    buffer_load_dwordx2 v[64:65], v1, s[20:23], s72 offen
    s_xor_b32 s72, s69, 96
    s_add_u32 s72, s72, s82
    buffer_load_dwordx2 v[66:67], v1, s[20:23], s72 offen
    s_setpc_b64 s[66:67]
L_pe1:
    s_mul_i32 s49, s48, 94
    s_lshr_b32 s49, s49, 10
    s_mul_i32 s72, s49, 11
    s_sub_u32 s50, s48, s72
    s_lshl_b32 s50, s50, 2
    s_add_u32 s50, s50, s3
    s_add_u32 s49, s49, 2
    s_mul_i32 s53, s49, 35152
    s_add_u32 s58, s53, 35152
    v_lshlrev_b32 v1, 4, v0
    s_mul_i32 s72, s3, 9216
    s_add_u32 s72, s72, s53
    buffer_load_dwordx4 v[68:71], v1, s[56:59], s72 offen offset:0
    buffer_load_dwordx4 v[72:75], v1, s[56:59], s72 offen offset:1024
    buffer_load_dwordx4 v[76:79], v1, s[56:59], s72 offen offset:2048
    buffer_load_dwordx4 v[80:83], v1, s[56:59], s72 offen offset:3072
    s_add_u32 s72, s72, 4096
    buffer_load_dwordx4 v[84:87], v1, s[56:59], s72 offen offset:0
    buffer_load_dwordx4 v[88:91], v1, s[56:59], s72 offen offset:1024
    buffer_load_dwordx4 v[92:95], v1, s[56:59], s72 offen offset:2048
    buffer_load_dwordx4 v[96:99], v1, s[56:59], s72 offen offset:3072
    s_add_u32 s72, s72, 4096
    buffer_load_dwordx4 v[100:103], v1, s[56:59], s72 offen offset:0
    s_cmp_ge_u32 s48, 22
    s_cbranch_scc1 L_ret
    s_lshl_b32 s72, s50, 4
    s_add_u32 s72, s72, s53
    buffer_load_dwordx4 v[104:107], v243, s[56:59], s72 offen
    v_lshlrev_b32 v1, 1, v254
    s_mul_i32 s72, s49, 52
    buffer_load_ushort v121, v1, s[44:47], s72 offen
    buffer_load_ushort v122, v1, s[44:47], 52 offen
    v_lshrrev_b32 v3, 5, v0
    v_mul_u32_u24 v3, 26, v3
    s_lshl_b32 s72, s50, 3
    s_sub_u32 s72, s72, 338
    s_lshl_b32 s73, s72, 1
    s_add_u32 s73, s73, 52
    s_cmp_lt_u32 s72, 13
    s_cselect_b32 s73, s73, 1073741824
    v_add_u32 v2, s73, v3
    buffer_load_ushort v108, v2, s[44:47], 0 offen
    s_lshl_b32 s72, s50, 3
    s_sub_u32 s72, s72, 337
    s_lshl_b32 s73, s72, 1
    s_add_u32 s73, s73, 52
    s_cmp_lt_u32 s72, 13
    s_cselect_b32 s73, s73, 1073741824
    v_add_u32 v2, s73, v3
    buffer_load_ushort v109, v2, s[44:47], 0 offen
    s_lshl_b32 s72, s50, 3
    s_sub_u32 s72, s72, 336
    s_lshl_b32 s73, s72, 1
    s_add_u32 s73, s73, 52
    s_cmp_lt_u32 s72, 13
    s_cselect_b32 s73, s73, 1073741824
    v_add_u32 v2, s73, v3
    buffer_load_ushort v110, v2, s[44:47], 0 offen
    s_lshl_b32 s72, s50, 3
    s_sub_u32 s72, s72, 335
    s_lshl_b32 s73, s72, 1
    s_add_u32 s73, s73, 52
    s_cmp_lt_u32 s72, 13
    s_cselect_b32 s73, s73, 1073741824
    v_add_u32 v2, s73, v3
    buffer_load_ushort v111, v2, s[44:47], 0 offen
    s_lshl_b32 s72, s50, 3
    s_sub_u32 s72, s72, 334
    s_lshl_b32 s73, s72, 1
    s_add_u32 s73, s73, 52
    s_cmp_lt_u32 s72, 13
    s_cselect_b32 s73, s73, 1073741824
    v_add_u32 v2, s73, v3
    buffer_load_ushort v112, v2, s[44:47], 0 offen
    s_lshl_b32 s72, s50, 3
    s_sub_u32 s72, s72, 333
    s_lshl_b32 s73, s72, 1
    s_add_u32 s73, s73, 52
    s_cmp_lt_u32 s72, 13
    s_cselect_b32 s73, s73, 1073741824
    v_add_u32 v2, s73, v3
    buffer_load_ushort v113, v2, s[44:47], 0 offen
    s_lshl_b32 s72, s50, 3
    s_sub_u32 s72, s72, 332
    s_lshl_b32 s73, s72, 1
    s_add_u32 s73, s73, 52
    s_cmp_lt_u32 s72, 13
    s_cselect_b32 s73, s73, 1073741824
    v_add_u32 v2, s73, v3
    buffer_load_ushort v114, v2, s[44:47], 0 offen
    s_lshl_b32 s72, s50, 3
    s_sub_u32 s72, s72, 331
    s_lshl_b32 s73, s72, 1
    s_add_u32 s73, s73, 52
    s_cmp_lt_u32 s72, 13
    s_cselect_b32 s73, s73, 1073741824
    v_add_u32 v2, s73, v3
    buffer_load_ushort v115, v2, s[44:47], 0 offen
L_ret:
    s_setpc_b64 s[66:67]
L_pe2:
    s_waitcnt vmcnt(13)
    v_mov_b32 v255, 160000
    v_and_b32 v68, s80, v68
    v_and_b32 v69, s80, v69
    v_and_b32 v70, s80, v70
    v_and_b32 v71, s80, v71
    v_and_b32 v72, s80, v72
    v_and_b32 v73, s80, v73
    v_and_b32 v74, s80, v74
    v_and_b32 v75, s80, v75
    v_and_b32 v76, s80, v76
    v_and_b32 v77, s80, v77
    v_and_b32 v78, s80, v78
    v_and_b32 v79, s80, v79
    v_and_b32 v80, s80, v80
    v_and_b32 v81, s80, v81
    v_and_b32 v82, s80, v82
    v_and_b32 v83, s80, v83
    v_and_b32 v84, s80, v84
    v_and_b32 v85, s80, v85
    v_and_b32 v86, s80, v86
    v_and_b32 v87, s80, v87
    v_and_b32 v88, s80, v88
    v_and_b32 v89, s80, v89
    v_and_b32 v90, s80, v90
    v_and_b32 v91, s80, v91
    v_and_b32 v92, s80, v92
    v_and_b32 v93, s80, v93
    v_and_b32 v94, s80, v94
    v_and_b32 v95, s80, v95
    v_and_b32 v96, s80, v96
    v_and_b32 v97, s80, v97
    v_and_b32 v98, s80, v98
    v_and_b32 v99, s80, v99
    v_and_b32 v100, s80, v100
    v_and_b32 v101, s80, v101
    v_and_b32 v102, s80, v102
    v_and_b32 v103, s80, v103
    v_pk_max_u16 v1, v68, v69
    v_pk_max_u16 v3, v70, v71
    v_pk_max_u16 v1, v1, v72
    v_pk_max_u16 v3, v3, v73
    v_pk_max_u16 v1, v1, v74
    v_pk_max_u16 v3, v3, v75
    v_pk_max_u16 v1, v1, v76
    v_pk_max_u16 v3, v3, v77
    v_pk_max_u16 v1, v1, v78
    v_pk_max_u16 v3, v3, v79
    v_pk_max_u16 v1, v1, v80
    v_pk_max_u16 v3, v3, v81
    v_pk_max_u16 v1, v1, v82
    v_pk_max_u16 v3, v3, v83
    v_pk_max_u16 v1, v1, v84
    v_pk_max_u16 v3, v3, v85
    v_pk_max_u16 v1, v1, v86
    v_pk_max_u16 v3, v3, v87
    v_pk_max_u16 v1, v1, v88
    v_pk_max_u16 v3, v3, v89
    v_pk_max_u16 v1, v1, v90
    v_pk_max_u16 v3, v3, v91
    v_pk_max_u16 v1, v1, v92
    v_pk_max_u16 v3, v3, v93
    v_pk_max_u16 v1, v1, v94
    v_pk_max_u16 v3, v3, v95
    v_pk_max_u16 v1, v1, v96
    v_pk_max_u16 v3, v3, v97
    v_pk_max_u16 v1, v1, v98
    v_pk_max_u16 v3, v3, v99
    v_pk_max_u16 v1, v1, v100
    v_pk_max_u16 v3, v3, v101
    v_pk_max_u16 v1, v1, v102
    v_pk_max_u16 v3, v3, v103
    v_pk_max_u16 v1, v1, v3
    v_alignbit_b32 v3, v1, v1, 16
    v_pk_max_u16 v1, v1, v3
    s_nop 1
    v_max_u32_dpp v1, v1, v1 row_ror:8 row_mask:0xf bank_mask:0xf
    s_nop 1
    v_max_u32_dpp v1, v1, v1 row_ror:4 row_mask:0xf bank_mask:0xf
    s_nop 1
    v_max_u32_dpp v1, v1, v1 row_ror:2 row_mask:0xf bank_mask:0xf
    s_nop 1
    v_max_u32_dpp v1, v1, v1 row_ror:1 row_mask:0xf bank_mask:0xf
    v_lshrrev_b32 v2, 4, v0
    s_lshl_b32 s72, s3, 4
    s_add_u32 s72, s72, 159872
    v_lshl_add_u32 v2, v2, 2, s72
    ds_write_b32 v2, v1
    s_add_u32 s68, s68, 4
    v_mov_b32 v1, 1
    s_mov_b64 exec, 1
    ds_add_u32 v255, v1 offset:48
    s_mov_b64 exec, -1
    s_mov_b32 s72, 1600000
L_lw_117:
    ds_read_b32 v1, v255 offset:48
    s_waitcnt lgkmcnt(0)
    v_readfirstlane_b32 s73, v1
    s_nop 0
    s_cmp_ge_u32 s73, s68
    s_cbranch_scc1 L_ld_118
    s_sleep 1
    s_sub_u32 s72, s72, 1
    s_cbranch_scc0 L_lw_117
L_ld_118:
    v_and_b32 v2, 15, v0
    v_lshlrev_b32 v2, 2, v2
    v_add_u32 v2, 159872, v2
    ds_read_b32 v1, v2
    s_waitcnt lgkmcnt(0)
    v_max_u32_dpp v1, v1, v1 row_ror:8 row_mask:0xf bank_mask:0xf
    s_nop 1
    v_max_u32_dpp v1, v1, v1 row_ror:4 row_mask:0xf bank_mask:0xf
    s_nop 1
    v_max_u32_dpp v1, v1, v1 row_ror:2 row_mask:0xf bank_mask:0xf
    s_nop 1
    v_max_u32_dpp v1, v1, v1 row_ror:1 row_mask:0xf bank_mask:0xf
    s_nop 0
    v_readfirstlane_b32 s51, v1
    s_nop 0
    s_bfe_u32 s51, s51, 0x80007
    s_cmp_ge_u32 s48, 22
    s_cbranch_scc1 L_ret
L_gjob:
    s_min_u32 s74, s51, 249
    s_sub_u32 s75, 251, s74
    s_lshl_b32 s75, s75, 23
    s_cmp_lt_u32 s50, 42
    s_cselect_b32 s73, -1, 0
    v_and_b32 v105, s73, v105
    v_and_b32 v106, s73, v106
    v_and_b32 v107, s73, v107
    s_cmp_lt_u32 s50, 43
    s_cselect_b32 s73, -1, 0
    v_and_b32 v104, s73, v104
    v_alignbit_b32 v104, v104, v104, v252
    v_alignbit_b32 v105, v105, v105, v252
    v_alignbit_b32 v106, v106, v106, v252
    v_alignbit_b32 v107, v107, v107, v252
    v_lshlrev_b32 v68, 16, v104
    v_and_b32 v69, 0xffff0000, v104
    v_lshlrev_b32 v70, 16, v105
    v_and_b32 v71, 0xffff0000, v105
    v_lshlrev_b32 v72, 16, v106
    v_and_b32 v73, 0xffff0000, v106
    v_lshlrev_b32 v74, 16, v107
    v_and_b32 v75, 0xffff0000, v107
    v_mul_f32 v68, s75, v68
    v_mul_f32 v69, s75, v69
    v_mul_f32 v70, s75, v70
    v_mul_f32 v71, s75, v71
    v_mul_f32 v72, s75, v72
    v_mul_f32 v73, s75, v73
    v_mul_f32 v74, s75, v74
    v_mul_f32 v75, s75, v75
    v_cvt_pk_f16_f32 v104, v68, v69
    v_cvt_pk_f16_f32 v105, v70, v71
    v_cvt_pk_f16_f32 v106, v72, v73
    v_cvt_pk_f16_f32 v107, v74, v75
    v_lshlrev_b32 v121, 16, v121
    v_and_b32 v1, 0x7fffffff, v121
    s_nop 1
    v_max_u32_dpp v1, v1, v1 row_ror:8 row_mask:0xf bank_mask:0xf
    s_nop 1
    v_max_u32_dpp v1, v1, v1 row_ror:4 row_mask:0xf bank_mask:0xf
    s_nop 1
    v_max_u32_dpp v1, v1, v1 row_ror:2 row_mask:0xf bank_mask:0xf
    s_nop 1
    v_max_u32_dpp v1, v1, v1 row_ror:1 row_mask:0xf bank_mask:0xf
    s_nop 0
    v_readlane_b32 s52, v1, 0
    v_readlane_b32 s72, v1, 16
    s_nop 0
    s_max_u32 s52, s52, s72
    v_readlane_b32 s72, v1, 32
    s_nop 0
    s_max_u32 s52, s52, s72
    v_readlane_b32 s72, v1, 48
    s_nop 0
    s_max_u32 s52, s52, s72
    s_lshr_b32 s52, s52, 23
    s_sub_u32 s52, s52, 126
    s_sub_u32 s52, s52, 13
    s_sub_u32 s72, 0, s52
    v_ldexp_f32 v121, v121, s72
    v_mul_f32 v68, v68, v121
    v_mul_f32 v69, v69, v121
    v_mul_f32 v70, v70, v121
    v_mul_f32 v71, v71, v121
    v_mul_f32 v72, v72, v121
    v_mul_f32 v73, v73, v121
    v_mul_f32 v74, v74, v121
    v_mul_f32 v75, v75, v121
    v_add_f32_dpp v68, v68, v68 row_shr:1 row_mask:0xf bank_mask:0xf bound_ctrl:0
    v_add_f32_dpp v69, v69, v69 row_shr:1 row_mask:0xf bank_mask:0xf bound_ctrl:0
    v_add_f32_dpp v70, v70, v70 row_shr:1 row_mask:0xf bank_mask:0xf bound_ctrl:0
    v_add_f32_dpp v71, v71, v71 row_shr:1 row_mask:0xf bank_mask:0xf bound_ctrl:0
    v_add_f32_dpp v72, v72, v72 row_shr:1 row_mask:0xf bank_mask:0xf bound_ctrl:0
    v_add_f32_dpp v73, v73, v73 row_shr:1 row_mask:0xf bank_mask:0xf bound_ctrl:0
    v_add_f32_dpp v74, v74, v74 row_shr:1 row_mask:0xf bank_mask:0xf bound_ctrl:0
    v_add_f32_dpp v75, v75, v75 row_shr:1 row_mask:0xf bank_mask:0xf bound_ctrl:0
    v_add_f32_dpp v68, v68, v68 row_shr:2 row_mask:0xf bank_mask:0xf bound_ctrl:0
    v_add_f32_dpp v69, v69, v69 row_shr:2 row_mask:0xf bank_mask:0xf bound_ctrl:0
    v_add_f32_dpp v70, v70, v70 row_shr:2 row_mask:0xf bank_mask:0xf bound_ctrl:0
    v_add_f32_dpp v71, v71, v71 row_shr:2 row_mask:0xf bank_mask:0xf bound_ctrl:0
    v_add_f32_dpp v72, v72, v72 row_shr:2 row_mask:0xf bank_mask:0xf bound_ctrl:0
    v_add_f32_dpp v73, v73, v73 row_shr:2 row_mask:0xf bank_mask:0xf bound_ctrl:0
    v_add_f32_dpp v74, v74, v74 row_shr:2 row_mask:0xf bank_mask:0xf bound_ctrl:0
    v_add_f32_dpp v75, v75, v75 row_shr:2 row_mask:0xf bank_mask:0xf bound_ctrl:0
    v_add_f32_dpp v68, v68, v68 row_shr:4 row_mask:0xf bank_mask:0xf bound_ctrl:0
    v_add_f32_dpp v69, v69, v69 row_shr:4 row_mask:0xf bank_mask:0xf bound_ctrl:0
    v_add_f32_dpp v70, v70, v70 row_shr:4 row_mask:0xf bank_mask:0xf bound_ctrl:0
    v_add_f32_dpp v71, v71, v71 row_shr:4 row_mask:0xf bank_mask:0xf bound_ctrl:0
    v_add_f32_dpp v72, v72, v72 row_shr:4 row_mask:0xf bank_mask:0xf bound_ctrl:0
    v_add_f32_dpp v73, v73, v73 row_shr:4 row_mask:0xf bank_mask:0xf bound_ctrl:0
    v_add_f32_dpp v74, v74, v74 row_shr:4 row_mask:0xf bank_mask:0xf bound_ctrl:0
    v_add_f32_dpp v75, v75, v75 row_shr:4 row_mask:0xf bank_mask:0xf bound_ctrl:0
    v_add_f32_dpp v68, v68, v68 row_shr:8 row_mask:0xf bank_mask:0xf bound_ctrl:0
    v_add_f32_dpp v69, v69, v69 row_shr:8 row_mask:0xf bank_mask:0xf bound_ctrl:0
    v_add_f32_dpp v70, v70, v70 row_shr:8 row_mask:0xf bank_mask:0xf bound_ctrl:0
    v_add_f32_dpp v71, v71, v71 row_shr:8 row_mask:0xf bank_mask:0xf bound_ctrl:0
    v_add_f32_dpp v72, v72, v72 row_shr:8 row_mask:0xf bank_mask:0xf bound_ctrl:0
    v_add_f32_dpp v73, v73, v73 row_shr:8 row_mask:0xf bank_mask:0xf bound_ctrl:0
    v_add_f32_dpp v74, v74, v74 row_shr:8 row_mask:0xf bank_mask:0xf bound_ctrl:0
    v_add_f32_dpp v75, v75, v75 row_shr:8 row_mask:0xf bank_mask:0xf bound_ctrl:0
    v_add_f32_dpp v68, v68, v68 row_bcast:15 row_mask:0xa bank_mask:0xf
    v_add_f32_dpp v69, v69, v69 row_bcast:15 row_mask:0xa bank_mask:0xf
    v_add_f32_dpp v70, v70, v70 row_bcast:15 row_mask:0xa bank_mask:0xf
    v_add_f32_dpp v71, v71, v71 row_bcast:15 row_mask:0xa bank_mask:0xf
    v_add_f32_dpp v72, v72, v72 row_bcast:15 row_mask:0xa bank_mask:0xf
    v_add_f32_dpp v73, v73, v73 row_bcast:15 row_mask:0xa bank_mask:0xf
    v_add_f32_dpp v74, v74, v74 row_bcast:15 row_mask:0xa bank_mask:0xf
    v_add_f32_dpp v75, v75, v75 row_bcast:15 row_mask:0xa bank_mask:0xf
    v_cvt_pk_f16_f32 v68, v68, v69
    v_cvt_pk_f16_f32 v70, v70, v71
    v_cvt_pk_f16_f32 v72, v72, v73
    v_cvt_pk_f16_f32 v74, v74, v75
    v_and_b32 v2, 31, v0
    v_cmp_eq_u32 vcc, 31, v2
    s_nop 1
    v_cndmask_b32 v104, v104, v68, vcc
    v_cndmask_b32 v105, v105, v70, vcc
    v_cndmask_b32 v106, v106, v72, vcc
    v_cndmask_b32 v107, v107, v74, vcc
    v_lshlrev_b32 v1, 16, v122
    v_and_b32 v1, 0x7fffffff, v1
    s_nop 1
    v_max_u32_dpp v1, v1, v1 row_ror:8 row_mask:0xf bank_mask:0xf
    s_nop 1
    v_max_u32_dpp v1, v1, v1 row_ror:4 row_mask:0xf bank_mask:0xf
    s_nop 1
    v_max_u32_dpp v1, v1, v1 row_ror:2 row_mask:0xf bank_mask:0xf
    s_nop 1
    v_max_u32_dpp v1, v1, v1 row_ror:1 row_mask:0xf bank_mask:0xf
    s_nop 0
    v_readlane_b32 s62, v1, 0
    v_readlane_b32 s72, v1, 16
    s_nop 0
    s_max_u32 s62, s62, s72
    v_readlane_b32 s72, v1, 32
    s_nop 0
    s_max_u32 s62, s62, s72
    v_readlane_b32 s72, v1, 48
    s_nop 0
    s_max_u32 s62, s62, s72
    s_lshr_b32 s62, s62, 23
    s_sub_u32 s62, s62, 126
    s_sub_u32 s72, 15, s62
    v_lshlrev_b32 v108, 16, v108
    v_lshlrev_b32 v109, 16, v109
    v_lshlrev_b32 v110, 16, v110
    v_lshlrev_b32 v111, 16, v111
    v_lshlrev_b32 v112, 16, v112
    v_lshlrev_b32 v113, 16, v113
    v_lshlrev_b32 v114, 16, v114
    v_lshlrev_b32 v115, 16, v115
    v_ldexp_f32 v108, v108, s72
    v_ldexp_f32 v109, v109, s72
    v_ldexp_f32 v110, v110, s72
    v_ldexp_f32 v111, v111, s72
    v_ldexp_f32 v112, v112, s72
    v_ldexp_f32 v113, v113, s72
    v_ldexp_f32 v114, v114, s72
    v_ldexp_f32 v115, v115, s72
    v_cvt_pk_f16_f32 v108, v108, v109
    v_cvt_pk_f16_f32 v110, v110, v111
    v_cvt_pk_f16_f32 v112, v112, v113
    v_cvt_pk_f16_f32 v114, v114, v115
    v_cmp_eq_u32 vcc, 30, v2
    s_nop 1
    v_cndmask_b32 v104, v104, v108, vcc
    v_cndmask_b32 v105, v105, v110, vcc
    v_cndmask_b32 v106, v106, v112, vcc
    v_cndmask_b32 v107, v107, v114, vcc
    s_cmp_lg_u32 s50, 0
    s_cbranch_scc1 L_nohdr
    s_sub_u32 s74, s74, 124
    s_add_u32 s52, s52, s74
    s_sub_u32 s62, s62, 15
    v_writelane_b32 v104, s74, 29
    v_writelane_b32 v105, s52, 29
    v_writelane_b32 v106, s62, 29
L_nohdr:
    s_mul_i32 s72, s49, 45056
    s_lshl_b32 s73, s50, 10
    s_add_u32 s72, s72, s73
    s_sub_u32 s72, s72, 90112
    v_lshlrev_b32 v1, 4, v0
    buffer_store_dwordx4 v[104:107], v1, s[12:15], s72 offen sc1
    s_nop 0
    s_setpc_b64 s[66:67]
L_cs_6:
    s_mov_b32 s73, 1600000
L_ct_8:
    s_sleep 1
    ds_read_b32 v2, v3
    s_waitcnt lgkmcnt(0)
    v_readfirstlane_b32 s74, v2
    s_nop 0
    s_cmp_ge_u32 s74, 4
    s_cbranch_scc1 L_cb_7
    s_sub_u32 s73, s73, 1
    s_cbranch_scc0 L_ct_8
    s_branch L_cb_7
L_cs_9:
    s_mov_b32 s73, 1600000
L_ct_11:
    s_sleep 1
    ds_read_b32 v2, v3
    s_waitcnt lgkmcnt(0)
    v_readfirstlane_b32 s74, v2
    s_nop 0
    s_cmp_ge_u32 s74, 4
    s_cbranch_scc1 L_cb_10
    s_sub_u32 s73, s73, 1
    s_cbranch_scc0 L_ct_11
    s_branch L_cb_10
L_cs_12:
    s_mov_b32 s73, 1600000
L_ct_14:
    s_sleep 1
    ds_read_b32 v2, v3
    s_waitcnt lgkmcnt(0)
    v_readfirstlane_b32 s74, v2
    s_nop 0
    s_cmp_ge_u32 s74, 4
    s_cbranch_scc1 L_cb_13
    s_sub_u32 s73, s73, 1
    s_cbranch_scc0 L_ct_14
    s_branch L_cb_13
L_cs_15:
    s_mov_b32 s73, 1600000
L_ct_17:
    s_sleep 1
    ds_read_b32 v2, v3
    s_waitcnt lgkmcnt(0)
    v_readfirstlane_b32 s74, v2
    s_nop 0
    s_cmp_ge_u32 s74, 4
    s_cbranch_scc1 L_cb_16
    s_sub_u32 s73, s73, 1
    s_cbranch_scc0 L_ct_17
    s_branch L_cb_16
L_rdys:
    s_sleep 8
    buffer_load_dword v28, v29, s[32:35], 0 offen offset:0 sc1
    s_waitcnt vmcnt(0)
    s_sub_u32 s72, s72, 1
    s_cbranch_scc0 L_rdy
    s_branch L_rdyd
L_ps_33:
    s_sleep 8
    s_sub_u32 s72, s72, 1
    s_cbranch_scc0 L_pt_32
    s_branch L_pd_31
L_ps_42:
    s_sleep 8
    s_sub_u32 s72, s72, 1
    s_cbranch_scc0 L_pt_41
    s_branch L_pd_40
L_ps_55:
    s_sleep 8
    s_sub_u32 s72, s72, 1
    s_cbranch_scc0 L_pt_54
    s_branch L_pd_53
L_ps_66:
    s_sleep 8
    s_sub_u32 s72, s72, 1
    s_cbranch_scc0 L_pt_65
    s_branch L_pd_64
L_ps_92:
    s_sleep 8
    s_sub_u32 s72, s72, 1
    s_cbranch_scc0 L_pt_91
    s_branch L_pd_90
L_ps_102:
    s_sleep 8
    s_sub_u32 s72, s72, 1
    s_cbranch_scc0 L_pt_101
    s_branch L_pd_100
L_ps_109:
    s_sleep 8
    s_sub_u32 s72, s72, 1
    s_cbranch_scc0 L_pt_108
    s_branch L_pd_107
L_end:
    s_endpgm
.section .rodata,"a"
.p2align 6
.amdhsa_kernel standalone__deep_cross_xdeepfm__recsys_kernel
  .amdhsa_next_free_vgpr 256
  .amdhsa_next_free_sgpr 102
  .amdhsa_accum_offset 256
  .amdhsa_group_segment_fixed_size 0
  .amdhsa_kernarg_size 88
  .amdhsa_user_sgpr_count 2
  .amdhsa_user_sgpr_kernarg_segment_ptr 1
  .amdhsa_system_sgpr_workgroup_id_x 1
.end_amdhsa_kernel
```
